```python
import torch

def _softmax(x, axis=-1):
    return torch.softmax(x, dim=axis)

def _gelu(x):
    return torch.nn.functional.gelu(x, approximate='tanh')

def _silu(x):
    return torch.nn.functional.silu(x)

def _sigmoid(x):
    return torch.sigmoid(x)

def _layernorm(x, axis=-1, eps=1e-05):
    m = x.mean(dim=axis, keepdim=True)
    v = x.var(dim=axis, keepdim=True, unbiased=False)
    return (x - m) / torch.sqrt(v + eps)

def _scatter_add(tgt, idx, src, axis=0):
    return tgt.clone().index_add_(axis, idx, src)

def _segment_sum(src, seg, n):
    out = torch.zeros((n,) + src.shape[1:], dtype=src.dtype)
    return out.index_add_(0, seg, src)

def _pad(x, pw):
    flat = tuple((v for pair in reversed(pw) for v in pair))
    return torch.nn.functional.pad(x, flat)
kernel_name = 'adaLN_cond__mha_block__mixer_gmlp__prompt'

def setup_inputs():

    _w = lambda a: (lambda t: t.to(torch.bfloat16) if t.is_floating_point() else t)(torch.as_tensor(a))

    def _A_setup():
        B, S, D, H = (1, 2048, 512, 32)
        return {'x': _w((lambda *s: torch.randn(*s, dtype=torch.bfloat16) * 0.05)(B, S, D)), 'wqkv': _w((lambda *s: torch.randn(*s, dtype=torch.bfloat16) * 0.05)(D, 3 * D)), 'wo': _w((lambda *s: torch.randn(*s, dtype=torch.bfloat16) * 0.05)(D, D))}
    _A_in = _A_setup()

    def _B_setup():
        B, S, D, F = (1, 2048, 512, 1792)
        Fh = F // 2
        return {'x': _w((lambda *s: torch.randn(*s, dtype=torch.bfloat16) * 0.05)(B, S, D)), 'w_in': _w((lambda *s: torch.randn(*s, dtype=torch.bfloat16) * 0.4)(D, 2 * Fh)), 'w_sp': _w(0.01 * (lambda *s: torch.randn(*s, dtype=torch.bfloat16) * 0.4)(S, S)), 'b_sp': _w(1.0 + 0.01 * (lambda *s: torch.randn(*s, dtype=torch.bfloat16) * 0.05)(S)), 'w_out': _w((lambda *s: torch.randn(*s, dtype=torch.bfloat16) * 0.05)(Fh, D))}
    _B_in = _B_setup()
    return {'A_x': _A_in['x'], 'A_wqkv': _A_in['wqkv'], 'A_wo': _A_in['wo'], 'B_x': _B_in['x'], 'B_w_in': _B_in['w_in'], 'B_w_sp': _B_in['w_sp'], 'B_b_sp': _B_in['b_sp'], 'B_w_out': _B_in['w_out'], 'c': _w((lambda *s: torch.randn(*s, dtype=torch.bfloat16) * 0.1)(1, 512) * 8.0), 'w_mod': _w((lambda *s: torch.randn(*s, dtype=torch.bfloat16) * 0.1)(512, 6 * 512) * 512 ** (-0.5) * 8.0)}

def reference(A_x, A_wqkv, A_wo, B_x, B_w_in, B_w_sp, B_b_sp, B_w_out, c, w_mod):

    def _A_ref(x, wqkv, wo):
        B, S, D = x.shape
        H = 32
        Dh = D // H
        qkv = (lambda x, *d: x.permute(*d))((x @ wqkv).reshape(B, S, 3, H, Dh), 2, 0, 3, 1, 4)
        q, k, v = (qkv[0], qkv[1], qkv[2])
        scores = torch.einsum('bhqd,bhkd->bhqk', q, k) * Dh ** (-0.5)
        p = _softmax(scores, axis=-1)
        o = torch.einsum('bhqk,bhkd->bhqd', p, v)
        return (lambda x, *d: x.permute(*d))(o, 0, 2, 1, 3).reshape(B, S, D) @ wo

    def _B_ref(x, w_in, w_sp, b_sp, w_out):
        B, S, D = x.shape
        F = w_in.shape[-1]
        Fh = F // 2
        z = _gelu(torch.einsum('bsd,df->bsf', x, w_in))
        z1 = z[..., :Fh].clone()
        z2 = _layernorm(z[..., Fh:], axis=-1)
        g = torch.einsum('ts,bsf->btf', w_sp, z2) + b_sp[None, :, None]
        return torch.einsum('bsf,fd->bsd', z1 * g, w_out)
    x = A_x
    mod = (_silu(c) @ w_mod).reshape(c.shape[0], 6, 1, -1)
    sa, ca, ga, sb, cb, gb = (mod[:, 0].clone(), mod[:, 1].clone(), mod[:, 2].clone(), mod[:, 3].clone(), mod[:, 4].clone(), mod[:, 5].clone())
    h = _layernorm(x, axis=-1) * (1 + ca) + sa
    x = x + ga * _A_ref(h, A_wqkv, A_wo)
    h = _layernorm(x, axis=-1) * (1 + cb) + sb
    x = x + gb * _B_ref(h, B_w_in, B_w_sp, B_b_sp, B_w_out)
    return x
```

```asm
; @launch grid=(256,1,1) block=(512,1,1) lds=163840
.amdgcn_target "amdgcn-amd-amdhsa--gfx950"
.text
.globl adaLN_cond__mha_block__mixer_gmlp__prompt_kernel
.p2align 8
.type adaLN_cond__mha_block__mixer_gmlp__prompt_kernel,@function
adaLN_cond__mha_block__mixer_gmlp__prompt_kernel:
    s_load_dwordx16 s[16:31], s[0:1], 0
    s_load_dwordx8 s[32:39], s[0:1], 64
    s_load_dwordx2 s[40:41], s[0:1], 96
    s_cmp_ge_u32 s2, 256
    s_cbranch_scc0 go_17001
    s_endpgm
go_17001:
    v_and_b32 v1, 63, v0
    v_lshrrev_b32 v2, 6, v0
    s_nop 0
    v_readfirstlane_b32 s3, v2
    s_waitcnt lgkmcnt(0)
    s_and_b32 s4, s2, 1
    s_lshl_b32 s4, s4, 2
    s_bfe_u32 s5, s2, 0x20003
    s_add_u32 s9, s4, s5
    s_bfe_u32 s4, s2, 0x20001
    s_lshl_b32 s4, s4, 3
    s_lshr_b32 s5, s2, 5
    s_add_u32 s8, s4, s5
    s_and_b32 s4, s2, 7
    s_lshl_b32 s4, s4, 2
    s_bfe_u32 s5, s2, 0x20003
    s_add_u32 s88, s4, s5
    s_lshr_b32 s89, s2, 5
    s_add_u32 s84, s40, 0x10000
    s_addc_u32 s85, s41, 0
    s_mov_b32 s86, 0x8000
    s_mov_b32 s87, 0x00020000
    s_mov_b32 s44, s16
    s_mov_b32 s45, s17
    s_mov_b32 s46, 0x200000
    s_mov_b32 s47, 0x00020000
    s_mov_b32 s52, s40
    s_mov_b32 s53, s41
    s_mov_b32 s54, 0x3000
    s_mov_b32 s55, 0x00020000
    s_mov_b32 s56, s18
    s_mov_b32 s57, s19
    s_mov_b32 s58, 0x180000
    s_mov_b32 s59, 0x00020000
    s_mov_b32 s48, s38
    s_mov_b32 s49, s39
    s_mov_b32 s50, 0x100
    s_mov_b32 s51, 0x00020000
    s_or_b32 s5, s2, s3
    s_cmp_eq_u32 s5, 0
    s_cbranch_scc0 nn_17002
    s_memrealtime s[12:13]
    s_waitcnt lgkmcnt(0)
    s_or_b32 s12, s12, 1
    v_mov_b32 v5, s12
    s_mov_b64 exec, 1
    buffer_store_dword v5, off, s[48:51], 0 sc1
    s_mov_b64 exec, -1
nn_17002:
    s_lshl_b32 s10, s8, 6
    v_lshlrev_b32 v2, 4, v1
    v_lshrrev_b32 v5, 3, v1
    s_lshl_b32 s5, s3, 3
    v_add_u32 v5, s5, v5
    v_mul_u32_u24 v64, 3072, v5
    v_bfe_u32 v5, v1, 4, 1
    s_and_b32 s5, s3, 1
    s_lshl_b32 s5, s5, 1
    v_or_b32 v5, s5, v5
    v_lshlrev_b32 v5, 1, v5
    v_and_b32 v6, 7, v1
    v_xor_b32 v5, v5, v6
    v_lshl_add_u32 v64, v5, 4, v64
    s_lshl_b32 s14, s9, 7
    s_add_u32 s15, s9, 4
    s_and_b32 s15, s15, 7
    s_lshl_b32 s15, s15, 7
    s_add_u32 s42, s9, 4
    s_and_b32 s42, s42, 7
    s_lshl_b32 s42, s42, 7
    s_lshl_b32 s11, s3, 10
    s_add_u32 s11, s11, 65536
    s_cmp_lt_u32 s2, 96
    s_cbranch_scc0 fr_nomod
    s_mov_b32 s60, s34
    s_mov_b32 s61, s35
    s_mov_b32 s62, 0x300000
    s_mov_b32 s63, 0x00020000
    s_mov_b32 s64, s32
    s_mov_b32 s65, s33
    s_mov_b32 s66, 0x400
    s_mov_b32 s67, 0x00020000
    v_lshrrev_b32 v7, 2, v0
    v_and_b32 v10, 3, v0
    v_mul_u32_u24 v4, 6144, v7
    v_lshl_add_u32 v4, v10, 4, v4
    v_lshlrev_b32 v5, 1, v7
    s_lshl_b32 s4, s2, 6
    s_cmp_lt_u32 s2, 32
    s_cbranch_scc0 z_17003
    s_cmp_lt_u32 s3, 4
    s_cbranch_scc0 z_17003
    s_lshl_b32 s5, s2, 10
    v_lshlrev_b32 v8, 2, v0
    v_mov_b32 v9, 0
    buffer_store_dword v9, v8, s[84:87], s5 offen sc1
z_17003:
    buffer_load_ushort v160, v5, s[64:67], 0 offen offset:0
    buffer_load_ushort v161, v5, s[64:67], 0 offen offset:256
    buffer_load_ushort v162, v5, s[64:67], 0 offen offset:512
    buffer_load_ushort v163, v5, s[64:67], 0 offen offset:768
    s_add_u32 s5, s4, 0
    buffer_load_dwordx4 v[128:131], v4, s[60:63], s5 offen
    s_add_u32 s5, s4, 786432
    buffer_load_dwordx4 v[132:135], v4, s[60:63], s5 offen
    s_add_u32 s5, s4, 1572864
    buffer_load_dwordx4 v[136:139], v4, s[60:63], s5 offen
    s_add_u32 s5, s4, 2359296
    buffer_load_dwordx4 v[140:143], v4, s[60:63], s5 offen
    s_waitcnt vmcnt(4)
    v_lshlrev_b32 v160, 16, v160
    v_lshlrev_b32 v161, 16, v161
    v_lshlrev_b32 v162, 16, v162
    v_lshlrev_b32 v163, 16, v163
    v_mul_f32 v176, 0xbfb8aa3b, v160
    v_mul_f32 v177, 0xbfb8aa3b, v161
    v_mul_f32 v178, 0xbfb8aa3b, v162
    v_mul_f32 v179, 0xbfb8aa3b, v163
    v_exp_f32 v176, v176
    v_exp_f32 v177, v177
    v_exp_f32 v178, v178
    v_exp_f32 v179, v179
    v_add_f32 v176, 1.0, v176
    v_add_f32 v177, 1.0, v177
    v_add_f32 v178, 1.0, v178
    v_add_f32 v179, 1.0, v179
    v_rcp_f32 v176, v176
    v_rcp_f32 v177, v177
    v_rcp_f32 v178, v178
    v_rcp_f32 v179, v179
    v_mul_f32 v160, v160, v176
    v_mul_f32 v161, v161, v177
    v_mul_f32 v162, v162, v178
    v_mul_f32 v163, v163, v179
    v_cvt_pk_bf16_f32 v160, v160, v160
    v_lshlrev_b32 v160, 16, v160
    v_cvt_pk_bf16_f32 v161, v161, v161
    v_lshlrev_b32 v161, 16, v161
    v_cvt_pk_bf16_f32 v162, v162, v162
    v_lshlrev_b32 v162, 16, v162
    v_cvt_pk_bf16_f32 v163, v163, v163
    v_lshlrev_b32 v163, 16, v163
    buffer_load_dword v181, off, s[48:51], 0 sc1
    s_lshl_b32 s5, s3, 3
    s_add_u32 s5, s5, s10
    s_lshl_b32 s6, s5, 10
    s_add_u32 s7, s6, 4096
    buffer_load_dwordx4 v[16:19], v2, s[44:47], s6 offen offset:0
    buffer_load_dwordx4 v[20:23], v2, s[44:47], s6 offen offset:1024
    buffer_load_dwordx4 v[24:27], v2, s[44:47], s6 offen offset:2048
    buffer_load_dwordx4 v[28:31], v2, s[44:47], s6 offen offset:3072
    buffer_load_dwordx4 v[32:35], v2, s[44:47], s7 offen offset:0
    buffer_load_dwordx4 v[36:39], v2, s[44:47], s7 offen offset:1024
    buffer_load_dwordx4 v[40:43], v2, s[44:47], s7 offen offset:2048
    buffer_load_dwordx4 v[44:47], v2, s[44:47], s7 offen offset:3072
    s_add_u32 m0, s11, 0
    s_add_u32 s5, s14, 0
    buffer_load_dwordx4 v64, s[56:59], s5 offen lds
    s_add_u32 m0, s11, 8192
    s_add_u32 s5, s15, 1024
    buffer_load_dwordx4 v64, s[56:59], s5 offen lds
    s_add_u32 m0, s11, 16384
    s_add_u32 s5, s42, 2048
    buffer_load_dwordx4 v64, s[56:59], s5 offen lds
    s_add_u32 m0, s11, 24576
    s_add_u32 s5, s14, 196608
    buffer_load_dwordx4 v64, s[56:59], s5 offen lds
    s_add_u32 m0, s11, 32768
    s_add_u32 s5, s15, 197632
    buffer_load_dwordx4 v64, s[56:59], s5 offen lds
    s_add_u32 m0, s11, 40960
    s_add_u32 s5, s42, 198656
    buffer_load_dwordx4 v64, s[56:59], s5 offen lds
    s_add_u32 m0, s11, 49152
    s_add_u32 s5, s14, 393216
    buffer_load_dwordx4 v64, s[56:59], s5 offen lds
    s_add_u32 m0, s11, 57344
    s_add_u32 s5, s15, 394240
    buffer_load_dwordx4 v64, s[56:59], s5 offen lds
    s_add_u32 m0, s11, 65536
    s_add_u32 s5, s42, 395264
    buffer_load_dwordx4 v64, s[56:59], s5 offen lds
    v_mov_b32 v168, 0
    v_mov_b32 v169, 0
    v_mov_b32 v170, 0
    v_mov_b32 v171, 0
    v_mov_b32 v172, 0
    v_mov_b32 v173, 0
    v_mov_b32 v174, 0
    v_mov_b32 v175, 0
    s_waitcnt vmcnt(18)
    v_lshlrev_b32 v6, 16, v128
    v_and_b32 v7, 0xffff0000, v128
    v_fmac_f32 v168, v6, v160
    v_fmac_f32 v169, v7, v160
    v_lshlrev_b32 v8, 16, v129
    v_and_b32 v9, 0xffff0000, v129
    v_fmac_f32 v170, v8, v160
    v_fmac_f32 v171, v9, v160
    v_lshlrev_b32 v6, 16, v130
    v_and_b32 v7, 0xffff0000, v130
    v_fmac_f32 v172, v6, v160
    v_fmac_f32 v173, v7, v160
    v_lshlrev_b32 v8, 16, v131
    v_and_b32 v9, 0xffff0000, v131
    v_fmac_f32 v174, v8, v160
    v_fmac_f32 v175, v9, v160
    v_lshlrev_b32 v6, 16, v132
    v_and_b32 v7, 0xffff0000, v132
    v_fmac_f32 v168, v6, v161
    v_fmac_f32 v169, v7, v161
    v_lshlrev_b32 v8, 16, v133
    v_and_b32 v9, 0xffff0000, v133
    v_fmac_f32 v170, v8, v161
    v_fmac_f32 v171, v9, v161
    v_lshlrev_b32 v6, 16, v134
    v_and_b32 v7, 0xffff0000, v134
    v_fmac_f32 v172, v6, v161
    v_fmac_f32 v173, v7, v161
    v_lshlrev_b32 v8, 16, v135
    v_and_b32 v9, 0xffff0000, v135
    v_fmac_f32 v174, v8, v161
    v_fmac_f32 v175, v9, v161
    v_lshlrev_b32 v6, 16, v136
    v_and_b32 v7, 0xffff0000, v136
    v_fmac_f32 v168, v6, v162
    v_fmac_f32 v169, v7, v162
    v_lshlrev_b32 v8, 16, v137
    v_and_b32 v9, 0xffff0000, v137
    v_fmac_f32 v170, v8, v162
    v_fmac_f32 v171, v9, v162
    v_lshlrev_b32 v6, 16, v138
    v_and_b32 v7, 0xffff0000, v138
    v_fmac_f32 v172, v6, v162
    v_fmac_f32 v173, v7, v162
    v_lshlrev_b32 v8, 16, v139
    v_and_b32 v9, 0xffff0000, v139
    v_fmac_f32 v174, v8, v162
    v_fmac_f32 v175, v9, v162
    v_lshlrev_b32 v6, 16, v140
    v_and_b32 v7, 0xffff0000, v140
    v_fmac_f32 v168, v6, v163
    v_fmac_f32 v169, v7, v163
    v_lshlrev_b32 v8, 16, v141
    v_and_b32 v9, 0xffff0000, v141
    v_fmac_f32 v170, v8, v163
    v_fmac_f32 v171, v9, v163
    v_lshlrev_b32 v6, 16, v142
    v_and_b32 v7, 0xffff0000, v142
    v_fmac_f32 v172, v6, v163
    v_fmac_f32 v173, v7, v163
    v_lshlrev_b32 v8, 16, v143
    v_and_b32 v9, 0xffff0000, v143
    v_fmac_f32 v174, v8, v163
    v_fmac_f32 v175, v9, v163
    v_permlane32_swap_b32 v168, v172
    v_permlane32_swap_b32 v169, v173
    v_permlane32_swap_b32 v170, v174
    v_permlane32_swap_b32 v171, v175
    v_add_f32 v168, v168, v172
    v_add_f32 v169, v169, v173
    v_add_f32 v170, v170, v174
    v_add_f32 v171, v171, v175
    s_nop 1
    v_permlane16_swap_b32 v168, v170
    v_permlane16_swap_b32 v169, v171
    s_nop 1
    v_add_f32 v168, v168, v170
    v_add_f32 v169, v169, v171
    s_nop 1
    v_add_f32_dpp v168, v168, v168 row_ror:4 row_mask:0xf bank_mask:0xf
    v_add_f32_dpp v169, v169, v169 row_ror:4 row_mask:0xf bank_mask:0xf
    s_nop 1
    v_add_f32_dpp v168, v168, v168 row_ror:8 row_mask:0xf bank_mask:0xf
    v_add_f32_dpp v169, v169, v169 row_ror:8 row_mask:0xf bank_mask:0xf
    s_nop 1
    v_lshlrev_b32 v6, 5, v10
    v_bfe_u32 v7, v1, 4, 1
    v_lshl_add_u32 v6, v7, 3, v6
    v_lshrrev_b32 v7, 5, v1
    v_lshl_add_u32 v6, v7, 4, v6
    s_lshl_b32 s5, s3, 7
    v_add_u32 v6, s5, v6
    s_mov_b32 s12, 0x000f000f
    s_mov_b32 s13, 0x000f000f
    s_mov_b64 exec, s[12:13]
    ds_write_b64 v6, v[168:169]
    s_mov_b64 exec, -1
    s_waitcnt lgkmcnt(0)
    s_barrier
    s_cmp_eq_u32 s3, 0
    s_cbranch_scc0 fr_mod_done
    v_lshlrev_b32 v6, 2, v1
    s_mov_b32 s12, -1
    s_mov_b32 s13, 0
    s_mov_b64 exec, s[12:13]
    ds_read_b32 v160, v6 offset:0
    ds_read_b32 v161, v6 offset:128
    ds_read_b32 v162, v6 offset:256
    ds_read_b32 v163, v6 offset:384
    ds_read_b32 v164, v6 offset:512
    ds_read_b32 v165, v6 offset:640
    ds_read_b32 v166, v6 offset:768
    ds_read_b32 v167, v6 offset:896
    s_waitcnt lgkmcnt(0)
    v_add_f32 v160, v160, v164
    v_add_f32 v161, v161, v165
    v_add_f32 v162, v162, v166
    v_add_f32 v163, v163, v167
    v_add_f32 v160, v160, v161
    v_add_f32 v162, v162, v163
    v_add_f32 v160, v160, v162
    v_cvt_pk_bf16_f32 v160, v160, v160
    v_lshlrev_b32 v160, 16, v160
    s_lshr_b32 s5, s2, 4
    s_cmp_eq_u32 s5, 1
    s_cbranch_scc1 fr_p1
    s_cmp_eq_u32 s5, 4
    s_cbranch_scc0 fr_st
fr_p1:
    v_add_f32 v160, 1.0, v160
    v_cvt_pk_bf16_f32 v160, v160, v160
    v_lshlrev_b32 v160, 16, v160
fr_st:
    s_lshl_b32 s5, s2, 7
    buffer_store_dword v160, v6, s[52:55], s5 offen sc1
    s_cmp_lt_u32 s2, 32
    s_cbranch_scc0 fr_nf
    s_add_u32 s64, s40, 0x8000
    s_addc_u32 s65, s41, 0
    s_mov_b32 s66, 0x2000
    s_mov_b32 s67, 0x00020000
    s_mov_b32 s6, 0
    s_waitcnt vmcnt(18)
fr_np:
    v_readfirstlane_b32 s7, v181
    s_nop 0
    s_cmp_lg_u32 s7, 0
    s_cbranch_scc1 fr_nq
    s_add_u32 s6, s6, 1
    s_cmp_gt_u32 s6, 0x20000
    s_cbranch_scc1 fr_nq
    buffer_load_dword v181, off, s[48:51], 0 sc1
    s_waitcnt vmcnt(0)
    s_branch fr_np
fr_nq:
    v_mov_b32 v161, s7
    v_lshlrev_b32 v6, 3, v1
    s_lshl_b32 s5, s2, 8
    buffer_store_dwordx2 v[160:161], v6, s[64:67], s5 offen sc1
    s_waitcnt vmcnt(0)
    s_lshl_b32 s5, s2, 2
    v_mov_b32 v6, 1
    s_mov_b64 exec, 1
    buffer_store_dword v6, off, s[48:51], s5 offset:128 sc1
fr_nf:
    s_mov_b64 exec, -1
fr_mod_done:
    s_branch fr_join
fr_nomod:
    s_lshl_b32 s5, s3, 3
    s_add_u32 s5, s5, s10
    s_lshl_b32 s6, s5, 10
    s_add_u32 s7, s6, 4096
    buffer_load_dwordx4 v[16:19], v2, s[44:47], s6 offen offset:0
    buffer_load_dwordx4 v[20:23], v2, s[44:47], s6 offen offset:1024
    buffer_load_dwordx4 v[24:27], v2, s[44:47], s6 offen offset:2048
    buffer_load_dwordx4 v[28:31], v2, s[44:47], s6 offen offset:3072
    buffer_load_dwordx4 v[32:35], v2, s[44:47], s7 offen offset:0
    buffer_load_dwordx4 v[36:39], v2, s[44:47], s7 offen offset:1024
    buffer_load_dwordx4 v[40:43], v2, s[44:47], s7 offen offset:2048
    buffer_load_dwordx4 v[44:47], v2, s[44:47], s7 offen offset:3072
    s_add_u32 m0, s11, 0
    s_add_u32 s5, s14, 0
    buffer_load_dwordx4 v64, s[56:59], s5 offen lds
    s_add_u32 m0, s11, 8192
    s_add_u32 s5, s15, 1024
    buffer_load_dwordx4 v64, s[56:59], s5 offen lds
    s_add_u32 m0, s11, 16384
    s_add_u32 s5, s42, 2048
    buffer_load_dwordx4 v64, s[56:59], s5 offen lds
    s_add_u32 m0, s11, 24576
    s_add_u32 s5, s14, 196608
    buffer_load_dwordx4 v64, s[56:59], s5 offen lds
    s_add_u32 m0, s11, 32768
    s_add_u32 s5, s15, 197632
    buffer_load_dwordx4 v64, s[56:59], s5 offen lds
    s_add_u32 m0, s11, 40960
    s_add_u32 s5, s42, 198656
    buffer_load_dwordx4 v64, s[56:59], s5 offen lds
    s_add_u32 m0, s11, 49152
    s_add_u32 s5, s14, 393216
    buffer_load_dwordx4 v64, s[56:59], s5 offen lds
    s_add_u32 m0, s11, 57344
    s_add_u32 s5, s15, 394240
    buffer_load_dwordx4 v64, s[56:59], s5 offen lds
    s_add_u32 m0, s11, 65536
    s_add_u32 s5, s42, 395264
    buffer_load_dwordx4 v64, s[56:59], s5 offen lds
fr_join:
    s_mov_b32 s60, s24
    s_mov_b32 s61, s25
    s_mov_b32 s62, 0x1c0000
    s_mov_b32 s63, 0x00020000
    s_sub_u32 s4, s2, 96
    s_lshl_b32 s4, s4, 9
    s_cmp_lt_u32 s2, 224
    s_cselect_b32 s4, s4, 0x40000000
    v_add_u32 v106, s4, v0
    s_mov_b32 s5, 0x24924925
    v_lshrrev_b32 v3, 1, v106
    v_mul_hi_u32 v3, v3, s5
    v_mul_u32_u24 v4, 14, v3
    v_sub_u32 v4, v106, v4
    v_and_b32 v5, 511, v3
    v_lshrrev_b32 v6, 1, v5
    v_and_b32 v6, 4, v6
    v_lshlrev_b32 v7, 1, v5
    v_and_b32 v7, 8, v7
    v_and_b32 v5, 0x1f3, v5
    v_or3_b32 v5, v5, v6, v7
    v_bfe_u32 v6, v3, 9, 1
    v_xor_b32 v6, 1, v6
    v_mul_u32_u24 v6, 1792, v6
    v_lshrrev_b32 v7, 10, v3
    v_mul_u32_u24 v7, 224, v7
    v_mul_u32_u24 v5, 3584, v5
    v_add3_u32 v5, v5, v6, v7
    v_lshl_add_u32 v5, v4, 4, v5
    v_cmp_gt_u32 vcc, 114688, v106
    v_mov_b32 v6, 0x7fffffff
    v_lshlrev_b32 v7, 4, v106
    v_cndmask_b32 v5, v6, v5, vcc
    v_cndmask_b32 v104, v6, v7, vcc
    buffer_load_dwordx4 v[96:99], v5, s[60:63], 0 offen
    v_add_u32 v106, 0x10000, v106
    v_lshrrev_b32 v3, 1, v106
    v_mul_hi_u32 v3, v3, s5
    v_mul_u32_u24 v4, 14, v3
    v_sub_u32 v4, v106, v4
    v_and_b32 v5, 511, v3
    v_lshrrev_b32 v6, 1, v5
    v_and_b32 v6, 4, v6
    v_lshlrev_b32 v7, 1, v5
    v_and_b32 v7, 8, v7
    v_and_b32 v5, 0x1f3, v5
    v_or3_b32 v5, v5, v6, v7
    v_bfe_u32 v6, v3, 9, 1
    v_xor_b32 v6, 1, v6
    v_mul_u32_u24 v6, 1792, v6
    v_lshrrev_b32 v7, 10, v3
    v_mul_u32_u24 v7, 224, v7
    v_mul_u32_u24 v5, 3584, v5
    v_add3_u32 v5, v5, v6, v7
    v_lshl_add_u32 v5, v4, 4, v5
    v_cmp_gt_u32 vcc, 114688, v106
    v_mov_b32 v6, 0x7fffffff
    v_lshlrev_b32 v7, 4, v106
    v_cndmask_b32 v5, v6, v5, vcc
    v_cndmask_b32 v105, v6, v7, vcc
    buffer_load_dwordx4 v[100:103], v5, s[60:63], 0 offen
    s_waitcnt vmcnt(11)
    v_lshlrev_b32 v6, 16, v16
    v_and_b32 v7, 0xffff0000, v16
    v_add_f32 v128, v6, v7
    v_mul_f32 v136, v6, v6
    v_fmac_f32 v136, v7, v7
    v_lshlrev_b32 v8, 16, v17
    v_and_b32 v9, 0xffff0000, v17
    v_add_f32 v128, v128, v8
    v_fmac_f32 v136, v8, v8
    v_add_f32 v128, v128, v9
    v_fmac_f32 v136, v9, v9
    v_lshlrev_b32 v6, 16, v18
    v_and_b32 v7, 0xffff0000, v18
    v_add_f32 v128, v128, v6
    v_fmac_f32 v136, v6, v6
    v_add_f32 v128, v128, v7
    v_fmac_f32 v136, v7, v7
    v_lshlrev_b32 v8, 16, v19
    v_and_b32 v9, 0xffff0000, v19
    v_add_f32 v128, v128, v8
    v_fmac_f32 v136, v8, v8
    v_add_f32 v128, v128, v9
    v_fmac_f32 v136, v9, v9
    v_lshlrev_b32 v6, 16, v20
    v_and_b32 v7, 0xffff0000, v20
    v_add_f32 v129, v6, v7
    v_mul_f32 v137, v6, v6
    v_fmac_f32 v137, v7, v7
    v_lshlrev_b32 v8, 16, v21
    v_and_b32 v9, 0xffff0000, v21
    v_add_f32 v129, v129, v8
    v_fmac_f32 v137, v8, v8
    v_add_f32 v129, v129, v9
    v_fmac_f32 v137, v9, v9
    v_lshlrev_b32 v6, 16, v22
    v_and_b32 v7, 0xffff0000, v22
    v_add_f32 v129, v129, v6
    v_fmac_f32 v137, v6, v6
    v_add_f32 v129, v129, v7
    v_fmac_f32 v137, v7, v7
    v_lshlrev_b32 v8, 16, v23
    v_and_b32 v9, 0xffff0000, v23
    v_add_f32 v129, v129, v8
    v_fmac_f32 v137, v8, v8
    v_add_f32 v129, v129, v9
    v_fmac_f32 v137, v9, v9
    v_lshlrev_b32 v6, 16, v24
    v_and_b32 v7, 0xffff0000, v24
    v_add_f32 v130, v6, v7
    v_mul_f32 v138, v6, v6
    v_fmac_f32 v138, v7, v7
    v_lshlrev_b32 v8, 16, v25
    v_and_b32 v9, 0xffff0000, v25
    v_add_f32 v130, v130, v8
    v_fmac_f32 v138, v8, v8
    v_add_f32 v130, v130, v9
    v_fmac_f32 v138, v9, v9
    v_lshlrev_b32 v6, 16, v26
    v_and_b32 v7, 0xffff0000, v26
    v_add_f32 v130, v130, v6
    v_fmac_f32 v138, v6, v6
    v_add_f32 v130, v130, v7
    v_fmac_f32 v138, v7, v7
    v_lshlrev_b32 v8, 16, v27
    v_and_b32 v9, 0xffff0000, v27
    v_add_f32 v130, v130, v8
    v_fmac_f32 v138, v8, v8
    v_add_f32 v130, v130, v9
    v_fmac_f32 v138, v9, v9
    v_lshlrev_b32 v6, 16, v28
    v_and_b32 v7, 0xffff0000, v28
    v_add_f32 v131, v6, v7
    v_mul_f32 v139, v6, v6
    v_fmac_f32 v139, v7, v7
    v_lshlrev_b32 v8, 16, v29
    v_and_b32 v9, 0xffff0000, v29
    v_add_f32 v131, v131, v8
    v_fmac_f32 v139, v8, v8
    v_add_f32 v131, v131, v9
    v_fmac_f32 v139, v9, v9
    v_lshlrev_b32 v6, 16, v30
    v_and_b32 v7, 0xffff0000, v30
    v_add_f32 v131, v131, v6
    v_fmac_f32 v139, v6, v6
    v_add_f32 v131, v131, v7
    v_fmac_f32 v139, v7, v7
    v_lshlrev_b32 v8, 16, v31
    v_and_b32 v9, 0xffff0000, v31
    v_add_f32 v131, v131, v8
    v_fmac_f32 v139, v8, v8
    v_add_f32 v131, v131, v9
    v_fmac_f32 v139, v9, v9
    v_lshlrev_b32 v6, 16, v32
    v_and_b32 v7, 0xffff0000, v32
    v_add_f32 v132, v6, v7
    v_mul_f32 v140, v6, v6
    v_fmac_f32 v140, v7, v7
    v_lshlrev_b32 v8, 16, v33
    v_and_b32 v9, 0xffff0000, v33
    v_add_f32 v132, v132, v8
    v_fmac_f32 v140, v8, v8
    v_add_f32 v132, v132, v9
    v_fmac_f32 v140, v9, v9
    v_lshlrev_b32 v6, 16, v34
    v_and_b32 v7, 0xffff0000, v34
    v_add_f32 v132, v132, v6
    v_fmac_f32 v140, v6, v6
    v_add_f32 v132, v132, v7
    v_fmac_f32 v140, v7, v7
    v_lshlrev_b32 v8, 16, v35
    v_and_b32 v9, 0xffff0000, v35
    v_add_f32 v132, v132, v8
    v_fmac_f32 v140, v8, v8
    v_add_f32 v132, v132, v9
    v_fmac_f32 v140, v9, v9
    v_lshlrev_b32 v6, 16, v36
    v_and_b32 v7, 0xffff0000, v36
    v_add_f32 v133, v6, v7
    v_mul_f32 v141, v6, v6
    v_fmac_f32 v141, v7, v7
    v_lshlrev_b32 v8, 16, v37
    v_and_b32 v9, 0xffff0000, v37
    v_add_f32 v133, v133, v8
    v_fmac_f32 v141, v8, v8
    v_add_f32 v133, v133, v9
    v_fmac_f32 v141, v9, v9
    v_lshlrev_b32 v6, 16, v38
    v_and_b32 v7, 0xffff0000, v38
    v_add_f32 v133, v133, v6
    v_fmac_f32 v141, v6, v6
    v_add_f32 v133, v133, v7
    v_fmac_f32 v141, v7, v7
    v_lshlrev_b32 v8, 16, v39
    v_and_b32 v9, 0xffff0000, v39
    v_add_f32 v133, v133, v8
    v_fmac_f32 v141, v8, v8
    v_add_f32 v133, v133, v9
    v_fmac_f32 v141, v9, v9
    v_lshlrev_b32 v6, 16, v40
    v_and_b32 v7, 0xffff0000, v40
    v_add_f32 v134, v6, v7
    v_mul_f32 v142, v6, v6
    v_fmac_f32 v142, v7, v7
    v_lshlrev_b32 v8, 16, v41
    v_and_b32 v9, 0xffff0000, v41
    v_add_f32 v134, v134, v8
    v_fmac_f32 v142, v8, v8
    v_add_f32 v134, v134, v9
    v_fmac_f32 v142, v9, v9
    v_lshlrev_b32 v6, 16, v42
    v_and_b32 v7, 0xffff0000, v42
    v_add_f32 v134, v134, v6
    v_fmac_f32 v142, v6, v6
    v_add_f32 v134, v134, v7
    v_fmac_f32 v142, v7, v7
    v_lshlrev_b32 v8, 16, v43
    v_and_b32 v9, 0xffff0000, v43
    v_add_f32 v134, v134, v8
    v_fmac_f32 v142, v8, v8
    v_add_f32 v134, v134, v9
    v_fmac_f32 v142, v9, v9
    v_lshlrev_b32 v6, 16, v44
    v_and_b32 v7, 0xffff0000, v44
    v_add_f32 v135, v6, v7
    v_mul_f32 v143, v6, v6
    v_fmac_f32 v143, v7, v7
    v_lshlrev_b32 v8, 16, v45
    v_and_b32 v9, 0xffff0000, v45
    v_add_f32 v135, v135, v8
    v_fmac_f32 v143, v8, v8
    v_add_f32 v135, v135, v9
    v_fmac_f32 v143, v9, v9
    v_lshlrev_b32 v6, 16, v46
    v_and_b32 v7, 0xffff0000, v46
    v_add_f32 v135, v135, v6
    v_fmac_f32 v143, v6, v6
    v_add_f32 v135, v135, v7
    v_fmac_f32 v143, v7, v7
    v_lshlrev_b32 v8, 16, v47
    v_and_b32 v9, 0xffff0000, v47
    v_add_f32 v135, v135, v8
    v_fmac_f32 v143, v8, v8
    v_add_f32 v135, v135, v9
    v_fmac_f32 v143, v9, v9
    v_permlane32_swap_b32 v128, v136
    v_permlane32_swap_b32 v129, v137
    v_permlane32_swap_b32 v130, v138
    v_permlane32_swap_b32 v131, v139
    v_permlane32_swap_b32 v132, v140
    v_permlane32_swap_b32 v133, v141
    v_permlane32_swap_b32 v134, v142
    v_permlane32_swap_b32 v135, v143
    v_add_f32 v128, v128, v136
    v_add_f32 v129, v129, v137
    v_add_f32 v130, v130, v138
    v_add_f32 v131, v131, v139
    v_add_f32 v132, v132, v140
    v_add_f32 v133, v133, v141
    v_add_f32 v134, v134, v142
    v_add_f32 v135, v135, v143
    v_permlane16_swap_b32 v128, v132
    v_permlane16_swap_b32 v129, v133
    v_permlane16_swap_b32 v130, v134
    v_permlane16_swap_b32 v131, v135
    v_add_f32 v144, v128, v132
    v_add_f32 v145, v129, v133
    v_add_f32 v146, v130, v134
    v_add_f32 v147, v131, v135
    v_add_f32_dpp v144, v144, v144 quad_perm:[1,0,3,2] row_mask:0xf bank_mask:0xf
    v_add_f32_dpp v145, v145, v145 quad_perm:[1,0,3,2] row_mask:0xf bank_mask:0xf
    v_add_f32_dpp v146, v146, v146 quad_perm:[1,0,3,2] row_mask:0xf bank_mask:0xf
    v_add_f32_dpp v147, v147, v147 quad_perm:[1,0,3,2] row_mask:0xf bank_mask:0xf
    v_add_f32_dpp v144, v144, v144 quad_perm:[2,3,0,1] row_mask:0xf bank_mask:0xf
    v_add_f32_dpp v145, v145, v145 quad_perm:[2,3,0,1] row_mask:0xf bank_mask:0xf
    v_add_f32_dpp v146, v146, v146 quad_perm:[2,3,0,1] row_mask:0xf bank_mask:0xf
    v_add_f32_dpp v147, v147, v147 quad_perm:[2,3,0,1] row_mask:0xf bank_mask:0xf
    v_add_f32_dpp v144, v144, v144 row_half_mirror row_mask:0xf bank_mask:0xf
    v_add_f32_dpp v145, v145, v145 row_half_mirror row_mask:0xf bank_mask:0xf
    v_add_f32_dpp v146, v146, v146 row_half_mirror row_mask:0xf bank_mask:0xf
    v_add_f32_dpp v147, v147, v147 row_half_mirror row_mask:0xf bank_mask:0xf
    v_add_f32_dpp v144, v144, v144 row_mirror row_mask:0xf bank_mask:0xf
    v_add_f32_dpp v145, v145, v145 row_mirror row_mask:0xf bank_mask:0xf
    v_add_f32_dpp v146, v146, v146 row_mirror row_mask:0xf bank_mask:0xf
    v_add_f32_dpp v147, v147, v147 row_mirror row_mask:0xf bank_mask:0xf
    v_mov_b32 v148, v144
    v_mov_b32 v149, v145
    v_mov_b32 v150, v146
    v_mov_b32 v151, v147
    v_permlane32_swap_b32 v144, v148
    v_permlane32_swap_b32 v145, v149
    v_permlane32_swap_b32 v146, v150
    v_permlane32_swap_b32 v147, v151
    v_mul_f32 v144, 0x3b000000, v144
    v_mul_f32 v148, 0x3b000000, v148
    v_mul_f32 v145, 0x3b000000, v145
    v_mul_f32 v149, 0x3b000000, v149
    v_mul_f32 v146, 0x3b000000, v146
    v_mul_f32 v150, 0x3b000000, v150
    v_mul_f32 v147, 0x3b000000, v147
    v_mul_f32 v151, 0x3b000000, v151
    v_fma_f32 v148, -v144, v144, v148
    v_fma_f32 v149, -v145, v145, v149
    v_fma_f32 v150, -v146, v146, v150
    v_fma_f32 v151, -v147, v147, v151
    v_max_f32 v148, 0, v148
    v_max_f32 v149, 0, v149
    v_max_f32 v150, 0, v150
    v_max_f32 v151, 0, v151
    v_add_f32 v148, 0x3727c5ac, v148
    v_add_f32 v149, 0x3727c5ac, v149
    v_add_f32 v150, 0x3727c5ac, v150
    v_add_f32 v151, 0x3727c5ac, v151
    v_rsq_f32 v148, v148
    v_rsq_f32 v149, v149
    v_rsq_f32 v150, v150
    v_rsq_f32 v151, v151
    v_mul_f32 v144, v144, v148
    v_mul_f32 v145, v145, v149
    v_mul_f32 v146, v146, v150
    v_mul_f32 v147, v147, v151
    v_sub_f32 v144, 0, v144
    v_sub_f32 v145, 0, v145
    v_sub_f32 v146, 0, v146
    v_sub_f32 v147, 0, v147
    v_readlane_b32 s68, v148, 0
    v_readlane_b32 s69, v144, 0
    v_readlane_b32 s70, v149, 0
    v_readlane_b32 s71, v145, 0
    v_readlane_b32 s72, v150, 0
    v_readlane_b32 s73, v146, 0
    v_readlane_b32 s74, v151, 0
    v_readlane_b32 s75, v147, 0
    v_readlane_b32 s76, v148, 16
    v_readlane_b32 s77, v144, 16
    v_readlane_b32 s78, v149, 16
    v_readlane_b32 s79, v145, 16
    v_readlane_b32 s80, v150, 16
    v_readlane_b32 s81, v146, 16
    v_readlane_b32 s82, v151, 16
    v_readlane_b32 s83, v147, 16
    v_mov_b32 v5, s69
    v_lshlrev_b32 v160, 16, v16
    v_and_b32 v161, 0xffff0000, v16
    v_fma_f32 v160, v160, s68, v5
    v_fma_f32 v161, v161, s68, v5
    v_lshlrev_b32 v162, 16, v17
    v_and_b32 v163, 0xffff0000, v17
    v_fma_f32 v162, v162, s68, v5
    v_fma_f32 v163, v163, s68, v5
    v_lshlrev_b32 v164, 16, v18
    v_and_b32 v165, 0xffff0000, v18
    v_fma_f32 v164, v164, s68, v5
    v_fma_f32 v165, v165, s68, v5
    v_lshlrev_b32 v166, 16, v19
    v_and_b32 v167, 0xffff0000, v19
    v_fma_f32 v166, v166, s68, v5
    v_fma_f32 v167, v167, s68, v5
    v_mov_b32 v5, s71
    v_lshlrev_b32 v168, 16, v20
    v_and_b32 v169, 0xffff0000, v20
    v_fma_f32 v168, v168, s70, v5
    v_fma_f32 v169, v169, s70, v5
    v_lshlrev_b32 v170, 16, v21
    v_and_b32 v171, 0xffff0000, v21
    v_fma_f32 v170, v170, s70, v5
    v_fma_f32 v171, v171, s70, v5
    v_lshlrev_b32 v172, 16, v22
    v_and_b32 v173, 0xffff0000, v22
    v_fma_f32 v172, v172, s70, v5
    v_fma_f32 v173, v173, s70, v5
    v_lshlrev_b32 v174, 16, v23
    v_and_b32 v175, 0xffff0000, v23
    v_fma_f32 v174, v174, s70, v5
    v_fma_f32 v175, v175, s70, v5
    v_mov_b32 v5, s73
    v_lshlrev_b32 v176, 16, v24
    v_and_b32 v177, 0xffff0000, v24
    v_fma_f32 v176, v176, s72, v5
    v_fma_f32 v177, v177, s72, v5
    v_lshlrev_b32 v178, 16, v25
    v_and_b32 v179, 0xffff0000, v25
    v_fma_f32 v178, v178, s72, v5
    v_fma_f32 v179, v179, s72, v5
    v_lshlrev_b32 v180, 16, v26
    v_and_b32 v181, 0xffff0000, v26
    v_fma_f32 v180, v180, s72, v5
    v_fma_f32 v181, v181, s72, v5
    v_lshlrev_b32 v182, 16, v27
    v_and_b32 v183, 0xffff0000, v27
    v_fma_f32 v182, v182, s72, v5
    v_fma_f32 v183, v183, s72, v5
    v_mov_b32 v5, s75
    v_lshlrev_b32 v184, 16, v28
    v_and_b32 v185, 0xffff0000, v28
    v_fma_f32 v184, v184, s74, v5
    v_fma_f32 v185, v185, s74, v5
    v_lshlrev_b32 v186, 16, v29
    v_and_b32 v187, 0xffff0000, v29
    v_fma_f32 v186, v186, s74, v5
    v_fma_f32 v187, v187, s74, v5
    v_lshlrev_b32 v188, 16, v30
    v_and_b32 v189, 0xffff0000, v30
    v_fma_f32 v188, v188, s74, v5
    v_fma_f32 v189, v189, s74, v5
    v_lshlrev_b32 v190, 16, v31
    v_and_b32 v191, 0xffff0000, v31
    v_fma_f32 v190, v190, s74, v5
    v_fma_f32 v191, v191, s74, v5
    v_mov_b32 v5, s77
    v_lshlrev_b32 v192, 16, v32
    v_and_b32 v193, 0xffff0000, v32
    v_fma_f32 v192, v192, s76, v5
    v_fma_f32 v193, v193, s76, v5
    v_lshlrev_b32 v194, 16, v33
    v_and_b32 v195, 0xffff0000, v33
    v_fma_f32 v194, v194, s76, v5
    v_fma_f32 v195, v195, s76, v5
    v_lshlrev_b32 v196, 16, v34
    v_and_b32 v197, 0xffff0000, v34
    v_fma_f32 v196, v196, s76, v5
    v_fma_f32 v197, v197, s76, v5
    v_lshlrev_b32 v198, 16, v35
    v_and_b32 v199, 0xffff0000, v35
    v_fma_f32 v198, v198, s76, v5
    v_fma_f32 v199, v199, s76, v5
    v_mov_b32 v5, s79
    v_lshlrev_b32 v200, 16, v36
    v_and_b32 v201, 0xffff0000, v36
    v_fma_f32 v200, v200, s78, v5
    v_fma_f32 v201, v201, s78, v5
    v_lshlrev_b32 v202, 16, v37
    v_and_b32 v203, 0xffff0000, v37
    v_fma_f32 v202, v202, s78, v5
    v_fma_f32 v203, v203, s78, v5
    v_lshlrev_b32 v204, 16, v38
    v_and_b32 v205, 0xffff0000, v38
    v_fma_f32 v204, v204, s78, v5
    v_fma_f32 v205, v205, s78, v5
    v_lshlrev_b32 v206, 16, v39
    v_and_b32 v207, 0xffff0000, v39
    v_fma_f32 v206, v206, s78, v5
    v_fma_f32 v207, v207, s78, v5
    v_mov_b32 v5, s81
    v_lshlrev_b32 v208, 16, v40
    v_and_b32 v209, 0xffff0000, v40
    v_fma_f32 v208, v208, s80, v5
    v_fma_f32 v209, v209, s80, v5
    v_lshlrev_b32 v210, 16, v41
    v_and_b32 v211, 0xffff0000, v41
    v_fma_f32 v210, v210, s80, v5
    v_fma_f32 v211, v211, s80, v5
    v_lshlrev_b32 v212, 16, v42
    v_and_b32 v213, 0xffff0000, v42
    v_fma_f32 v212, v212, s80, v5
    v_fma_f32 v213, v213, s80, v5
    v_lshlrev_b32 v214, 16, v43
    v_and_b32 v215, 0xffff0000, v43
    v_fma_f32 v214, v214, s80, v5
    v_fma_f32 v215, v215, s80, v5
    v_mov_b32 v5, s83
    v_lshlrev_b32 v216, 16, v44
    v_and_b32 v217, 0xffff0000, v44
    v_fma_f32 v216, v216, s82, v5
    v_fma_f32 v217, v217, s82, v5
    v_lshlrev_b32 v218, 16, v45
    v_and_b32 v219, 0xffff0000, v45
    v_fma_f32 v218, v218, s82, v5
    v_fma_f32 v219, v219, s82, v5
    v_lshlrev_b32 v220, 16, v46
    v_and_b32 v221, 0xffff0000, v46
    v_fma_f32 v220, v220, s82, v5
    v_fma_f32 v221, v221, s82, v5
    v_lshlrev_b32 v222, 16, v47
    v_and_b32 v223, 0xffff0000, v47
    v_fma_f32 v222, v222, s82, v5
    v_fma_f32 v223, v223, s82, v5
    v_lshrrev_b32 v4, 2, v1
    v_lshlrev_b32 v4, 10, v4
    v_and_b32 v5, 3, v1
    v_lshl_add_u32 v4, v5, 8, v4
    v_and_b32 v5, 15, v1
    v_lshl_add_u32 v4, v5, 4, v4
    s_lshr_b32 s5, s3, 1
    s_lshl_b32 s5, s5, 14
    s_and_b32 s6, s3, 1
    s_lshl_b32 s6, s6, 7
    v_xor_b32 v4, s6, v4
    v_add_u32 v13, s5, v4
    s_add_u32 s64, s40, 0x8000
    s_addc_u32 s65, s41, 0
    s_mov_b32 s66, 0x2000
    s_mov_b32 s67, 0x00020000
    s_cmp_eq_u32 s3, 0
    s_cbranch_scc0 md_17005
    v_lshlrev_b32 v6, 6, v1
    s_mov_b32 s6, 0
    s_movk_i32 s7, 0x1000
mp_17004:
    buffer_load_dword v126, off, s[48:51], 0 sc1
    buffer_load_dwordx4 v[128:131], v6, s[64:67], 0 offen offset:0 sc1
    buffer_load_dwordx4 v[132:135], v6, s[64:67], 0 offen offset:16 sc1
    buffer_load_dwordx4 v[136:139], v6, s[64:67], 0 offen offset:32 sc1
    buffer_load_dwordx4 v[140:143], v6, s[64:67], 0 offen offset:48 sc1
    buffer_load_dwordx4 v[144:147], v6, s[64:67], s7 offen offset:0 sc1
    buffer_load_dwordx4 v[148:151], v6, s[64:67], s7 offen offset:16 sc1
    buffer_load_dwordx4 v[152:155], v6, s[64:67], s7 offen offset:32 sc1
    buffer_load_dwordx4 v[156:159], v6, s[64:67], s7 offen offset:48 sc1
    s_waitcnt vmcnt(0)
    v_xor_b32 v129, v126, v129
    v_xor_b32 v131, v126, v131
    v_xor_b32 v133, v126, v133
    v_xor_b32 v135, v126, v135
    v_xor_b32 v137, v126, v137
    v_xor_b32 v139, v126, v139
    v_xor_b32 v141, v126, v141
    v_xor_b32 v143, v126, v143
    v_xor_b32 v145, v126, v145
    v_xor_b32 v147, v126, v147
    v_xor_b32 v149, v126, v149
    v_xor_b32 v151, v126, v151
    v_xor_b32 v153, v126, v153
    v_xor_b32 v155, v126, v155
    v_xor_b32 v157, v126, v157
    v_xor_b32 v159, v126, v159
    v_or3_b32 v127, v129, v131, v133
    v_or3_b32 v127, v127, v135, v137
    v_or3_b32 v127, v127, v139, v141
    v_or3_b32 v127, v127, v143, v145
    v_or3_b32 v127, v127, v147, v149
    v_or3_b32 v127, v127, v151, v153
    v_or3_b32 v127, v127, v155, v157
    v_or_b32 v127, v127, v159
    v_cmp_eq_u32 vcc, 0, v127
    v_cmp_ne_u32 s[12:13], 0, v126
    s_add_u32 s6, s6, 1
    s_and_b64 vcc, vcc, s[12:13]
    s_cmp_gt_u32 s6, 0x8000
    s_cbranch_scc1 mp_17004_x
    s_cmp_eq_u64 vcc, -1
    s_cbranch_scc1 mp_17004_x
    s_sleep 28
    s_branch mp_17004
mp_17004_x:
    v_mov_b32 v48, v144
    v_mov_b32 v56, v128
    v_mov_b32 v49, v146
    v_mov_b32 v57, v130
    v_mov_b32 v50, v148
    v_mov_b32 v58, v132
    v_mov_b32 v51, v150
    v_mov_b32 v59, v134
    v_mov_b32 v52, v152
    v_mov_b32 v60, v136
    v_mov_b32 v53, v154
    v_mov_b32 v61, v138
    v_mov_b32 v54, v156
    v_mov_b32 v62, v140
    v_mov_b32 v55, v158
    v_mov_b32 v63, v142
    ds_write_b128 v6, v[48:51] offset:0
    ds_write_b128 v6, v[52:55] offset:16
    ds_write_b128 v6, v[56:59] offset:32
    ds_write_b128 v6, v[60:63] offset:48
    s_waitcnt lgkmcnt(0)
md_17005:
    s_barrier
    v_lshlrev_b32 v6, 6, v1
    ds_read_b128 v[48:51], v6 offset:0
    ds_read_b128 v[52:55], v6 offset:16
    ds_read_b128 v[56:59], v6 offset:32
    ds_read_b128 v[60:63], v6 offset:48
    s_waitcnt lgkmcnt(0)
    s_barrier
    s_waitcnt vmcnt(0)
    v_fma_f32 v160, v160, v48, v56
    v_fma_f32 v161, v161, v49, v57
    v_fma_f32 v162, v162, v50, v58
    v_fma_f32 v163, v163, v51, v59
    v_fma_f32 v164, v164, v52, v60
    v_fma_f32 v165, v165, v53, v61
    v_fma_f32 v166, v166, v54, v62
    v_fma_f32 v167, v167, v55, v63
    v_cvt_pk_bf16_f32 v16, v160, v161
    v_cvt_pk_bf16_f32 v17, v162, v163
    v_cvt_pk_bf16_f32 v18, v164, v165
    v_cvt_pk_bf16_f32 v19, v166, v167
    v_xor_b32 v12, 0, v13
    ds_write_b128 v12, v[16:19]
    v_fma_f32 v168, v168, v48, v56
    v_fma_f32 v169, v169, v49, v57
    v_fma_f32 v170, v170, v50, v58
    v_fma_f32 v171, v171, v51, v59
    v_fma_f32 v172, v172, v52, v60
    v_fma_f32 v173, v173, v53, v61
    v_fma_f32 v174, v174, v54, v62
    v_fma_f32 v175, v175, v55, v63
    v_cvt_pk_bf16_f32 v20, v168, v169
    v_cvt_pk_bf16_f32 v21, v170, v171
    v_cvt_pk_bf16_f32 v22, v172, v173
    v_cvt_pk_bf16_f32 v23, v174, v175
    v_xor_b32 v12, 16, v13
    ds_write_b128 v12, v[20:23]
    v_fma_f32 v176, v176, v48, v56
    v_fma_f32 v177, v177, v49, v57
    v_fma_f32 v178, v178, v50, v58
    v_fma_f32 v179, v179, v51, v59
    v_fma_f32 v180, v180, v52, v60
    v_fma_f32 v181, v181, v53, v61
    v_fma_f32 v182, v182, v54, v62
    v_fma_f32 v183, v183, v55, v63
    v_cvt_pk_bf16_f32 v24, v176, v177
    v_cvt_pk_bf16_f32 v25, v178, v179
    v_cvt_pk_bf16_f32 v26, v180, v181
    v_cvt_pk_bf16_f32 v27, v182, v183
    v_xor_b32 v12, 32, v13
    ds_write_b128 v12, v[24:27]
    v_fma_f32 v184, v184, v48, v56
    v_fma_f32 v185, v185, v49, v57
    v_fma_f32 v186, v186, v50, v58
    v_fma_f32 v187, v187, v51, v59
    v_fma_f32 v188, v188, v52, v60
    v_fma_f32 v189, v189, v53, v61
    v_fma_f32 v190, v190, v54, v62
    v_fma_f32 v191, v191, v55, v63
    v_cvt_pk_bf16_f32 v28, v184, v185
    v_cvt_pk_bf16_f32 v29, v186, v187
    v_cvt_pk_bf16_f32 v30, v188, v189
    v_cvt_pk_bf16_f32 v31, v190, v191
    v_xor_b32 v12, 48, v13
    ds_write_b128 v12, v[28:31]
    v_fma_f32 v192, v192, v48, v56
    v_fma_f32 v193, v193, v49, v57
    v_fma_f32 v194, v194, v50, v58
    v_fma_f32 v195, v195, v51, v59
    v_fma_f32 v196, v196, v52, v60
    v_fma_f32 v197, v197, v53, v61
    v_fma_f32 v198, v198, v54, v62
    v_fma_f32 v199, v199, v55, v63
    v_cvt_pk_bf16_f32 v32, v192, v193
    v_cvt_pk_bf16_f32 v33, v194, v195
    v_cvt_pk_bf16_f32 v34, v196, v197
    v_cvt_pk_bf16_f32 v35, v198, v199
    v_xor_b32 v12, 64, v13
    ds_write_b128 v12, v[32:35]
    v_fma_f32 v200, v200, v48, v56
    v_fma_f32 v201, v201, v49, v57
    v_fma_f32 v202, v202, v50, v58
    v_fma_f32 v203, v203, v51, v59
    v_fma_f32 v204, v204, v52, v60
    v_fma_f32 v205, v205, v53, v61
    v_fma_f32 v206, v206, v54, v62
    v_fma_f32 v207, v207, v55, v63
    v_cvt_pk_bf16_f32 v36, v200, v201
    v_cvt_pk_bf16_f32 v37, v202, v203
    v_cvt_pk_bf16_f32 v38, v204, v205
    v_cvt_pk_bf16_f32 v39, v206, v207
    v_xor_b32 v12, 80, v13
    ds_write_b128 v12, v[36:39]
    v_fma_f32 v208, v208, v48, v56
    v_fma_f32 v209, v209, v49, v57
    v_fma_f32 v210, v210, v50, v58
    v_fma_f32 v211, v211, v51, v59
    v_fma_f32 v212, v212, v52, v60
    v_fma_f32 v213, v213, v53, v61
    v_fma_f32 v214, v214, v54, v62
    v_fma_f32 v215, v215, v55, v63
    v_cvt_pk_bf16_f32 v40, v208, v209
    v_cvt_pk_bf16_f32 v41, v210, v211
    v_cvt_pk_bf16_f32 v42, v212, v213
    v_cvt_pk_bf16_f32 v43, v214, v215
    v_xor_b32 v12, 96, v13
    ds_write_b128 v12, v[40:43]
    v_fma_f32 v216, v216, v48, v56
    v_fma_f32 v217, v217, v49, v57
    v_fma_f32 v218, v218, v50, v58
    v_fma_f32 v219, v219, v51, v59
    v_fma_f32 v220, v220, v52, v60
    v_fma_f32 v221, v221, v53, v61
    v_fma_f32 v222, v222, v54, v62
    v_fma_f32 v223, v223, v55, v63
    v_cvt_pk_bf16_f32 v44, v216, v217
    v_cvt_pk_bf16_f32 v45, v218, v219
    v_cvt_pk_bf16_f32 v46, v220, v221
    v_cvt_pk_bf16_f32 v47, v222, v223
    v_xor_b32 v12, 112, v13
    ds_write_b128 v12, v[44:47]
    s_and_b32 s5, s3, 1
    s_lshl_b32 s5, s5, 15
    v_lshrrev_b32 v5, 4, v1
    v_and_b32 v6, 15, v1
    v_xor_b32 v6, v5, v6
    v_lshlrev_b32 v6, 4, v6
    v_lshl_add_u32 v6, v5, 8, v6
    v_xor_b32 v65, 0, v6
    v_add_u32 v65, s5, v65
    v_xor_b32 v66, 64, v6
    v_add_u32 v66, s5, v66
    v_xor_b32 v67, 128, v6
    v_add_u32 v67, s5, v67
    v_xor_b32 v68, 192, v6
    v_add_u32 v68, s5, v68
    v_lshrrev_b32 v5, 4, v1
    v_bfe_u32 v6, v1, 2, 2
    v_lshl_add_u32 v7, v5, 3, v6
    v_lshlrev_b32 v7, 7, v7
    v_bfe_u32 v6, v1, 3, 1
    v_and_b32 v5, 1, v5
    v_lshl_or_b32 v5, v5, 1, v6
    s_lshr_b32 s5, s3, 1
    v_xor_b32 v5, s5, v5
    v_lshl_add_u32 v7, v5, 5, v7
    v_and_b32 v5, 3, v1
    v_lshl_add_u32 v7, v5, 3, v7
    v_add_u32 v69, 65536, v7
    v_add_u32 v70, 114688, v7
    v_mov_b32 v72, 0
    v_mov_b32 v73, 0
    v_mov_b32 v74, 0
    v_mov_b32 v75, 0
    v_mov_b32 v76, 0
    v_mov_b32 v77, 0
    v_mov_b32 v78, 0
    v_mov_b32 v79, 0
    v_mov_b32 v80, 0
    v_mov_b32 v81, 0
    v_mov_b32 v82, 0
    v_mov_b32 v83, 0
    v_mov_b32 v84, 0
    v_mov_b32 v85, 0
    v_mov_b32 v86, 0
    v_mov_b32 v87, 0
    v_mov_b32 v88, 0
    v_mov_b32 v89, 0
    v_mov_b32 v90, 0
    v_mov_b32 v91, 0
    v_mov_b32 v92, 0
    v_mov_b32 v93, 0
    v_mov_b32 v94, 0
    v_mov_b32 v95, 0
    s_waitcnt lgkmcnt(0)
    s_waitcnt vmcnt(0)
    s_barrier
    ds_read_b128 v[128:131], v65 offset:0
    ds_read_b128 v[132:135], v65 offset:16384
    ds_read_b64_tr_b16 v[136:137], v69 offset:0
    ds_read_b64_tr_b16 v[138:139], v69 offset:512
    ds_read_b64_tr_b16 v[140:141], v69 offset:8192
    ds_read_b64_tr_b16 v[142:143], v69 offset:8704
    ds_read_b64_tr_b16 v[144:145], v69 offset:16384
    ds_read_b64_tr_b16 v[146:147], v69 offset:16896
    ds_read_b128 v[148:151], v66 offset:1024
    ds_read_b128 v[152:155], v66 offset:17408
    ds_read_b64_tr_b16 v[156:157], v69 offset:4096
    ds_read_b64_tr_b16 v[158:159], v69 offset:4608
    ds_read_b64_tr_b16 v[160:161], v69 offset:12288
    ds_read_b64_tr_b16 v[162:163], v69 offset:12800
    ds_read_b64_tr_b16 v[164:165], v69 offset:20480
    ds_read_b64_tr_b16 v[166:167], v69 offset:20992
    s_waitcnt lgkmcnt(8)
    v_mfma_f32_16x16x32_bf16 v[72:75], v[136:139], v[128:131], v[72:75]
    s_waitcnt vmcnt(0)
    s_barrier
    ds_read_b128 v[168:171], v67 offset:2048
    ds_read_b128 v[172:175], v67 offset:18432
    v_mfma_f32_16x16x32_bf16 v[76:79], v[136:139], v[132:135], v[76:79]
    ds_read_b64_tr_b16 v[176:177], v69 offset:24576
    ds_read_b64_tr_b16 v[178:179], v69 offset:25088
    v_mfma_f32_16x16x32_bf16 v[80:83], v[140:143], v[128:131], v[80:83]
    ds_read_b64_tr_b16 v[180:181], v69 offset:32768
    ds_read_b64_tr_b16 v[182:183], v69 offset:33280
    v_mfma_f32_16x16x32_bf16 v[84:87], v[140:143], v[132:135], v[84:87]
    ds_read_b64_tr_b16 v[184:185], v69 offset:40960
    ds_read_b64_tr_b16 v[186:187], v69 offset:41472
    v_mfma_f32_16x16x32_bf16 v[88:91], v[128:131], v[144:147], v[88:91]
    s_add_u32 m0, s11, 73728
    s_add_u32 s5, s14, 589824
    buffer_load_dwordx4 v64, s[56:59], s5 offen lds
    v_mfma_f32_16x16x32_bf16 v[92:95], v[132:135], v[144:147], v[92:95]
    s_add_u32 m0, s11, 81920
    s_add_u32 s5, s15, 590848
    buffer_load_dwordx4 v64, s[56:59], s5 offen lds
    s_add_u32 m0, s11, 90112
    s_add_u32 s5, s42, 591872
    buffer_load_dwordx4 v64, s[56:59], s5 offen lds
    s_waitcnt lgkmcnt(8)
    v_mfma_f32_16x16x32_bf16 v[72:75], v[156:159], v[148:151], v[72:75]
    ds_read_b128 v[128:131], v68 offset:3072
    ds_read_b128 v[132:135], v68 offset:19456
    v_mfma_f32_16x16x32_bf16 v[76:79], v[156:159], v[152:155], v[76:79]
    ds_read_b64_tr_b16 v[136:137], v69 offset:28672
    ds_read_b64_tr_b16 v[138:139], v69 offset:29184
    v_mfma_f32_16x16x32_bf16 v[80:83], v[160:163], v[148:151], v[80:83]
    ds_read_b64_tr_b16 v[140:141], v69 offset:36864
    ds_read_b64_tr_b16 v[142:143], v69 offset:37376
    v_mfma_f32_16x16x32_bf16 v[84:87], v[160:163], v[152:155], v[84:87]
    ds_read_b64_tr_b16 v[144:145], v69 offset:45056
    ds_read_b64_tr_b16 v[146:147], v69 offset:45568
    v_mfma_f32_16x16x32_bf16 v[88:91], v[148:151], v[164:167], v[88:91]
    v_mfma_f32_16x16x32_bf16 v[92:95], v[152:155], v[164:167], v[92:95]
    s_waitcnt lgkmcnt(8)
    v_mfma_f32_16x16x32_bf16 v[72:75], v[176:179], v[168:171], v[72:75]
    s_waitcnt vmcnt(3)
    s_barrier
    ds_read_b128 v[148:151], v65 offset:4096
    ds_read_b128 v[152:155], v65 offset:20480
    v_mfma_f32_16x16x32_bf16 v[76:79], v[176:179], v[172:175], v[76:79]
    ds_read_b64_tr_b16 v[156:157], v70 offset:0
    ds_read_b64_tr_b16 v[158:159], v70 offset:512
    v_mfma_f32_16x16x32_bf16 v[80:83], v[180:183], v[168:171], v[80:83]
    ds_read_b64_tr_b16 v[160:161], v70 offset:8192
    ds_read_b64_tr_b16 v[162:163], v70 offset:8704
    v_mfma_f32_16x16x32_bf16 v[84:87], v[180:183], v[172:175], v[84:87]
    ds_read_b64_tr_b16 v[164:165], v70 offset:16384
    ds_read_b64_tr_b16 v[166:167], v70 offset:16896
    v_mfma_f32_16x16x32_bf16 v[88:91], v[168:171], v[184:187], v[88:91]
    s_add_u32 m0, s11, 0
    s_add_u32 s5, s14, 786432
    buffer_load_dwordx4 v64, s[56:59], s5 offen lds
    v_mfma_f32_16x16x32_bf16 v[92:95], v[172:175], v[184:187], v[92:95]
    s_add_u32 m0, s11, 8192
    s_add_u32 s5, s15, 787456
    buffer_load_dwordx4 v64, s[56:59], s5 offen lds
    s_add_u32 m0, s11, 16384
    s_add_u32 s5, s42, 788480
    buffer_load_dwordx4 v64, s[56:59], s5 offen lds
    s_waitcnt lgkmcnt(8)
    v_mfma_f32_16x16x32_bf16 v[72:75], v[136:139], v[128:131], v[72:75]
    ds_read_b128 v[168:171], v66 offset:5120
    ds_read_b128 v[172:175], v66 offset:21504
    v_mfma_f32_16x16x32_bf16 v[76:79], v[136:139], v[132:135], v[76:79]
    ds_read_b64_tr_b16 v[176:177], v70 offset:4096
    ds_read_b64_tr_b16 v[178:179], v70 offset:4608
    v_mfma_f32_16x16x32_bf16 v[80:83], v[140:143], v[128:131], v[80:83]
    ds_read_b64_tr_b16 v[180:181], v70 offset:12288
    ds_read_b64_tr_b16 v[182:183], v70 offset:12800
    v_mfma_f32_16x16x32_bf16 v[84:87], v[140:143], v[132:135], v[84:87]
    ds_read_b64_tr_b16 v[184:185], v70 offset:20480
    ds_read_b64_tr_b16 v[186:187], v70 offset:20992
    v_mfma_f32_16x16x32_bf16 v[88:91], v[128:131], v[144:147], v[88:91]
    v_mfma_f32_16x16x32_bf16 v[92:95], v[132:135], v[144:147], v[92:95]
    s_waitcnt lgkmcnt(8)
    v_mfma_f32_16x16x32_bf16 v[72:75], v[156:159], v[148:151], v[72:75]
    s_waitcnt vmcnt(3)
    s_barrier
    ds_read_b128 v[128:131], v67 offset:6144
    ds_read_b128 v[132:135], v67 offset:22528
    v_mfma_f32_16x16x32_bf16 v[76:79], v[156:159], v[152:155], v[76:79]
    ds_read_b64_tr_b16 v[136:137], v70 offset:24576
    ds_read_b64_tr_b16 v[138:139], v70 offset:25088
    v_mfma_f32_16x16x32_bf16 v[80:83], v[160:163], v[148:151], v[80:83]
    ds_read_b64_tr_b16 v[140:141], v70 offset:32768
    ds_read_b64_tr_b16 v[142:143], v70 offset:33280
    v_mfma_f32_16x16x32_bf16 v[84:87], v[160:163], v[152:155], v[84:87]
    ds_read_b64_tr_b16 v[144:145], v70 offset:40960
    ds_read_b64_tr_b16 v[146:147], v70 offset:41472
    v_mfma_f32_16x16x32_bf16 v[88:91], v[148:151], v[164:167], v[88:91]
    s_add_u32 m0, s11, 24576
    s_add_u32 s5, s14, 983040
    buffer_load_dwordx4 v64, s[56:59], s5 offen lds
    v_mfma_f32_16x16x32_bf16 v[92:95], v[152:155], v[164:167], v[92:95]
    s_add_u32 m0, s11, 32768
    s_add_u32 s5, s15, 984064
    buffer_load_dwordx4 v64, s[56:59], s5 offen lds
    s_add_u32 m0, s11, 40960
    s_add_u32 s5, s42, 985088
    buffer_load_dwordx4 v64, s[56:59], s5 offen lds
    s_waitcnt lgkmcnt(8)
    v_mfma_f32_16x16x32_bf16 v[72:75], v[176:179], v[168:171], v[72:75]
    ds_read_b128 v[148:151], v68 offset:7168
    ds_read_b128 v[152:155], v68 offset:23552
    v_mfma_f32_16x16x32_bf16 v[76:79], v[176:179], v[172:175], v[76:79]
    ds_read_b64_tr_b16 v[156:157], v70 offset:28672
    ds_read_b64_tr_b16 v[158:159], v70 offset:29184
    v_mfma_f32_16x16x32_bf16 v[80:83], v[180:183], v[168:171], v[80:83]
    ds_read_b64_tr_b16 v[160:161], v70 offset:36864
    ds_read_b64_tr_b16 v[162:163], v70 offset:37376
    v_mfma_f32_16x16x32_bf16 v[84:87], v[180:183], v[172:175], v[84:87]
    ds_read_b64_tr_b16 v[164:165], v70 offset:45056
    ds_read_b64_tr_b16 v[166:167], v70 offset:45568
    v_mfma_f32_16x16x32_bf16 v[88:91], v[168:171], v[184:187], v[88:91]
    v_mfma_f32_16x16x32_bf16 v[92:95], v[172:175], v[184:187], v[92:95]
    s_waitcnt lgkmcnt(8)
    v_mfma_f32_16x16x32_bf16 v[72:75], v[136:139], v[128:131], v[72:75]
    s_waitcnt vmcnt(3)
    s_barrier
    ds_read_b128 v[168:171], v65 offset:8192
    ds_read_b128 v[172:175], v65 offset:24576
    v_mfma_f32_16x16x32_bf16 v[76:79], v[136:139], v[132:135], v[76:79]
    ds_read_b64_tr_b16 v[176:177], v69 offset:0
    ds_read_b64_tr_b16 v[178:179], v69 offset:512
    v_mfma_f32_16x16x32_bf16 v[80:83], v[140:143], v[128:131], v[80:83]
    ds_read_b64_tr_b16 v[180:181], v69 offset:8192
    ds_read_b64_tr_b16 v[182:183], v69 offset:8704
    v_mfma_f32_16x16x32_bf16 v[84:87], v[140:143], v[132:135], v[84:87]
    ds_read_b64_tr_b16 v[184:185], v69 offset:16384
    ds_read_b64_tr_b16 v[186:187], v69 offset:16896
    v_mfma_f32_16x16x32_bf16 v[88:91], v[128:131], v[144:147], v[88:91]
    s_add_u32 m0, s11, 49152
    s_add_u32 s5, s14, 1179648
    buffer_load_dwordx4 v64, s[56:59], s5 offen lds
    v_mfma_f32_16x16x32_bf16 v[92:95], v[132:135], v[144:147], v[92:95]
    s_add_u32 m0, s11, 57344
    s_add_u32 s5, s15, 1180672
    buffer_load_dwordx4 v64, s[56:59], s5 offen lds
    s_add_u32 m0, s11, 65536
    s_add_u32 s5, s42, 1181696
    buffer_load_dwordx4 v64, s[56:59], s5 offen lds
    s_waitcnt lgkmcnt(8)
    v_mfma_f32_16x16x32_bf16 v[72:75], v[156:159], v[148:151], v[72:75]
    ds_read_b128 v[128:131], v66 offset:9216
    ds_read_b128 v[132:135], v66 offset:25600
    v_mfma_f32_16x16x32_bf16 v[76:79], v[156:159], v[152:155], v[76:79]
    ds_read_b64_tr_b16 v[136:137], v69 offset:4096
    ds_read_b64_tr_b16 v[138:139], v69 offset:4608
    v_mfma_f32_16x16x32_bf16 v[80:83], v[160:163], v[148:151], v[80:83]
    ds_read_b64_tr_b16 v[140:141], v69 offset:12288
    ds_read_b64_tr_b16 v[142:143], v69 offset:12800
    v_mfma_f32_16x16x32_bf16 v[84:87], v[160:163], v[152:155], v[84:87]
    ds_read_b64_tr_b16 v[144:145], v69 offset:20480
    ds_read_b64_tr_b16 v[146:147], v69 offset:20992
    v_mfma_f32_16x16x32_bf16 v[88:91], v[148:151], v[164:167], v[88:91]
    v_mfma_f32_16x16x32_bf16 v[92:95], v[152:155], v[164:167], v[92:95]
    s_waitcnt lgkmcnt(8)
    v_mfma_f32_16x16x32_bf16 v[72:75], v[176:179], v[168:171], v[72:75]
    s_waitcnt vmcnt(3)
    s_barrier
    ds_read_b128 v[148:151], v67 offset:10240
    ds_read_b128 v[152:155], v67 offset:26624
    v_mfma_f32_16x16x32_bf16 v[76:79], v[176:179], v[172:175], v[76:79]
    ds_read_b64_tr_b16 v[156:157], v69 offset:24576
    ds_read_b64_tr_b16 v[158:159], v69 offset:25088
    v_mfma_f32_16x16x32_bf16 v[80:83], v[180:183], v[168:171], v[80:83]
    ds_read_b64_tr_b16 v[160:161], v69 offset:32768
    ds_read_b64_tr_b16 v[162:163], v69 offset:33280
    v_mfma_f32_16x16x32_bf16 v[84:87], v[180:183], v[172:175], v[84:87]
    ds_read_b64_tr_b16 v[164:165], v69 offset:40960
    ds_read_b64_tr_b16 v[166:167], v69 offset:41472
    v_mfma_f32_16x16x32_bf16 v[88:91], v[168:171], v[184:187], v[88:91]
    s_add_u32 m0, s11, 73728
    s_add_u32 s5, s14, 1376256
    buffer_load_dwordx4 v64, s[56:59], s5 offen lds
    v_mfma_f32_16x16x32_bf16 v[92:95], v[172:175], v[184:187], v[92:95]
    s_add_u32 m0, s11, 81920
    s_add_u32 s5, s15, 1377280
    buffer_load_dwordx4 v64, s[56:59], s5 offen lds
    s_add_u32 m0, s11, 90112
    s_add_u32 s5, s42, 1378304
    buffer_load_dwordx4 v64, s[56:59], s5 offen lds
    s_waitcnt lgkmcnt(8)
    v_mfma_f32_16x16x32_bf16 v[72:75], v[136:139], v[128:131], v[72:75]
    ds_read_b128 v[168:171], v68 offset:11264
    ds_read_b128 v[172:175], v68 offset:27648
    v_mfma_f32_16x16x32_bf16 v[76:79], v[136:139], v[132:135], v[76:79]
    ds_read_b64_tr_b16 v[176:177], v69 offset:28672
    ds_read_b64_tr_b16 v[178:179], v69 offset:29184
    v_mfma_f32_16x16x32_bf16 v[80:83], v[140:143], v[128:131], v[80:83]
    ds_read_b64_tr_b16 v[180:181], v69 offset:36864
    ds_read_b64_tr_b16 v[182:183], v69 offset:37376
    v_mfma_f32_16x16x32_bf16 v[84:87], v[140:143], v[132:135], v[84:87]
    ds_read_b64_tr_b16 v[184:185], v69 offset:45056
    ds_read_b64_tr_b16 v[186:187], v69 offset:45568
    v_mfma_f32_16x16x32_bf16 v[88:91], v[128:131], v[144:147], v[88:91]
    v_mfma_f32_16x16x32_bf16 v[92:95], v[132:135], v[144:147], v[92:95]
    s_waitcnt lgkmcnt(8)
    v_mfma_f32_16x16x32_bf16 v[72:75], v[156:159], v[148:151], v[72:75]
    s_waitcnt vmcnt(3)
    s_barrier
    ds_read_b128 v[128:131], v65 offset:12288
    ds_read_b128 v[132:135], v65 offset:28672
    v_mfma_f32_16x16x32_bf16 v[76:79], v[156:159], v[152:155], v[76:79]
    ds_read_b64_tr_b16 v[136:137], v70 offset:0
    ds_read_b64_tr_b16 v[138:139], v70 offset:512
    v_mfma_f32_16x16x32_bf16 v[80:83], v[160:163], v[148:151], v[80:83]
    ds_read_b64_tr_b16 v[140:141], v70 offset:8192
    ds_read_b64_tr_b16 v[142:143], v70 offset:8704
    v_mfma_f32_16x16x32_bf16 v[84:87], v[160:163], v[152:155], v[84:87]
    ds_read_b64_tr_b16 v[144:145], v70 offset:16384
    ds_read_b64_tr_b16 v[146:147], v70 offset:16896
    v_mfma_f32_16x16x32_bf16 v[88:91], v[148:151], v[164:167], v[88:91]
    v_mfma_f32_16x16x32_bf16 v[92:95], v[152:155], v[164:167], v[92:95]
    s_waitcnt lgkmcnt(8)
    v_mfma_f32_16x16x32_bf16 v[72:75], v[176:179], v[168:171], v[72:75]
    ds_read_b128 v[148:151], v66 offset:13312
    ds_read_b128 v[152:155], v66 offset:29696
    v_mfma_f32_16x16x32_bf16 v[76:79], v[176:179], v[172:175], v[76:79]
    ds_read_b64_tr_b16 v[156:157], v70 offset:4096
    ds_read_b64_tr_b16 v[158:159], v70 offset:4608
    v_mfma_f32_16x16x32_bf16 v[80:83], v[180:183], v[168:171], v[80:83]
    ds_read_b64_tr_b16 v[160:161], v70 offset:12288
    ds_read_b64_tr_b16 v[162:163], v70 offset:12800
    v_mfma_f32_16x16x32_bf16 v[84:87], v[180:183], v[172:175], v[84:87]
    ds_read_b64_tr_b16 v[164:165], v70 offset:20480
    ds_read_b64_tr_b16 v[166:167], v70 offset:20992
    v_mfma_f32_16x16x32_bf16 v[88:91], v[168:171], v[184:187], v[88:91]
    v_mfma_f32_16x16x32_bf16 v[92:95], v[172:175], v[184:187], v[92:95]
    s_waitcnt lgkmcnt(8)
    v_mfma_f32_16x16x32_bf16 v[72:75], v[136:139], v[128:131], v[72:75]
    s_waitcnt vmcnt(0)
    s_barrier
    ds_read_b128 v[168:171], v67 offset:14336
    ds_read_b128 v[172:175], v67 offset:30720
    v_mfma_f32_16x16x32_bf16 v[76:79], v[136:139], v[132:135], v[76:79]
    ds_read_b64_tr_b16 v[176:177], v70 offset:24576
    ds_read_b64_tr_b16 v[178:179], v70 offset:25088
    v_mfma_f32_16x16x32_bf16 v[80:83], v[140:143], v[128:131], v[80:83]
    ds_read_b64_tr_b16 v[180:181], v70 offset:32768
    ds_read_b64_tr_b16 v[182:183], v70 offset:33280
    v_mfma_f32_16x16x32_bf16 v[84:87], v[140:143], v[132:135], v[84:87]
    ds_read_b64_tr_b16 v[184:185], v70 offset:40960
    ds_read_b64_tr_b16 v[186:187], v70 offset:41472
    v_mfma_f32_16x16x32_bf16 v[88:91], v[128:131], v[144:147], v[88:91]
    v_mfma_f32_16x16x32_bf16 v[92:95], v[132:135], v[144:147], v[92:95]
    s_waitcnt lgkmcnt(8)
    v_mfma_f32_16x16x32_bf16 v[72:75], v[156:159], v[148:151], v[72:75]
    ds_read_b128 v[128:131], v68 offset:15360
    ds_read_b128 v[132:135], v68 offset:31744
    v_mfma_f32_16x16x32_bf16 v[76:79], v[156:159], v[152:155], v[76:79]
    ds_read_b64_tr_b16 v[136:137], v70 offset:28672
    ds_read_b64_tr_b16 v[138:139], v70 offset:29184
    v_mfma_f32_16x16x32_bf16 v[80:83], v[160:163], v[148:151], v[80:83]
    ds_read_b64_tr_b16 v[140:141], v70 offset:36864
    ds_read_b64_tr_b16 v[142:143], v70 offset:37376
    v_mfma_f32_16x16x32_bf16 v[84:87], v[160:163], v[152:155], v[84:87]
    ds_read_b64_tr_b16 v[144:145], v70 offset:45056
    ds_read_b64_tr_b16 v[146:147], v70 offset:45568
    v_mfma_f32_16x16x32_bf16 v[88:91], v[148:151], v[164:167], v[88:91]
    v_mfma_f32_16x16x32_bf16 v[92:95], v[152:155], v[164:167], v[92:95]
    s_waitcnt lgkmcnt(8)
    v_mfma_f32_16x16x32_bf16 v[72:75], v[176:179], v[168:171], v[72:75]
    v_mfma_f32_16x16x32_bf16 v[76:79], v[176:179], v[172:175], v[76:79]
    v_mfma_f32_16x16x32_bf16 v[80:83], v[180:183], v[168:171], v[80:83]
    v_mfma_f32_16x16x32_bf16 v[84:87], v[180:183], v[172:175], v[84:87]
    v_mfma_f32_16x16x32_bf16 v[88:91], v[168:171], v[184:187], v[88:91]
    v_mfma_f32_16x16x32_bf16 v[92:95], v[172:175], v[184:187], v[92:95]
    s_waitcnt lgkmcnt(0)
    v_mfma_f32_16x16x32_bf16 v[72:75], v[136:139], v[128:131], v[72:75]
    v_mfma_f32_16x16x32_bf16 v[76:79], v[136:139], v[132:135], v[76:79]
    v_mfma_f32_16x16x32_bf16 v[80:83], v[140:143], v[128:131], v[80:83]
    v_mfma_f32_16x16x32_bf16 v[84:87], v[140:143], v[132:135], v[84:87]
    v_mfma_f32_16x16x32_bf16 v[88:91], v[128:131], v[144:147], v[88:91]
    v_mfma_f32_16x16x32_bf16 v[92:95], v[132:135], v[144:147], v[92:95]
    v_lshlrev_b32 v107, 2, v1
    v_and_b32 v107, 127, v107
    buffer_load_dword v108, v107, s[48:51], 0 offen offset:128 sc1
    s_add_u32 s64, s40, 0x180000
    s_addc_u32 s65, s41, 0
    s_mov_b32 s66, 0x40000
    s_mov_b32 s67, 0x00020000
    s_lshl_b32 s5, s2, 10
    v_lshlrev_b32 v8, 1, v0
    v_mov_b32 v9, 0
    buffer_store_short v9, v8, s[64:67], s5 offen sc1
    s_add_u32 s64, s40, 0x200000
    s_addc_u32 s65, s41, 0
    s_mov_b32 s66, 0x1c0000
    s_mov_b32 s67, 0x00020000
    buffer_store_dwordx4 v[96:99], v104, s[64:67], 0 offen sc1
    buffer_store_dwordx4 v[100:103], v105, s[64:67], 0 offen sc1
    s_add_u32 s60, s40, 0x400000
    s_addc_u32 s61, s41, 0
    s_mov_b32 s62, 0x600000
    s_mov_b32 s63, 0x00020000
    s_add_u32 s64, s40, 0x4000
    s_addc_u32 s65, s41, 0
    s_mov_b32 s66, 0x2000
    s_mov_b32 s67, 0x00020000
    s_lshr_b32 s5, s3, 1
    s_lshl_b32 s5, s5, 6
    s_lshl_b32 s6, s8, 1
    s_add_u32 s5, s5, s6
    s_and_b32 s6, s3, 1
    s_add_u32 s13, s5, s6
    s_lshl_b32 s7, s15, 1
    s_add_u32 s7, s7, s13
    s_lshl_b32 s7, s7, 2
    v_lshlrev_b32 v2, 4, v1
    v_mul_f32 v72, 0x3eb8aa3b, v72
    v_mul_f32 v73, 0x3eb8aa3b, v73
    v_mul_f32 v74, 0x3eb8aa3b, v74
    v_mul_f32 v75, 0x3eb8aa3b, v75
    v_mul_f32 v76, 0x3eb8aa3b, v76
    v_mul_f32 v77, 0x3eb8aa3b, v77
    v_mul_f32 v78, 0x3eb8aa3b, v78
    v_mul_f32 v79, 0x3eb8aa3b, v79
    v_cvt_pk_bf16_f32 v16, v72, v73
    v_cvt_pk_bf16_f32 v17, v74, v75
    v_cvt_pk_bf16_f32 v18, v76, v77
    v_cvt_pk_bf16_f32 v19, v78, v79
    s_nop 0
    v_permlane16_swap_b32 v16, v18
    v_permlane16_swap_b32 v17, v19
    s_lshl_b32 s4, s14, 1
    s_add_u32 s4, s4, s13
    s_lshl_b32 s4, s4, 10
    s_add_u32 s4, s4, 0
    buffer_store_dwordx4 v[16:19], v2, s[60:63], s4 offen sc1
    v_cvt_pk_bf16_f32 v20, v80, v81
    v_cvt_pk_bf16_f32 v21, v82, v83
    v_cvt_pk_bf16_f32 v22, v84, v85
    v_cvt_pk_bf16_f32 v23, v86, v87
    s_nop 0
    v_permlane16_swap_b32 v20, v22
    v_permlane16_swap_b32 v21, v23
    s_lshl_b32 s4, s15, 1
    s_add_u32 s4, s4, s13
    s_lshl_b32 s4, s4, 10
    s_add_u32 s4, s4, 2097152
    buffer_store_dwordx4 v[20:23], v2, s[60:63], s4 offen sc1
    v_cvt_pk_bf16_f32 v24, v88, v89
    v_cvt_pk_bf16_f32 v25, v90, v91
    v_cvt_pk_bf16_f32 v26, v92, v93
    v_cvt_pk_bf16_f32 v27, v94, v95
    s_nop 0
    v_permlane32_swap_b32 v24, v26
    v_permlane32_swap_b32 v25, v27
    s_lshl_b32 s4, s42, 1
    s_add_u32 s4, s4, s13
    s_lshl_b32 s4, s4, 10
    s_add_u32 s4, s4, 4194304
    buffer_store_dwordx4 v[24:27], v2, s[60:63], s4 offen sc1
    v_mul_f32 v8, v80, v80
    v_fmac_f32 v8, v81, v81
    v_fmac_f32 v8, v82, v82
    v_fmac_f32 v8, v83, v83
    v_mul_f32 v9, v84, v84
    v_fmac_f32 v9, v85, v85
    v_fmac_f32 v9, v86, v86
    v_fmac_f32 v9, v87, v87
    v_mov_b32 v6, v8
    s_nop 1
    v_permlane16_swap_b32 v8, v6
    v_add_f32 v8, v8, v6
    v_mov_b32 v6, v9
    s_nop 1
    v_permlane16_swap_b32 v9, v6
    v_add_f32 v9, v9, v6
    v_mov_b32 v6, v8
    s_nop 1
    v_permlane32_swap_b32 v8, v6
    v_add_f32 v8, v8, v6
    v_mov_b32 v6, v9
    s_nop 1
    v_permlane32_swap_b32 v9, v6
    v_add_f32 v9, v9, v6
    v_max_f32 v8, v8, v9
    s_nop 1
    v_max_f32_dpp v8, v8, v8 quad_perm:[1,0,3,2] row_mask:0xf bank_mask:0xf
    s_nop 1
    v_max_f32_dpp v8, v8, v8 quad_perm:[2,3,0,1] row_mask:0xf bank_mask:0xf
    s_nop 1
    v_max_f32_dpp v8, v8, v8 row_half_mirror row_mask:0xf bank_mask:0xf
    s_nop 1
    v_max_f32_dpp v8, v8, v8 row_mirror row_mask:0xf bank_mask:0xf
    s_mov_b64 exec, 1
    buffer_store_dword v8, off, s[64:67], s7 sc1
    s_mov_b64 exec, -1
    s_waitcnt vmcnt(0)
    s_barrier
    s_cmp_eq_u32 s3, 0
    s_cbranch_scc0 pb_17006_e
    s_mov_b32 s6, 0
pb_17006:
    v_cmp_ne_u32 vcc, 0, v108
    s_nop 0
    s_cmp_eq_u64 vcc, -1
    s_cbranch_scc1 pb_17006_x
    s_add_u32 s6, s6, 1
    s_cmp_gt_u32 s6, 0x20000
    s_cbranch_scc1 pb_17006_x
    buffer_load_dword v108, v107, s[48:51], 0 offen offset:128 sc1
    s_waitcnt vmcnt(0)
    s_branch pb_17006
pb_17006_x:
    s_add_u32 s5, s9, 112
    s_lshl_b32 s5, s5, 8
    s_lshl_b32 s6, s8, 2
    s_add_u32 s5, s5, s6
    v_mov_b32 v5, 1
    s_mov_b64 exec, 1
    buffer_store_dword v5, off, s[84:87], s5 sc1
    s_mov_b64 exec, -1
pb_17006_e:
    s_cmp_eq_u32 s3, 0
    s_cbranch_scc0 qd_17008
    s_and_b32 s5, s2, 7
    v_lshrrev_b32 v6, 5, v1
    v_lshlrev_b32 v6, 2, v6
    v_xor_b32 v6, s5, v6
    v_add_u32 v6, 112, v6
    v_lshlrev_b32 v6, 8, v6
    v_and_b32 v7, 31, v1
    v_lshl_add_u32 v6, v7, 2, v6
    s_mov_b32 s6, 0
qp_17007:
    buffer_load_dword v5, v6, s[84:87], 0 offen sc0 sc1
    s_waitcnt vmcnt(0)
    v_cmp_ne_u32 vcc, 0, v5
    s_add_u32 s6, s6, 1
    s_cmp_gt_u32 s6, 0x20000
    s_cbranch_scc1 qd_17008
    s_cmp_eq_u64 vcc, -1
    s_cbranch_scc1 qd_17008
    s_sleep 6
    s_branch qp_17007
qd_17008:
    s_barrier
    s_add_u32 s44, s40, 0x400000
    s_addc_u32 s45, s41, 0
    s_mov_b32 s46, 0x600000
    s_mov_b32 s47, 0x00020000
    s_add_u32 s48, s40, 0x4000
    s_addc_u32 s49, s41, 0
    s_mov_b32 s50, 0x2000
    s_mov_b32 s51, 0x00020000
    s_add_u32 s52, s40, 0xa00000
    s_addc_u32 s53, s41, 0
    s_mov_b32 s54, 0x200000
    s_mov_b32 s55, 0x00020000
    s_mov_b32 s56, s26
    s_mov_b32 s57, s27
    s_mov_b32 s58, 0x800000
    s_mov_b32 s59, 0x00020000
    v_lshlrev_b32 v2, 4, v1
    s_lshl_b32 s10, s88, 16
    s_lshl_b32 s5, s89, 3
    s_add_u32 s5, s5, s3
    s_lshl_b32 s5, s5, 10
    s_add_u32 s5, s5, s10
    buffer_load_dwordx4 v[4:7], v2, s[44:47], s5 offen sc1
    v_lshlrev_b32 v3, 2, v1
    s_lshl_b32 s5, s88, 8
    buffer_load_dword v8, v3, s[48:51], s5 offen sc1
    s_lshl_b32 s11, s3, 10
    s_add_u32 s12, s10, s11
    s_add_u32 s12, s12, 2097152
    s_add_u32 s5, s12, 0
    s_add_u32 s6, s11, 0
    s_mov_b32 m0, s6
    s_nop 0
    buffer_load_dwordx4 v2, s[44:47], s5 offen sc1 lds
    s_add_u32 s5, s12, 2097152
    s_add_u32 s6, s11, 65536
    s_mov_b32 m0, s6
    s_nop 0
    buffer_load_dwordx4 v2, s[44:47], s5 offen sc1 lds
    s_add_u32 s5, s12, 8192
    s_add_u32 s6, s11, 8192
    s_mov_b32 m0, s6
    s_nop 0
    buffer_load_dwordx4 v2, s[44:47], s5 offen sc1 lds
    s_add_u32 s5, s12, 2105344
    s_add_u32 s6, s11, 73728
    s_mov_b32 m0, s6
    s_nop 0
    buffer_load_dwordx4 v2, s[44:47], s5 offen sc1 lds
    s_add_u32 s5, s12, 16384
    s_add_u32 s6, s11, 16384
    s_mov_b32 m0, s6
    s_nop 0
    buffer_load_dwordx4 v2, s[44:47], s5 offen sc1 lds
    s_add_u32 s5, s12, 2113536
    s_add_u32 s6, s11, 81920
    s_mov_b32 m0, s6
    s_nop 0
    buffer_load_dwordx4 v2, s[44:47], s5 offen sc1 lds
    s_add_u32 s5, s12, 24576
    s_add_u32 s6, s11, 24576
    s_mov_b32 m0, s6
    s_nop 0
    buffer_load_dwordx4 v2, s[44:47], s5 offen sc1 lds
    s_add_u32 s5, s12, 2121728
    s_add_u32 s6, s11, 90112
    s_mov_b32 m0, s6
    s_nop 0
    buffer_load_dwordx4 v2, s[44:47], s5 offen sc1 lds
    s_add_u32 s5, s12, 32768
    s_add_u32 s6, s11, 32768
    s_mov_b32 m0, s6
    s_nop 0
    buffer_load_dwordx4 v2, s[44:47], s5 offen sc1 lds
    s_add_u32 s5, s12, 2129920
    s_add_u32 s6, s11, 98304
    s_mov_b32 m0, s6
    s_nop 0
    buffer_load_dwordx4 v2, s[44:47], s5 offen sc1 lds
    s_add_u32 s5, s12, 40960
    s_add_u32 s6, s11, 40960
    s_mov_b32 m0, s6
    s_nop 0
    buffer_load_dwordx4 v2, s[44:47], s5 offen sc1 lds
    s_add_u32 s5, s12, 2138112
    s_add_u32 s6, s11, 106496
    s_mov_b32 m0, s6
    s_nop 0
    buffer_load_dwordx4 v2, s[44:47], s5 offen sc1 lds
    s_add_u32 s5, s12, 49152
    s_add_u32 s6, s11, 49152
    s_mov_b32 m0, s6
    s_nop 0
    buffer_load_dwordx4 v2, s[44:47], s5 offen sc1 lds
    s_add_u32 s5, s12, 2146304
    s_add_u32 s6, s11, 114688
    s_mov_b32 m0, s6
    s_nop 0
    buffer_load_dwordx4 v2, s[44:47], s5 offen sc1 lds
    s_add_u32 s5, s12, 57344
    s_add_u32 s6, s11, 57344
    s_mov_b32 m0, s6
    s_nop 0
    buffer_load_dwordx4 v2, s[44:47], s5 offen sc1 lds
    s_add_u32 s5, s12, 2154496
    s_add_u32 s6, s11, 122880
    s_mov_b32 m0, s6
    s_nop 0
    buffer_load_dwordx4 v2, s[44:47], s5 offen sc1 lds
    v_mov_b32 v16, 0
    v_mov_b32 v64, 0
    v_mov_b32 v17, 0
    v_mov_b32 v65, 0
    v_mov_b32 v18, 0
    v_mov_b32 v66, 0
    v_mov_b32 v19, 0
    v_mov_b32 v67, 0
    v_mov_b32 v20, 0
    v_mov_b32 v68, 0
    v_mov_b32 v21, 0
    v_mov_b32 v69, 0
    v_mov_b32 v22, 0
    v_mov_b32 v70, 0
    v_mov_b32 v23, 0
    v_mov_b32 v71, 0
    v_mov_b32 v24, 0
    v_mov_b32 v72, 0
    v_mov_b32 v25, 0
    v_mov_b32 v73, 0
    v_mov_b32 v26, 0
    v_mov_b32 v74, 0
    v_mov_b32 v27, 0
    v_mov_b32 v75, 0
    v_mov_b32 v28, 0
    v_mov_b32 v76, 0
    v_mov_b32 v29, 0
    v_mov_b32 v77, 0
    v_mov_b32 v30, 0
    v_mov_b32 v78, 0
    v_mov_b32 v31, 0
    v_mov_b32 v79, 0
    v_and_b32 v9, 27, v1
    v_cmp_eq_u32 vcc, 16, v9
    v_mov_b32 v10, 0x3f803f80
    v_mov_b32 v11, 0
    s_nop 0
    v_cndmask_b32 v9, v11, v10, vcc
    v_mov_b32 v88, v9
    v_mov_b32 v89, v9
    v_mov_b32 v90, v9
    v_mov_b32 v91, v9
    v_mov_b32 v92, v9
    v_mov_b32 v93, v9
    v_mov_b32 v94, v9
    v_mov_b32 v95, v9
    v_mov_b32 v96, v9
    v_mov_b32 v97, v9
    v_mov_b32 v98, v9
    v_mov_b32 v99, v9
    v_mov_b32 v100, v9
    v_mov_b32 v101, v9
    v_mov_b32 v102, v9
    v_mov_b32 v103, v9
    v_mov_b32 v12, v2
    v_and_b32 v13, 15, v1
    v_lshlrev_b32 v13, 4, v13
    v_lshrrev_b32 v14, 5, v1
    v_lshl_add_u32 v13, v14, 8, v13
    v_add_u32 v13, 0x10000, v13
    s_mov_b32 s14, 0x0000ffff
    s_mov_b32 s15, 0x0000ffff
    v_and_b32 v104, 15, v1
    s_lshl_b32 s5, s8, 6
    s_bfe_u32 s6, s3, 0x10001
    s_lshl_b32 s6, s6, 5
    s_add_u32 s5, s5, s6
    v_add_u32 v104, s5, v104
    v_lshlrev_b32 v104, 12, v104
    v_lshrrev_b32 v105, 4, v1
    v_lshl_add_u32 v104, v105, 4, v104
    s_and_b32 s5, s3, 1
    s_lshr_b32 s6, s3, 2
    s_lshl_b32 s6, s6, 1
    s_or_b32 s5, s5, s6
    s_lshl_b32 s5, s5, 10
    v_add_u32 v104, s5, v104
    s_mov_b32 s60, s20
    s_mov_b32 s61, s21
    s_mov_b32 s62, 0x80000
    s_mov_b32 s63, 0x00020000
    s_mov_b32 s64, s30
    s_mov_b32 s65, s31
    s_mov_b32 s66, 0xe0000
    s_mov_b32 s67, 0x00020000
    s_add_u32 s68, s40, 0x200000
    s_addc_u32 s69, s41, 0
    s_mov_b32 s70, 0x1c0000
    s_mov_b32 s71, 0x00020000
    v_lshrrev_b32 v105, 3, v1
    s_lshl_b32 s5, s3, 3
    v_add_u32 v105, s5, v105
    v_lshlrev_b32 v105, 10, v105
    v_and_b32 v106, 7, v1
    v_lshl_add_u32 v105, v106, 4, v105
    s_lshl_b32 s5, s9, 7
    v_add_u32 v105, s5, v105
    s_and_b32 s91, s8, 7
    s_waitcnt vmcnt(16)
    v_max_f32_dpp v8, v8, v8 quad_perm:[1,0,3,2] row_mask:0xf bank_mask:0xf
    s_nop 1
    v_max_f32_dpp v8, v8, v8 quad_perm:[2,3,0,1] row_mask:0xf bank_mask:0xf
    s_nop 1
    v_max_f32_dpp v8, v8, v8 row_half_mirror row_mask:0xf bank_mask:0xf
    s_nop 1
    v_max_f32_dpp v8, v8, v8 row_mirror row_mask:0xf bank_mask:0xf
    v_mov_b32 v14, v8
    s_nop 1
    v_permlane16_swap_b32 v8, v14
    v_max_f32 v8, v8, v14
    v_mov_b32 v14, v8
    s_nop 1
    v_permlane32_swap_b32 v8, v14
    v_max_f32 v8, v8, v14
    v_mov_b32 v10, 0
    v_lshlrev_b32 v14, 16, v4
    v_and_b32 v15, 0xffff0000, v4
    v_fmac_f32 v10, v14, v14
    v_fmac_f32 v10, v15, v15
    v_lshlrev_b32 v14, 16, v5
    v_and_b32 v15, 0xffff0000, v5
    v_fmac_f32 v10, v14, v14
    v_fmac_f32 v10, v15, v15
    v_lshlrev_b32 v14, 16, v6
    v_and_b32 v15, 0xffff0000, v6
    v_fmac_f32 v10, v14, v14
    v_fmac_f32 v10, v15, v15
    v_lshlrev_b32 v14, 16, v7
    v_and_b32 v15, 0xffff0000, v7
    v_fmac_f32 v10, v14, v14
    v_fmac_f32 v10, v15, v15
    v_mov_b32 v14, v10
    s_nop 1
    v_permlane32_swap_b32 v10, v14
    v_add_f32 v10, v10, v14
    v_mul_f32 v10, v10, v8
    v_mul_f32 v10, 0x3f866666, v10
    v_mov_b32 v11, 0x45800000
    v_cmp_gt_f32 vcc, v10, v11
    s_nop 1
    s_cmp_lg_u64 vcc, 0
    s_cselect_b32 s5, 1, 0
    v_mov_b32 v10, s5
    s_lshl_b32 s6, s3, 2
    s_add_u32 s6, s6, 0x22000
    v_mov_b32 v11, s6
    ds_write_b32 v11, v10
    s_waitcnt vmcnt(12) lgkmcnt(0)
    s_barrier
    v_and_b32 v11, 7, v1
    v_lshlrev_b32 v11, 2, v11
    v_add_u32 v11, 0x22000, v11
    ds_read_b32 v10, v11
    s_waitcnt lgkmcnt(0)
    v_cmp_ne_u32 vcc, 0, v10
    s_cbranch_vccz k2_fast
    s_waitcnt vmcnt(0)
    s_barrier
    v_mov_b32 v8, 0xff800000
    v_mov_b32 v14, v12
    s_mov_b32 s5, 0
k2_slow:
    ds_read_b128 v[80:83], v14
    s_waitcnt lgkmcnt(0)
    v_mfma_f32_32x32x16_bf16 v[32:47], v[80:83], v[4:7], v[16:31]
    s_nop 11
    v_max3_f32 v8, v8, v32, v33
    v_max3_f32 v8, v8, v34, v35
    v_max3_f32 v8, v8, v36, v37
    v_max3_f32 v8, v8, v38, v39
    v_max3_f32 v8, v8, v40, v41
    v_max3_f32 v8, v8, v42, v43
    v_max3_f32 v8, v8, v44, v45
    v_max3_f32 v8, v8, v46, v47
    v_add_u32 v14, 1024, v14
    s_add_u32 s5, s5, 1
    s_cmp_lt_u32 s5, 64
    s_cbranch_scc1 k2_slow
    v_mov_b32 v14, v8
    s_nop 1
    v_permlane32_swap_b32 v8, v14
    v_max_f32 v8, v8, v14
    v_sub_f32 v8, 0, v8
    v_mov_b32 v16, v8
    v_mov_b32 v17, v8
    v_mov_b32 v18, v8
    v_mov_b32 v19, v8
    v_mov_b32 v20, v8
    v_mov_b32 v21, v8
    v_mov_b32 v22, v8
    v_mov_b32 v23, v8
    v_mov_b32 v24, v8
    v_mov_b32 v25, v8
    v_mov_b32 v26, v8
    v_mov_b32 v27, v8
    v_mov_b32 v28, v8
    v_mov_b32 v29, v8
    v_mov_b32 v30, v8
    v_mov_b32 v31, v8
k2_fast:
    ds_read_b128 v[80:83], v12 offset:0
    ds_read_b128 v[84:87], v12 offset:1024
    s_mov_b64 exec, s[14:15]
    ds_read_b128 v[88:91], v13 offset:0
    ds_read_b128 v[92:95], v13 offset:512
    s_mov_b64 exec, -1
    v_mov_b32 v56, 0
    v_mov_b32 v57, 0
    v_mov_b32 v58, 0
    v_mov_b32 v59, 0
    s_waitcnt lgkmcnt(0)
    v_mfma_f32_32x32x16_bf16 v[32:47], v[80:83], v[4:7], v[16:31]
    s_nop 11
    v_exp_f32 v32, v32
    v_exp_f32 v33, v33
    v_mfma_f32_32x32x16_bf16 v[64:79], v[100:103], v[56:59], v[64:79]
    v_exp_f32 v34, v34
    v_exp_f32 v35, v35
    v_exp_f32 v36, v36
    v_exp_f32 v37, v37
    v_exp_f32 v38, v38
    s_waitcnt lgkmcnt(0)
    v_mfma_f32_32x32x16_bf16 v[48:63], v[84:87], v[4:7], v[16:31]
    ds_read_b128 v[80:83], v12 offset:2048
    s_mov_b64 exec, s[14:15]
    ds_read_b128 v[96:99], v13 offset:1024
    ds_read_b128 v[100:103], v13 offset:1536
    s_mov_b64 exec, -1
    v_exp_f32 v39, v39
    v_cvt_pk_bf16_f32 v32, v32, v33
    v_cvt_pk_bf16_f32 v33, v34, v35
    v_cvt_pk_bf16_f32 v34, v36, v37
    v_cvt_pk_bf16_f32 v35, v38, v39
    v_exp_f32 v40, v40
    v_exp_f32 v41, v41
    v_exp_f32 v42, v42
    v_exp_f32 v43, v43
    v_mfma_f32_32x32x16_bf16 v[64:79], v[88:91], v[32:35], v[64:79]
    v_exp_f32 v44, v44
    v_exp_f32 v45, v45
    v_exp_f32 v46, v46
    v_exp_f32 v47, v47
    v_cvt_pk_bf16_f32 v40, v40, v41
    v_cvt_pk_bf16_f32 v41, v42, v43
    v_cvt_pk_bf16_f32 v42, v44, v45
    v_cvt_pk_bf16_f32 v43, v46, v47
    v_exp_f32 v48, v48
    v_exp_f32 v49, v49
    v_mfma_f32_32x32x16_bf16 v[64:79], v[92:95], v[40:43], v[64:79]
    v_exp_f32 v50, v50
    v_exp_f32 v51, v51
    v_exp_f32 v52, v52
    v_exp_f32 v53, v53
    v_exp_f32 v54, v54
    s_waitcnt lgkmcnt(0)
    v_mfma_f32_32x32x16_bf16 v[32:47], v[80:83], v[4:7], v[16:31]
    ds_read_b128 v[84:87], v12 offset:3072
    s_mov_b64 exec, s[14:15]
    ds_read_b128 v[88:91], v13 offset:2048
    ds_read_b128 v[92:95], v13 offset:2560
    s_mov_b64 exec, -1
    v_exp_f32 v55, v55
    v_cvt_pk_bf16_f32 v48, v48, v49
    v_cvt_pk_bf16_f32 v49, v50, v51
    v_cvt_pk_bf16_f32 v50, v52, v53
    v_cvt_pk_bf16_f32 v51, v54, v55
    v_exp_f32 v56, v56
    v_exp_f32 v57, v57
    v_exp_f32 v58, v58
    v_exp_f32 v59, v59
    v_mfma_f32_32x32x16_bf16 v[64:79], v[96:99], v[48:51], v[64:79]
    v_exp_f32 v60, v60
    v_exp_f32 v61, v61
    v_exp_f32 v62, v62
    v_exp_f32 v63, v63
    v_cvt_pk_bf16_f32 v56, v56, v57
    v_cvt_pk_bf16_f32 v57, v58, v59
    v_cvt_pk_bf16_f32 v58, v60, v61
    v_cvt_pk_bf16_f32 v59, v62, v63
    v_exp_f32 v32, v32
    v_exp_f32 v33, v33
    v_mfma_f32_32x32x16_bf16 v[64:79], v[100:103], v[56:59], v[64:79]
    v_exp_f32 v34, v34
    v_exp_f32 v35, v35
    v_exp_f32 v36, v36
    v_exp_f32 v37, v37
    v_exp_f32 v38, v38
    s_waitcnt lgkmcnt(0)
    v_mfma_f32_32x32x16_bf16 v[48:63], v[84:87], v[4:7], v[16:31]
    ds_read_b128 v[80:83], v12 offset:4096
    s_mov_b64 exec, s[14:15]
    ds_read_b128 v[96:99], v13 offset:3072
    ds_read_b128 v[100:103], v13 offset:3584
    s_mov_b64 exec, -1
    v_exp_f32 v39, v39
    v_cvt_pk_bf16_f32 v32, v32, v33
    v_cvt_pk_bf16_f32 v33, v34, v35
    v_cvt_pk_bf16_f32 v34, v36, v37
    v_cvt_pk_bf16_f32 v35, v38, v39
    v_exp_f32 v40, v40
    v_exp_f32 v41, v41
    v_exp_f32 v42, v42
    v_exp_f32 v43, v43
    v_mfma_f32_32x32x16_bf16 v[64:79], v[88:91], v[32:35], v[64:79]
    v_exp_f32 v44, v44
    v_exp_f32 v45, v45
    v_exp_f32 v46, v46
    v_exp_f32 v47, v47
    v_cvt_pk_bf16_f32 v40, v40, v41
    v_cvt_pk_bf16_f32 v41, v42, v43
    v_cvt_pk_bf16_f32 v42, v44, v45
    v_cvt_pk_bf16_f32 v43, v46, v47
    v_exp_f32 v48, v48
    v_exp_f32 v49, v49
    v_mfma_f32_32x32x16_bf16 v[64:79], v[92:95], v[40:43], v[64:79]
    v_exp_f32 v50, v50
    v_exp_f32 v51, v51
    v_exp_f32 v52, v52
    v_exp_f32 v53, v53
    v_exp_f32 v54, v54
    s_waitcnt lgkmcnt(0)
    v_mfma_f32_32x32x16_bf16 v[32:47], v[80:83], v[4:7], v[16:31]
    ds_read_b128 v[84:87], v12 offset:5120
    s_mov_b64 exec, s[14:15]
    ds_read_b128 v[88:91], v13 offset:4096
    ds_read_b128 v[92:95], v13 offset:4608
    s_mov_b64 exec, -1
    v_exp_f32 v55, v55
    v_cvt_pk_bf16_f32 v48, v48, v49
    v_cvt_pk_bf16_f32 v49, v50, v51
    v_cvt_pk_bf16_f32 v50, v52, v53
    v_cvt_pk_bf16_f32 v51, v54, v55
    v_exp_f32 v56, v56
    v_exp_f32 v57, v57
    v_exp_f32 v58, v58
    v_exp_f32 v59, v59
    v_mfma_f32_32x32x16_bf16 v[64:79], v[96:99], v[48:51], v[64:79]
    v_exp_f32 v60, v60
    v_exp_f32 v61, v61
    v_exp_f32 v62, v62
    v_exp_f32 v63, v63
    v_cvt_pk_bf16_f32 v56, v56, v57
    v_cvt_pk_bf16_f32 v57, v58, v59
    v_cvt_pk_bf16_f32 v58, v60, v61
    v_cvt_pk_bf16_f32 v59, v62, v63
    v_exp_f32 v32, v32
    v_exp_f32 v33, v33
    v_mfma_f32_32x32x16_bf16 v[64:79], v[100:103], v[56:59], v[64:79]
    v_exp_f32 v34, v34
    v_exp_f32 v35, v35
    v_exp_f32 v36, v36
    v_exp_f32 v37, v37
    v_exp_f32 v38, v38
    s_waitcnt lgkmcnt(0)
    v_mfma_f32_32x32x16_bf16 v[48:63], v[84:87], v[4:7], v[16:31]
    ds_read_b128 v[80:83], v12 offset:6144
    s_mov_b64 exec, s[14:15]
    ds_read_b128 v[96:99], v13 offset:5120
    ds_read_b128 v[100:103], v13 offset:5632
    s_mov_b64 exec, -1
    v_exp_f32 v39, v39
    v_cvt_pk_bf16_f32 v32, v32, v33
    v_cvt_pk_bf16_f32 v33, v34, v35
    v_cvt_pk_bf16_f32 v34, v36, v37
    v_cvt_pk_bf16_f32 v35, v38, v39
    v_exp_f32 v40, v40
    v_exp_f32 v41, v41
    v_exp_f32 v42, v42
    v_exp_f32 v43, v43
    v_mfma_f32_32x32x16_bf16 v[64:79], v[88:91], v[32:35], v[64:79]
    v_exp_f32 v44, v44
    v_exp_f32 v45, v45
    v_exp_f32 v46, v46
    v_exp_f32 v47, v47
    v_cvt_pk_bf16_f32 v40, v40, v41
    v_cvt_pk_bf16_f32 v41, v42, v43
    v_cvt_pk_bf16_f32 v42, v44, v45
    v_cvt_pk_bf16_f32 v43, v46, v47
    v_exp_f32 v48, v48
    v_exp_f32 v49, v49
    v_mfma_f32_32x32x16_bf16 v[64:79], v[92:95], v[40:43], v[64:79]
    v_exp_f32 v50, v50
    v_exp_f32 v51, v51
    v_exp_f32 v52, v52
    v_exp_f32 v53, v53
    v_exp_f32 v54, v54
    s_waitcnt lgkmcnt(0)
    v_mfma_f32_32x32x16_bf16 v[32:47], v[80:83], v[4:7], v[16:31]
    ds_read_b128 v[84:87], v12 offset:7168
    s_mov_b64 exec, s[14:15]
    ds_read_b128 v[88:91], v13 offset:6144
    ds_read_b128 v[92:95], v13 offset:6656
    s_mov_b64 exec, -1
    v_exp_f32 v55, v55
    v_cvt_pk_bf16_f32 v48, v48, v49
    v_cvt_pk_bf16_f32 v49, v50, v51
    v_cvt_pk_bf16_f32 v50, v52, v53
    v_cvt_pk_bf16_f32 v51, v54, v55
    v_exp_f32 v56, v56
    v_exp_f32 v57, v57
    v_exp_f32 v58, v58
    v_exp_f32 v59, v59
    v_mfma_f32_32x32x16_bf16 v[64:79], v[96:99], v[48:51], v[64:79]
    v_exp_f32 v60, v60
    v_exp_f32 v61, v61
    v_exp_f32 v62, v62
    v_exp_f32 v63, v63
    v_cvt_pk_bf16_f32 v56, v56, v57
    v_cvt_pk_bf16_f32 v57, v58, v59
    v_cvt_pk_bf16_f32 v58, v60, v61
    v_cvt_pk_bf16_f32 v59, v62, v63
    v_exp_f32 v32, v32
    v_exp_f32 v33, v33
    v_mfma_f32_32x32x16_bf16 v[64:79], v[100:103], v[56:59], v[64:79]
    v_exp_f32 v34, v34
    v_exp_f32 v35, v35
    v_exp_f32 v36, v36
    v_exp_f32 v37, v37
    v_exp_f32 v38, v38
    s_waitcnt lgkmcnt(0)
    v_mfma_f32_32x32x16_bf16 v[48:63], v[84:87], v[4:7], v[16:31]
    ds_read_b128 v[80:83], v12 offset:8192
    s_mov_b64 exec, s[14:15]
    ds_read_b128 v[96:99], v13 offset:7168
    ds_read_b128 v[100:103], v13 offset:7680
    s_mov_b64 exec, -1
    v_exp_f32 v39, v39
    v_cvt_pk_bf16_f32 v32, v32, v33
    v_cvt_pk_bf16_f32 v33, v34, v35
    v_cvt_pk_bf16_f32 v34, v36, v37
    v_cvt_pk_bf16_f32 v35, v38, v39
    v_exp_f32 v40, v40
    v_exp_f32 v41, v41
    v_exp_f32 v42, v42
    v_exp_f32 v43, v43
    v_mfma_f32_32x32x16_bf16 v[64:79], v[88:91], v[32:35], v[64:79]
    v_exp_f32 v44, v44
    v_exp_f32 v45, v45
    v_exp_f32 v46, v46
    v_exp_f32 v47, v47
    v_cvt_pk_bf16_f32 v40, v40, v41
    v_cvt_pk_bf16_f32 v41, v42, v43
    v_cvt_pk_bf16_f32 v42, v44, v45
    v_cvt_pk_bf16_f32 v43, v46, v47
    v_exp_f32 v48, v48
    v_exp_f32 v49, v49
    v_mfma_f32_32x32x16_bf16 v[64:79], v[92:95], v[40:43], v[64:79]
    v_exp_f32 v50, v50
    v_exp_f32 v51, v51
    v_exp_f32 v52, v52
    v_exp_f32 v53, v53
    v_exp_f32 v54, v54
    s_waitcnt lgkmcnt(0)
    v_mfma_f32_32x32x16_bf16 v[32:47], v[80:83], v[4:7], v[16:31]
    ds_read_b128 v[84:87], v12 offset:9216
    s_mov_b64 exec, s[14:15]
    ds_read_b128 v[88:91], v13 offset:8192
    ds_read_b128 v[92:95], v13 offset:8704
    s_mov_b64 exec, -1
    v_exp_f32 v55, v55
    v_cvt_pk_bf16_f32 v48, v48, v49
    v_cvt_pk_bf16_f32 v49, v50, v51
    v_cvt_pk_bf16_f32 v50, v52, v53
    v_cvt_pk_bf16_f32 v51, v54, v55
    v_exp_f32 v56, v56
    v_exp_f32 v57, v57
    v_exp_f32 v58, v58
    v_exp_f32 v59, v59
    v_mfma_f32_32x32x16_bf16 v[64:79], v[96:99], v[48:51], v[64:79]
    v_exp_f32 v60, v60
    v_exp_f32 v61, v61
    v_exp_f32 v62, v62
    v_exp_f32 v63, v63
    v_cvt_pk_bf16_f32 v56, v56, v57
    v_cvt_pk_bf16_f32 v57, v58, v59
    v_cvt_pk_bf16_f32 v58, v60, v61
    v_cvt_pk_bf16_f32 v59, v62, v63
    v_add_u32 v12, 8192, v12
    v_add_u32 v13, 8192, v13
    s_waitcnt vmcnt(0)
    s_barrier
    s_cmp_ge_u32 s3, 4
    s_cbranch_scc0 pr_17009_a
    s_setprio 1
    s_branch pr_17009_b
pr_17009_a:
    s_setprio 0
pr_17009_b:
    v_exp_f32 v32, v32
    v_exp_f32 v33, v33
    v_mfma_f32_32x32x16_bf16 v[64:79], v[100:103], v[56:59], v[64:79]
    v_exp_f32 v34, v34
    v_exp_f32 v35, v35
    v_exp_f32 v36, v36
    v_exp_f32 v37, v37
    v_exp_f32 v38, v38
    s_waitcnt lgkmcnt(0)
    v_mfma_f32_32x32x16_bf16 v[48:63], v[84:87], v[4:7], v[16:31]
    ds_read_b128 v[80:83], v12 offset:2048
    s_mov_b64 exec, s[14:15]
    ds_read_b128 v[96:99], v13 offset:1024
    ds_read_b128 v[100:103], v13 offset:1536
    s_mov_b64 exec, -1
    s_add_u32 s5, s91, 0
    s_and_b32 s5, s5, 7
    s_lshl_b32 s5, s5, 7
    s_add_u32 s5, s5, 0
    buffer_load_dwordx4 v[128:131], v104, s[56:59], s5 offen offset:0
    v_exp_f32 v39, v39
    v_cvt_pk_bf16_f32 v32, v32, v33
    v_cvt_pk_bf16_f32 v33, v34, v35
    v_cvt_pk_bf16_f32 v34, v36, v37
    v_cvt_pk_bf16_f32 v35, v38, v39
    v_exp_f32 v40, v40
    v_exp_f32 v41, v41
    v_exp_f32 v42, v42
    v_exp_f32 v43, v43
    v_mfma_f32_32x32x16_bf16 v[64:79], v[88:91], v[32:35], v[64:79]
    v_exp_f32 v44, v44
    v_exp_f32 v45, v45
    v_exp_f32 v46, v46
    v_exp_f32 v47, v47
    v_cvt_pk_bf16_f32 v40, v40, v41
    v_cvt_pk_bf16_f32 v41, v42, v43
    v_cvt_pk_bf16_f32 v42, v44, v45
    v_cvt_pk_bf16_f32 v43, v46, v47
    v_exp_f32 v48, v48
    v_exp_f32 v49, v49
    v_mfma_f32_32x32x16_bf16 v[64:79], v[92:95], v[40:43], v[64:79]
    v_exp_f32 v50, v50
    v_exp_f32 v51, v51
    v_exp_f32 v52, v52
    v_exp_f32 v53, v53
    v_exp_f32 v54, v54
    s_waitcnt lgkmcnt(0)
    v_mfma_f32_32x32x16_bf16 v[32:47], v[80:83], v[4:7], v[16:31]
    ds_read_b128 v[84:87], v12 offset:3072
    s_mov_b64 exec, s[14:15]
    ds_read_b128 v[88:91], v13 offset:2048
    ds_read_b128 v[92:95], v13 offset:2560
    s_mov_b64 exec, -1
    buffer_load_dwordx4 v[132:135], v104, s[56:59], s5 offen offset:64
    v_exp_f32 v55, v55
    v_cvt_pk_bf16_f32 v48, v48, v49
    v_cvt_pk_bf16_f32 v49, v50, v51
    v_cvt_pk_bf16_f32 v50, v52, v53
    v_cvt_pk_bf16_f32 v51, v54, v55
    v_exp_f32 v56, v56
    v_exp_f32 v57, v57
    v_exp_f32 v58, v58
    v_exp_f32 v59, v59
    v_mfma_f32_32x32x16_bf16 v[64:79], v[96:99], v[48:51], v[64:79]
    v_exp_f32 v60, v60
    v_exp_f32 v61, v61
    v_exp_f32 v62, v62
    v_exp_f32 v63, v63
    v_cvt_pk_bf16_f32 v56, v56, v57
    v_cvt_pk_bf16_f32 v57, v58, v59
    v_cvt_pk_bf16_f32 v58, v60, v61
    v_cvt_pk_bf16_f32 v59, v62, v63
    v_exp_f32 v32, v32
    v_exp_f32 v33, v33
    v_mfma_f32_32x32x16_bf16 v[64:79], v[100:103], v[56:59], v[64:79]
    v_exp_f32 v34, v34
    v_exp_f32 v35, v35
    v_exp_f32 v36, v36
    v_exp_f32 v37, v37
    v_exp_f32 v38, v38
    s_waitcnt lgkmcnt(0)
    v_mfma_f32_32x32x16_bf16 v[48:63], v[84:87], v[4:7], v[16:31]
    ds_read_b128 v[80:83], v12 offset:4096
    s_mov_b64 exec, s[14:15]
    ds_read_b128 v[96:99], v13 offset:3072
    ds_read_b128 v[100:103], v13 offset:3584
    s_mov_b64 exec, -1
    v_exp_f32 v39, v39
    v_cvt_pk_bf16_f32 v32, v32, v33
    v_cvt_pk_bf16_f32 v33, v34, v35
    v_cvt_pk_bf16_f32 v34, v36, v37
    v_cvt_pk_bf16_f32 v35, v38, v39
    v_exp_f32 v40, v40
    v_exp_f32 v41, v41
    v_exp_f32 v42, v42
    v_exp_f32 v43, v43
    v_mfma_f32_32x32x16_bf16 v[64:79], v[88:91], v[32:35], v[64:79]
    v_exp_f32 v44, v44
    v_exp_f32 v45, v45
    v_exp_f32 v46, v46
    v_exp_f32 v47, v47
    v_cvt_pk_bf16_f32 v40, v40, v41
    v_cvt_pk_bf16_f32 v41, v42, v43
    v_cvt_pk_bf16_f32 v42, v44, v45
    v_cvt_pk_bf16_f32 v43, v46, v47
    v_exp_f32 v48, v48
    v_exp_f32 v49, v49
    v_mfma_f32_32x32x16_bf16 v[64:79], v[92:95], v[40:43], v[64:79]
    v_exp_f32 v50, v50
    v_exp_f32 v51, v51
    v_exp_f32 v52, v52
    v_exp_f32 v53, v53
    v_exp_f32 v54, v54
    s_waitcnt lgkmcnt(0)
    v_mfma_f32_32x32x16_bf16 v[32:47], v[80:83], v[4:7], v[16:31]
    ds_read_b128 v[84:87], v12 offset:5120
    s_mov_b64 exec, s[14:15]
    ds_read_b128 v[88:91], v13 offset:4096
    ds_read_b128 v[92:95], v13 offset:4608
    s_mov_b64 exec, -1
    s_add_u32 s5, s91, 1
    s_and_b32 s5, s5, 7
    s_lshl_b32 s5, s5, 7
    s_add_u32 s5, s5, 0
    buffer_load_dwordx4 v[136:139], v104, s[56:59], s5 offen offset:0
    v_exp_f32 v55, v55
    v_cvt_pk_bf16_f32 v48, v48, v49
    v_cvt_pk_bf16_f32 v49, v50, v51
    v_cvt_pk_bf16_f32 v50, v52, v53
    v_cvt_pk_bf16_f32 v51, v54, v55
    v_exp_f32 v56, v56
    v_exp_f32 v57, v57
    v_exp_f32 v58, v58
    v_exp_f32 v59, v59
    v_mfma_f32_32x32x16_bf16 v[64:79], v[96:99], v[48:51], v[64:79]
    v_exp_f32 v60, v60
    v_exp_f32 v61, v61
    v_exp_f32 v62, v62
    v_exp_f32 v63, v63
    v_cvt_pk_bf16_f32 v56, v56, v57
    v_cvt_pk_bf16_f32 v57, v58, v59
    v_cvt_pk_bf16_f32 v58, v60, v61
    v_cvt_pk_bf16_f32 v59, v62, v63
    v_exp_f32 v32, v32
    v_exp_f32 v33, v33
    v_mfma_f32_32x32x16_bf16 v[64:79], v[100:103], v[56:59], v[64:79]
    v_exp_f32 v34, v34
    v_exp_f32 v35, v35
    v_exp_f32 v36, v36
    v_exp_f32 v37, v37
    v_exp_f32 v38, v38
    s_waitcnt lgkmcnt(0)
    v_mfma_f32_32x32x16_bf16 v[48:63], v[84:87], v[4:7], v[16:31]
    ds_read_b128 v[80:83], v12 offset:6144
    s_mov_b64 exec, s[14:15]
    ds_read_b128 v[96:99], v13 offset:5120
    ds_read_b128 v[100:103], v13 offset:5632
    s_mov_b64 exec, -1
    buffer_load_dwordx4 v[140:143], v104, s[56:59], s5 offen offset:64
    v_exp_f32 v39, v39
    v_cvt_pk_bf16_f32 v32, v32, v33
    v_cvt_pk_bf16_f32 v33, v34, v35
    v_cvt_pk_bf16_f32 v34, v36, v37
    v_cvt_pk_bf16_f32 v35, v38, v39
    v_exp_f32 v40, v40
    v_exp_f32 v41, v41
    v_exp_f32 v42, v42
    v_exp_f32 v43, v43
    v_mfma_f32_32x32x16_bf16 v[64:79], v[88:91], v[32:35], v[64:79]
    v_exp_f32 v44, v44
    v_exp_f32 v45, v45
    v_exp_f32 v46, v46
    v_exp_f32 v47, v47
    v_cvt_pk_bf16_f32 v40, v40, v41
    v_cvt_pk_bf16_f32 v41, v42, v43
    v_cvt_pk_bf16_f32 v42, v44, v45
    v_cvt_pk_bf16_f32 v43, v46, v47
    v_exp_f32 v48, v48
    v_exp_f32 v49, v49
    v_mfma_f32_32x32x16_bf16 v[64:79], v[92:95], v[40:43], v[64:79]
    v_exp_f32 v50, v50
    v_exp_f32 v51, v51
    v_exp_f32 v52, v52
    v_exp_f32 v53, v53
    v_exp_f32 v54, v54
    s_waitcnt lgkmcnt(0)
    v_mfma_f32_32x32x16_bf16 v[32:47], v[80:83], v[4:7], v[16:31]
    ds_read_b128 v[84:87], v12 offset:7168
    s_mov_b64 exec, s[14:15]
    ds_read_b128 v[88:91], v13 offset:6144
    ds_read_b128 v[92:95], v13 offset:6656
    s_mov_b64 exec, -1
    v_exp_f32 v55, v55
    v_cvt_pk_bf16_f32 v48, v48, v49
    v_cvt_pk_bf16_f32 v49, v50, v51
    v_cvt_pk_bf16_f32 v50, v52, v53
    v_cvt_pk_bf16_f32 v51, v54, v55
    v_exp_f32 v56, v56
    v_exp_f32 v57, v57
    v_exp_f32 v58, v58
    v_exp_f32 v59, v59
    v_mfma_f32_32x32x16_bf16 v[64:79], v[96:99], v[48:51], v[64:79]
    v_exp_f32 v60, v60
    v_exp_f32 v61, v61
    v_exp_f32 v62, v62
    v_exp_f32 v63, v63
    v_cvt_pk_bf16_f32 v56, v56, v57
    v_cvt_pk_bf16_f32 v57, v58, v59
    v_cvt_pk_bf16_f32 v58, v60, v61
    v_cvt_pk_bf16_f32 v59, v62, v63
    v_exp_f32 v32, v32
    v_exp_f32 v33, v33
    v_mfma_f32_32x32x16_bf16 v[64:79], v[100:103], v[56:59], v[64:79]
    v_exp_f32 v34, v34
    v_exp_f32 v35, v35
    v_exp_f32 v36, v36
    v_exp_f32 v37, v37
    v_exp_f32 v38, v38
    s_waitcnt lgkmcnt(0)
    v_mfma_f32_32x32x16_bf16 v[48:63], v[84:87], v[4:7], v[16:31]
    ds_read_b128 v[80:83], v12 offset:8192
    s_mov_b64 exec, s[14:15]
    ds_read_b128 v[96:99], v13 offset:7168
    ds_read_b128 v[100:103], v13 offset:7680
    s_mov_b64 exec, -1
    s_add_u32 s5, s91, 2
    s_and_b32 s5, s5, 7
    s_lshl_b32 s5, s5, 7
    s_add_u32 s5, s5, 0
    buffer_load_dwordx4 v[144:147], v104, s[56:59], s5 offen offset:0
    v_exp_f32 v39, v39
    v_cvt_pk_bf16_f32 v32, v32, v33
    v_cvt_pk_bf16_f32 v33, v34, v35
    v_cvt_pk_bf16_f32 v34, v36, v37
    v_cvt_pk_bf16_f32 v35, v38, v39
    v_exp_f32 v40, v40
    v_exp_f32 v41, v41
    v_exp_f32 v42, v42
    v_exp_f32 v43, v43
    v_mfma_f32_32x32x16_bf16 v[64:79], v[88:91], v[32:35], v[64:79]
    v_exp_f32 v44, v44
    v_exp_f32 v45, v45
    v_exp_f32 v46, v46
    v_exp_f32 v47, v47
    v_cvt_pk_bf16_f32 v40, v40, v41
    v_cvt_pk_bf16_f32 v41, v42, v43
    v_cvt_pk_bf16_f32 v42, v44, v45
    v_cvt_pk_bf16_f32 v43, v46, v47
    v_exp_f32 v48, v48
    v_exp_f32 v49, v49
    v_mfma_f32_32x32x16_bf16 v[64:79], v[92:95], v[40:43], v[64:79]
    v_exp_f32 v50, v50
    v_exp_f32 v51, v51
    v_exp_f32 v52, v52
    v_exp_f32 v53, v53
    v_exp_f32 v54, v54
    s_waitcnt lgkmcnt(0)
    v_mfma_f32_32x32x16_bf16 v[32:47], v[80:83], v[4:7], v[16:31]
    ds_read_b128 v[84:87], v12 offset:9216
    s_mov_b64 exec, s[14:15]
    ds_read_b128 v[88:91], v13 offset:8192
    ds_read_b128 v[92:95], v13 offset:8704
    s_mov_b64 exec, -1
    buffer_load_dwordx4 v[148:151], v104, s[56:59], s5 offen offset:64
    v_exp_f32 v55, v55
    v_cvt_pk_bf16_f32 v48, v48, v49
    v_cvt_pk_bf16_f32 v49, v50, v51
    v_cvt_pk_bf16_f32 v50, v52, v53
    v_cvt_pk_bf16_f32 v51, v54, v55
    v_exp_f32 v56, v56
    v_exp_f32 v57, v57
    v_exp_f32 v58, v58
    v_exp_f32 v59, v59
    v_mfma_f32_32x32x16_bf16 v[64:79], v[96:99], v[48:51], v[64:79]
    v_exp_f32 v60, v60
    v_exp_f32 v61, v61
    v_exp_f32 v62, v62
    v_exp_f32 v63, v63
    v_cvt_pk_bf16_f32 v56, v56, v57
    v_cvt_pk_bf16_f32 v57, v58, v59
    v_cvt_pk_bf16_f32 v58, v60, v61
    v_cvt_pk_bf16_f32 v59, v62, v63
    v_add_u32 v12, 8192, v12
    v_add_u32 v13, 8192, v13
    s_cmp_ge_u32 s3, 4
    s_cbranch_scc0 pr_17010_a
    s_setprio 1
    s_branch pr_17010_b
pr_17010_a:
    s_setprio 0
pr_17010_b:
    v_exp_f32 v32, v32
    v_exp_f32 v33, v33
    v_mfma_f32_32x32x16_bf16 v[64:79], v[100:103], v[56:59], v[64:79]
    v_exp_f32 v34, v34
    v_exp_f32 v35, v35
    v_exp_f32 v36, v36
    v_exp_f32 v37, v37
    v_exp_f32 v38, v38
    s_waitcnt lgkmcnt(0)
    v_mfma_f32_32x32x16_bf16 v[48:63], v[84:87], v[4:7], v[16:31]
    ds_read_b128 v[80:83], v12 offset:2048
    s_mov_b64 exec, s[14:15]
    ds_read_b128 v[96:99], v13 offset:1024
    ds_read_b128 v[100:103], v13 offset:1536
    s_mov_b64 exec, -1
    v_exp_f32 v39, v39
    v_cvt_pk_bf16_f32 v32, v32, v33
    v_cvt_pk_bf16_f32 v33, v34, v35
    v_cvt_pk_bf16_f32 v34, v36, v37
    v_cvt_pk_bf16_f32 v35, v38, v39
    v_exp_f32 v40, v40
    v_exp_f32 v41, v41
    v_exp_f32 v42, v42
    v_exp_f32 v43, v43
    v_mfma_f32_32x32x16_bf16 v[64:79], v[88:91], v[32:35], v[64:79]
    v_exp_f32 v44, v44
    v_exp_f32 v45, v45
    v_exp_f32 v46, v46
    v_exp_f32 v47, v47
    v_cvt_pk_bf16_f32 v40, v40, v41
    v_cvt_pk_bf16_f32 v41, v42, v43
    v_cvt_pk_bf16_f32 v42, v44, v45
    v_cvt_pk_bf16_f32 v43, v46, v47
    v_exp_f32 v48, v48
    v_exp_f32 v49, v49
    v_mfma_f32_32x32x16_bf16 v[64:79], v[92:95], v[40:43], v[64:79]
    v_exp_f32 v50, v50
    v_exp_f32 v51, v51
    v_exp_f32 v52, v52
    v_exp_f32 v53, v53
    v_exp_f32 v54, v54
    s_waitcnt lgkmcnt(0)
    v_mfma_f32_32x32x16_bf16 v[32:47], v[80:83], v[4:7], v[16:31]
    ds_read_b128 v[84:87], v12 offset:3072
    s_mov_b64 exec, s[14:15]
    ds_read_b128 v[88:91], v13 offset:2048
    ds_read_b128 v[92:95], v13 offset:2560
    s_mov_b64 exec, -1
    s_add_u32 s5, s91, 3
    s_and_b32 s5, s5, 7
    s_lshl_b32 s5, s5, 7
    s_add_u32 s5, s5, 0
    buffer_load_dwordx4 v[152:155], v104, s[56:59], s5 offen offset:0
    v_exp_f32 v55, v55
    v_cvt_pk_bf16_f32 v48, v48, v49
    v_cvt_pk_bf16_f32 v49, v50, v51
    v_cvt_pk_bf16_f32 v50, v52, v53
    v_cvt_pk_bf16_f32 v51, v54, v55
    v_exp_f32 v56, v56
    v_exp_f32 v57, v57
    v_exp_f32 v58, v58
    v_exp_f32 v59, v59
    v_mfma_f32_32x32x16_bf16 v[64:79], v[96:99], v[48:51], v[64:79]
    v_exp_f32 v60, v60
    v_exp_f32 v61, v61
    v_exp_f32 v62, v62
    v_exp_f32 v63, v63
    v_cvt_pk_bf16_f32 v56, v56, v57
    v_cvt_pk_bf16_f32 v57, v58, v59
    v_cvt_pk_bf16_f32 v58, v60, v61
    v_cvt_pk_bf16_f32 v59, v62, v63
    v_exp_f32 v32, v32
    v_exp_f32 v33, v33
    v_mfma_f32_32x32x16_bf16 v[64:79], v[100:103], v[56:59], v[64:79]
    v_exp_f32 v34, v34
    v_exp_f32 v35, v35
    v_exp_f32 v36, v36
    v_exp_f32 v37, v37
    v_exp_f32 v38, v38
    s_waitcnt lgkmcnt(0)
    v_mfma_f32_32x32x16_bf16 v[48:63], v[84:87], v[4:7], v[16:31]
    ds_read_b128 v[80:83], v12 offset:4096
    s_mov_b64 exec, s[14:15]
    ds_read_b128 v[96:99], v13 offset:3072
    ds_read_b128 v[100:103], v13 offset:3584
    s_mov_b64 exec, -1
    buffer_load_dwordx4 v[156:159], v104, s[56:59], s5 offen offset:64
    v_exp_f32 v39, v39
    v_cvt_pk_bf16_f32 v32, v32, v33
    v_cvt_pk_bf16_f32 v33, v34, v35
    v_cvt_pk_bf16_f32 v34, v36, v37
    v_cvt_pk_bf16_f32 v35, v38, v39
    v_exp_f32 v40, v40
    v_exp_f32 v41, v41
    v_exp_f32 v42, v42
    v_exp_f32 v43, v43
    v_mfma_f32_32x32x16_bf16 v[64:79], v[88:91], v[32:35], v[64:79]
    v_exp_f32 v44, v44
    v_exp_f32 v45, v45
    v_exp_f32 v46, v46
    v_exp_f32 v47, v47
    v_cvt_pk_bf16_f32 v40, v40, v41
    v_cvt_pk_bf16_f32 v41, v42, v43
    v_cvt_pk_bf16_f32 v42, v44, v45
    v_cvt_pk_bf16_f32 v43, v46, v47
    v_exp_f32 v48, v48
    v_exp_f32 v49, v49
    v_mfma_f32_32x32x16_bf16 v[64:79], v[92:95], v[40:43], v[64:79]
    v_exp_f32 v50, v50
    v_exp_f32 v51, v51
    v_exp_f32 v52, v52
    v_exp_f32 v53, v53
    v_exp_f32 v54, v54
    s_waitcnt lgkmcnt(0)
    v_mfma_f32_32x32x16_bf16 v[32:47], v[80:83], v[4:7], v[16:31]
    ds_read_b128 v[84:87], v12 offset:5120
    s_mov_b64 exec, s[14:15]
    ds_read_b128 v[88:91], v13 offset:4096
    ds_read_b128 v[92:95], v13 offset:4608
    s_mov_b64 exec, -1
    v_exp_f32 v55, v55
    v_cvt_pk_bf16_f32 v48, v48, v49
    v_cvt_pk_bf16_f32 v49, v50, v51
    v_cvt_pk_bf16_f32 v50, v52, v53
    v_cvt_pk_bf16_f32 v51, v54, v55
    v_exp_f32 v56, v56
    v_exp_f32 v57, v57
    v_exp_f32 v58, v58
    v_exp_f32 v59, v59
    v_mfma_f32_32x32x16_bf16 v[64:79], v[96:99], v[48:51], v[64:79]
    v_exp_f32 v60, v60
    v_exp_f32 v61, v61
    v_exp_f32 v62, v62
    v_exp_f32 v63, v63
    v_cvt_pk_bf16_f32 v56, v56, v57
    v_cvt_pk_bf16_f32 v57, v58, v59
    v_cvt_pk_bf16_f32 v58, v60, v61
    v_cvt_pk_bf16_f32 v59, v62, v63
    v_exp_f32 v32, v32
    v_exp_f32 v33, v33
    v_mfma_f32_32x32x16_bf16 v[64:79], v[100:103], v[56:59], v[64:79]
    v_exp_f32 v34, v34
    v_exp_f32 v35, v35
    v_exp_f32 v36, v36
    v_exp_f32 v37, v37
    v_exp_f32 v38, v38
    s_waitcnt lgkmcnt(0)
    v_mfma_f32_32x32x16_bf16 v[48:63], v[84:87], v[4:7], v[16:31]
    ds_read_b128 v[80:83], v12 offset:6144
    s_mov_b64 exec, s[14:15]
    ds_read_b128 v[96:99], v13 offset:5120
    ds_read_b128 v[100:103], v13 offset:5632
    s_mov_b64 exec, -1
    s_add_u32 s5, s91, 4
    s_and_b32 s5, s5, 7
    s_lshl_b32 s5, s5, 7
    s_add_u32 s5, s5, 0
    buffer_load_dwordx4 v[160:163], v104, s[56:59], s5 offen offset:0
    v_exp_f32 v39, v39
    v_cvt_pk_bf16_f32 v32, v32, v33
    v_cvt_pk_bf16_f32 v33, v34, v35
    v_cvt_pk_bf16_f32 v34, v36, v37
    v_cvt_pk_bf16_f32 v35, v38, v39
    v_exp_f32 v40, v40
    v_exp_f32 v41, v41
    v_exp_f32 v42, v42
    v_exp_f32 v43, v43
    v_mfma_f32_32x32x16_bf16 v[64:79], v[88:91], v[32:35], v[64:79]
    v_exp_f32 v44, v44
    v_exp_f32 v45, v45
    v_exp_f32 v46, v46
    v_exp_f32 v47, v47
    v_cvt_pk_bf16_f32 v40, v40, v41
    v_cvt_pk_bf16_f32 v41, v42, v43
    v_cvt_pk_bf16_f32 v42, v44, v45
    v_cvt_pk_bf16_f32 v43, v46, v47
    v_exp_f32 v48, v48
    v_exp_f32 v49, v49
    v_mfma_f32_32x32x16_bf16 v[64:79], v[92:95], v[40:43], v[64:79]
    v_exp_f32 v50, v50
    v_exp_f32 v51, v51
    v_exp_f32 v52, v52
    v_exp_f32 v53, v53
    v_exp_f32 v54, v54
    s_waitcnt lgkmcnt(0)
    v_mfma_f32_32x32x16_bf16 v[32:47], v[80:83], v[4:7], v[16:31]
    ds_read_b128 v[84:87], v12 offset:7168
    s_mov_b64 exec, s[14:15]
    ds_read_b128 v[88:91], v13 offset:6144
    ds_read_b128 v[92:95], v13 offset:6656
    s_mov_b64 exec, -1
    buffer_load_dwordx4 v[164:167], v104, s[56:59], s5 offen offset:64
    v_exp_f32 v55, v55
    v_cvt_pk_bf16_f32 v48, v48, v49
    v_cvt_pk_bf16_f32 v49, v50, v51
    v_cvt_pk_bf16_f32 v50, v52, v53
    v_cvt_pk_bf16_f32 v51, v54, v55
    v_exp_f32 v56, v56
    v_exp_f32 v57, v57
    v_exp_f32 v58, v58
    v_exp_f32 v59, v59
    v_mfma_f32_32x32x16_bf16 v[64:79], v[96:99], v[48:51], v[64:79]
    v_exp_f32 v60, v60
    v_exp_f32 v61, v61
    v_exp_f32 v62, v62
    v_exp_f32 v63, v63
    v_cvt_pk_bf16_f32 v56, v56, v57
    v_cvt_pk_bf16_f32 v57, v58, v59
    v_cvt_pk_bf16_f32 v58, v60, v61
    v_cvt_pk_bf16_f32 v59, v62, v63
    v_exp_f32 v32, v32
    v_exp_f32 v33, v33
    v_mfma_f32_32x32x16_bf16 v[64:79], v[100:103], v[56:59], v[64:79]
    v_exp_f32 v34, v34
    v_exp_f32 v35, v35
    v_exp_f32 v36, v36
    v_exp_f32 v37, v37
    v_exp_f32 v38, v38
    s_waitcnt lgkmcnt(0)
    v_mfma_f32_32x32x16_bf16 v[48:63], v[84:87], v[4:7], v[16:31]
    ds_read_b128 v[80:83], v12 offset:8192
    s_mov_b64 exec, s[14:15]
    ds_read_b128 v[96:99], v13 offset:7168
    ds_read_b128 v[100:103], v13 offset:7680
    s_mov_b64 exec, -1
    v_exp_f32 v39, v39
    v_cvt_pk_bf16_f32 v32, v32, v33
    v_cvt_pk_bf16_f32 v33, v34, v35
    v_cvt_pk_bf16_f32 v34, v36, v37
    v_cvt_pk_bf16_f32 v35, v38, v39
    v_exp_f32 v40, v40
    v_exp_f32 v41, v41
    v_exp_f32 v42, v42
    v_exp_f32 v43, v43
    v_mfma_f32_32x32x16_bf16 v[64:79], v[88:91], v[32:35], v[64:79]
    v_exp_f32 v44, v44
    v_exp_f32 v45, v45
    v_exp_f32 v46, v46
    v_exp_f32 v47, v47
    v_cvt_pk_bf16_f32 v40, v40, v41
    v_cvt_pk_bf16_f32 v41, v42, v43
    v_cvt_pk_bf16_f32 v42, v44, v45
    v_cvt_pk_bf16_f32 v43, v46, v47
    v_exp_f32 v48, v48
    v_exp_f32 v49, v49
    v_mfma_f32_32x32x16_bf16 v[64:79], v[92:95], v[40:43], v[64:79]
    v_exp_f32 v50, v50
    v_exp_f32 v51, v51
    v_exp_f32 v52, v52
    v_exp_f32 v53, v53
    v_exp_f32 v54, v54
    s_waitcnt lgkmcnt(0)
    v_mfma_f32_32x32x16_bf16 v[32:47], v[80:83], v[4:7], v[16:31]
    ds_read_b128 v[84:87], v12 offset:9216
    s_mov_b64 exec, s[14:15]
    ds_read_b128 v[88:91], v13 offset:8192
    ds_read_b128 v[92:95], v13 offset:8704
    s_mov_b64 exec, -1
    s_add_u32 s5, s91, 5
    s_and_b32 s5, s5, 7
    s_lshl_b32 s5, s5, 7
    s_add_u32 s5, s5, 0
    buffer_load_dwordx4 v[168:171], v104, s[56:59], s5 offen offset:0
    v_exp_f32 v55, v55
    v_cvt_pk_bf16_f32 v48, v48, v49
    v_cvt_pk_bf16_f32 v49, v50, v51
    v_cvt_pk_bf16_f32 v50, v52, v53
    v_cvt_pk_bf16_f32 v51, v54, v55
    v_exp_f32 v56, v56
    v_exp_f32 v57, v57
    v_exp_f32 v58, v58
    v_exp_f32 v59, v59
    v_mfma_f32_32x32x16_bf16 v[64:79], v[96:99], v[48:51], v[64:79]
    v_exp_f32 v60, v60
    v_exp_f32 v61, v61
    v_exp_f32 v62, v62
    v_exp_f32 v63, v63
    v_cvt_pk_bf16_f32 v56, v56, v57
    v_cvt_pk_bf16_f32 v57, v58, v59
    v_cvt_pk_bf16_f32 v58, v60, v61
    v_cvt_pk_bf16_f32 v59, v62, v63
    v_add_u32 v12, 8192, v12
    v_add_u32 v13, 8192, v13
    s_cmp_ge_u32 s3, 4
    s_cbranch_scc0 pr_17011_a
    s_setprio 1
    s_branch pr_17011_b
pr_17011_a:
    s_setprio 0
pr_17011_b:
    v_exp_f32 v32, v32
    v_exp_f32 v33, v33
    v_mfma_f32_32x32x16_bf16 v[64:79], v[100:103], v[56:59], v[64:79]
    v_exp_f32 v34, v34
    v_exp_f32 v35, v35
    v_exp_f32 v36, v36
    v_exp_f32 v37, v37
    v_exp_f32 v38, v38
    s_waitcnt lgkmcnt(0)
    v_mfma_f32_32x32x16_bf16 v[48:63], v[84:87], v[4:7], v[16:31]
    ds_read_b128 v[80:83], v12 offset:2048
    s_mov_b64 exec, s[14:15]
    ds_read_b128 v[96:99], v13 offset:1024
    ds_read_b128 v[100:103], v13 offset:1536
    s_mov_b64 exec, -1
    buffer_load_dwordx4 v[172:175], v104, s[56:59], s5 offen offset:64
    v_exp_f32 v39, v39
    v_cvt_pk_bf16_f32 v32, v32, v33
    v_cvt_pk_bf16_f32 v33, v34, v35
    v_cvt_pk_bf16_f32 v34, v36, v37
    v_cvt_pk_bf16_f32 v35, v38, v39
    v_exp_f32 v40, v40
    v_exp_f32 v41, v41
    v_exp_f32 v42, v42
    v_exp_f32 v43, v43
    v_mfma_f32_32x32x16_bf16 v[64:79], v[88:91], v[32:35], v[64:79]
    v_exp_f32 v44, v44
    v_exp_f32 v45, v45
    v_exp_f32 v46, v46
    v_exp_f32 v47, v47
    v_cvt_pk_bf16_f32 v40, v40, v41
    v_cvt_pk_bf16_f32 v41, v42, v43
    v_cvt_pk_bf16_f32 v42, v44, v45
    v_cvt_pk_bf16_f32 v43, v46, v47
    v_exp_f32 v48, v48
    v_exp_f32 v49, v49
    v_mfma_f32_32x32x16_bf16 v[64:79], v[92:95], v[40:43], v[64:79]
    v_exp_f32 v50, v50
    v_exp_f32 v51, v51
    v_exp_f32 v52, v52
    v_exp_f32 v53, v53
    v_exp_f32 v54, v54
    s_waitcnt lgkmcnt(0)
    v_mfma_f32_32x32x16_bf16 v[32:47], v[80:83], v[4:7], v[16:31]
    ds_read_b128 v[84:87], v12 offset:3072
    s_mov_b64 exec, s[14:15]
    ds_read_b128 v[88:91], v13 offset:2048
    ds_read_b128 v[92:95], v13 offset:2560
    s_mov_b64 exec, -1
    v_exp_f32 v55, v55
    v_cvt_pk_bf16_f32 v48, v48, v49
    v_cvt_pk_bf16_f32 v49, v50, v51
    v_cvt_pk_bf16_f32 v50, v52, v53
    v_cvt_pk_bf16_f32 v51, v54, v55
    v_exp_f32 v56, v56
    v_exp_f32 v57, v57
    v_exp_f32 v58, v58
    v_exp_f32 v59, v59
    v_mfma_f32_32x32x16_bf16 v[64:79], v[96:99], v[48:51], v[64:79]
    v_exp_f32 v60, v60
    v_exp_f32 v61, v61
    v_exp_f32 v62, v62
    v_exp_f32 v63, v63
    v_cvt_pk_bf16_f32 v56, v56, v57
    v_cvt_pk_bf16_f32 v57, v58, v59
    v_cvt_pk_bf16_f32 v58, v60, v61
    v_cvt_pk_bf16_f32 v59, v62, v63
    v_exp_f32 v32, v32
    v_exp_f32 v33, v33
    v_mfma_f32_32x32x16_bf16 v[64:79], v[100:103], v[56:59], v[64:79]
    v_exp_f32 v34, v34
    v_exp_f32 v35, v35
    v_exp_f32 v36, v36
    v_exp_f32 v37, v37
    v_exp_f32 v38, v38
    s_waitcnt lgkmcnt(0)
    v_mfma_f32_32x32x16_bf16 v[48:63], v[84:87], v[4:7], v[16:31]
    ds_read_b128 v[80:83], v12 offset:4096
    s_mov_b64 exec, s[14:15]
    ds_read_b128 v[96:99], v13 offset:3072
    ds_read_b128 v[100:103], v13 offset:3584
    s_mov_b64 exec, -1
    s_add_u32 s5, s91, 6
    s_and_b32 s5, s5, 7
    s_lshl_b32 s5, s5, 7
    s_add_u32 s5, s5, 0
    buffer_load_dwordx4 v[176:179], v104, s[56:59], s5 offen offset:0
    v_exp_f32 v39, v39
    v_cvt_pk_bf16_f32 v32, v32, v33
    v_cvt_pk_bf16_f32 v33, v34, v35
    v_cvt_pk_bf16_f32 v34, v36, v37
    v_cvt_pk_bf16_f32 v35, v38, v39
    v_exp_f32 v40, v40
    v_exp_f32 v41, v41
    v_exp_f32 v42, v42
    v_exp_f32 v43, v43
    v_mfma_f32_32x32x16_bf16 v[64:79], v[88:91], v[32:35], v[64:79]
    v_exp_f32 v44, v44
    v_exp_f32 v45, v45
    v_exp_f32 v46, v46
    v_exp_f32 v47, v47
    v_cvt_pk_bf16_f32 v40, v40, v41
    v_cvt_pk_bf16_f32 v41, v42, v43
    v_cvt_pk_bf16_f32 v42, v44, v45
    v_cvt_pk_bf16_f32 v43, v46, v47
    v_exp_f32 v48, v48
    v_exp_f32 v49, v49
    v_mfma_f32_32x32x16_bf16 v[64:79], v[92:95], v[40:43], v[64:79]
    v_exp_f32 v50, v50
    v_exp_f32 v51, v51
    v_exp_f32 v52, v52
    v_exp_f32 v53, v53
    v_exp_f32 v54, v54
    s_waitcnt lgkmcnt(0)
    v_mfma_f32_32x32x16_bf16 v[32:47], v[80:83], v[4:7], v[16:31]
    ds_read_b128 v[84:87], v12 offset:5120
    s_mov_b64 exec, s[14:15]
    ds_read_b128 v[88:91], v13 offset:4096
    ds_read_b128 v[92:95], v13 offset:4608
    s_mov_b64 exec, -1
    v_exp_f32 v55, v55
    v_cvt_pk_bf16_f32 v48, v48, v49
    v_cvt_pk_bf16_f32 v49, v50, v51
    v_cvt_pk_bf16_f32 v50, v52, v53
    v_cvt_pk_bf16_f32 v51, v54, v55
    v_exp_f32 v56, v56
    v_exp_f32 v57, v57
    v_exp_f32 v58, v58
    v_exp_f32 v59, v59
    v_mfma_f32_32x32x16_bf16 v[64:79], v[96:99], v[48:51], v[64:79]
    v_exp_f32 v60, v60
    v_exp_f32 v61, v61
    v_exp_f32 v62, v62
    v_exp_f32 v63, v63
    v_cvt_pk_bf16_f32 v56, v56, v57
    v_cvt_pk_bf16_f32 v57, v58, v59
    v_cvt_pk_bf16_f32 v58, v60, v61
    v_cvt_pk_bf16_f32 v59, v62, v63
    v_exp_f32 v32, v32
    v_exp_f32 v33, v33
    v_mfma_f32_32x32x16_bf16 v[64:79], v[100:103], v[56:59], v[64:79]
    v_exp_f32 v34, v34
    v_exp_f32 v35, v35
    v_exp_f32 v36, v36
    v_exp_f32 v37, v37
    v_exp_f32 v38, v38
    s_waitcnt lgkmcnt(0)
    v_mfma_f32_32x32x16_bf16 v[48:63], v[84:87], v[4:7], v[16:31]
    ds_read_b128 v[80:83], v12 offset:6144
    s_mov_b64 exec, s[14:15]
    ds_read_b128 v[96:99], v13 offset:5120
    ds_read_b128 v[100:103], v13 offset:5632
    s_mov_b64 exec, -1
    buffer_load_dwordx4 v[180:183], v104, s[56:59], s5 offen offset:64
    v_exp_f32 v39, v39
    v_cvt_pk_bf16_f32 v32, v32, v33
    v_cvt_pk_bf16_f32 v33, v34, v35
    v_cvt_pk_bf16_f32 v34, v36, v37
    v_cvt_pk_bf16_f32 v35, v38, v39
    v_exp_f32 v40, v40
    v_exp_f32 v41, v41
    v_exp_f32 v42, v42
    v_exp_f32 v43, v43
    v_mfma_f32_32x32x16_bf16 v[64:79], v[88:91], v[32:35], v[64:79]
    v_exp_f32 v44, v44
    v_exp_f32 v45, v45
    v_exp_f32 v46, v46
    v_exp_f32 v47, v47
    v_cvt_pk_bf16_f32 v40, v40, v41
    v_cvt_pk_bf16_f32 v41, v42, v43
    v_cvt_pk_bf16_f32 v42, v44, v45
    v_cvt_pk_bf16_f32 v43, v46, v47
    v_exp_f32 v48, v48
    v_exp_f32 v49, v49
    v_mfma_f32_32x32x16_bf16 v[64:79], v[92:95], v[40:43], v[64:79]
    v_exp_f32 v50, v50
    v_exp_f32 v51, v51
    v_exp_f32 v52, v52
    v_exp_f32 v53, v53
    v_exp_f32 v54, v54
    s_waitcnt lgkmcnt(0)
    v_mfma_f32_32x32x16_bf16 v[32:47], v[80:83], v[4:7], v[16:31]
    ds_read_b128 v[84:87], v12 offset:7168
    s_mov_b64 exec, s[14:15]
    ds_read_b128 v[88:91], v13 offset:6144
    ds_read_b128 v[92:95], v13 offset:6656
    s_mov_b64 exec, -1
    s_add_u32 s5, s91, 7
    s_and_b32 s5, s5, 7
    s_lshl_b32 s5, s5, 7
    s_add_u32 s5, s5, 0
    buffer_load_dwordx4 v[184:187], v104, s[56:59], s5 offen offset:0
    v_exp_f32 v55, v55
    v_cvt_pk_bf16_f32 v48, v48, v49
    v_cvt_pk_bf16_f32 v49, v50, v51
    v_cvt_pk_bf16_f32 v50, v52, v53
    v_cvt_pk_bf16_f32 v51, v54, v55
    v_exp_f32 v56, v56
    v_exp_f32 v57, v57
    v_exp_f32 v58, v58
    v_exp_f32 v59, v59
    v_mfma_f32_32x32x16_bf16 v[64:79], v[96:99], v[48:51], v[64:79]
    v_exp_f32 v60, v60
    v_exp_f32 v61, v61
    v_exp_f32 v62, v62
    v_exp_f32 v63, v63
    v_cvt_pk_bf16_f32 v56, v56, v57
    v_cvt_pk_bf16_f32 v57, v58, v59
    v_cvt_pk_bf16_f32 v58, v60, v61
    v_cvt_pk_bf16_f32 v59, v62, v63
    v_exp_f32 v32, v32
    v_exp_f32 v33, v33
    v_mfma_f32_32x32x16_bf16 v[64:79], v[100:103], v[56:59], v[64:79]
    v_exp_f32 v34, v34
    v_exp_f32 v35, v35
    v_exp_f32 v36, v36
    v_exp_f32 v37, v37
    v_exp_f32 v38, v38
    s_waitcnt lgkmcnt(0)
    v_mfma_f32_32x32x16_bf16 v[48:63], v[84:87], v[4:7], v[16:31]
    ds_read_b128 v[80:83], v12 offset:8192
    s_mov_b64 exec, s[14:15]
    ds_read_b128 v[96:99], v13 offset:7168
    ds_read_b128 v[100:103], v13 offset:7680
    s_mov_b64 exec, -1
    v_exp_f32 v39, v39
    v_cvt_pk_bf16_f32 v32, v32, v33
    v_cvt_pk_bf16_f32 v33, v34, v35
    v_cvt_pk_bf16_f32 v34, v36, v37
    v_cvt_pk_bf16_f32 v35, v38, v39
    v_exp_f32 v40, v40
    v_exp_f32 v41, v41
    v_exp_f32 v42, v42
    v_exp_f32 v43, v43
    v_mfma_f32_32x32x16_bf16 v[64:79], v[88:91], v[32:35], v[64:79]
    v_exp_f32 v44, v44
    v_exp_f32 v45, v45
    v_exp_f32 v46, v46
    v_exp_f32 v47, v47
    v_cvt_pk_bf16_f32 v40, v40, v41
    v_cvt_pk_bf16_f32 v41, v42, v43
    v_cvt_pk_bf16_f32 v42, v44, v45
    v_cvt_pk_bf16_f32 v43, v46, v47
    v_exp_f32 v48, v48
    v_exp_f32 v49, v49
    v_mfma_f32_32x32x16_bf16 v[64:79], v[92:95], v[40:43], v[64:79]
    v_exp_f32 v50, v50
    v_exp_f32 v51, v51
    v_exp_f32 v52, v52
    v_exp_f32 v53, v53
    v_exp_f32 v54, v54
    s_waitcnt lgkmcnt(0)
    v_mfma_f32_32x32x16_bf16 v[32:47], v[80:83], v[4:7], v[16:31]
    ds_read_b128 v[84:87], v12 offset:9216
    s_mov_b64 exec, s[14:15]
    ds_read_b128 v[88:91], v13 offset:8192
    ds_read_b128 v[92:95], v13 offset:8704
    s_mov_b64 exec, -1
    buffer_load_dwordx4 v[188:191], v104, s[56:59], s5 offen offset:64
    v_exp_f32 v55, v55
    v_cvt_pk_bf16_f32 v48, v48, v49
    v_cvt_pk_bf16_f32 v49, v50, v51
    v_cvt_pk_bf16_f32 v50, v52, v53
    v_cvt_pk_bf16_f32 v51, v54, v55
    v_exp_f32 v56, v56
    v_exp_f32 v57, v57
    v_exp_f32 v58, v58
    v_exp_f32 v59, v59
    v_mfma_f32_32x32x16_bf16 v[64:79], v[96:99], v[48:51], v[64:79]
    v_exp_f32 v60, v60
    v_exp_f32 v61, v61
    v_exp_f32 v62, v62
    v_exp_f32 v63, v63
    v_cvt_pk_bf16_f32 v56, v56, v57
    v_cvt_pk_bf16_f32 v57, v58, v59
    v_cvt_pk_bf16_f32 v58, v60, v61
    v_cvt_pk_bf16_f32 v59, v62, v63
    v_add_u32 v12, 8192, v12
    v_add_u32 v13, 8192, v13
    s_cmp_ge_u32 s3, 4
    s_cbranch_scc0 pr_17012_a
    s_setprio 1
    s_branch pr_17012_b
pr_17012_a:
    s_setprio 0
pr_17012_b:
    v_exp_f32 v32, v32
    v_exp_f32 v33, v33
    v_mfma_f32_32x32x16_bf16 v[64:79], v[100:103], v[56:59], v[64:79]
    v_exp_f32 v34, v34
    v_exp_f32 v35, v35
    v_exp_f32 v36, v36
    v_exp_f32 v37, v37
    v_exp_f32 v38, v38
    s_waitcnt lgkmcnt(0)
    v_mfma_f32_32x32x16_bf16 v[48:63], v[84:87], v[4:7], v[16:31]
    ds_read_b128 v[80:83], v12 offset:2048
    s_mov_b64 exec, s[14:15]
    ds_read_b128 v[96:99], v13 offset:1024
    ds_read_b128 v[100:103], v13 offset:1536
    s_mov_b64 exec, -1
    s_add_u32 s5, s91, 0
    s_and_b32 s5, s5, 7
    s_lshl_b32 s5, s5, 7
    s_add_u32 s5, s5, 65536
    buffer_load_dwordx4 v[192:195], v104, s[56:59], s5 offen offset:0
    v_exp_f32 v39, v39
    v_cvt_pk_bf16_f32 v32, v32, v33
    v_cvt_pk_bf16_f32 v33, v34, v35
    v_cvt_pk_bf16_f32 v34, v36, v37
    v_cvt_pk_bf16_f32 v35, v38, v39
    v_exp_f32 v40, v40
    v_exp_f32 v41, v41
    v_exp_f32 v42, v42
    v_exp_f32 v43, v43
    v_mfma_f32_32x32x16_bf16 v[64:79], v[88:91], v[32:35], v[64:79]
    v_exp_f32 v44, v44
    v_exp_f32 v45, v45
    v_exp_f32 v46, v46
    v_exp_f32 v47, v47
    v_cvt_pk_bf16_f32 v40, v40, v41
    v_cvt_pk_bf16_f32 v41, v42, v43
    v_cvt_pk_bf16_f32 v42, v44, v45
    v_cvt_pk_bf16_f32 v43, v46, v47
    v_exp_f32 v48, v48
    v_exp_f32 v49, v49
    v_mfma_f32_32x32x16_bf16 v[64:79], v[92:95], v[40:43], v[64:79]
    v_exp_f32 v50, v50
    v_exp_f32 v51, v51
    v_exp_f32 v52, v52
    v_exp_f32 v53, v53
    v_exp_f32 v54, v54
    s_waitcnt lgkmcnt(0)
    v_mfma_f32_32x32x16_bf16 v[32:47], v[80:83], v[4:7], v[16:31]
    ds_read_b128 v[84:87], v12 offset:3072
    s_mov_b64 exec, s[14:15]
    ds_read_b128 v[88:91], v13 offset:2048
    ds_read_b128 v[92:95], v13 offset:2560
    s_mov_b64 exec, -1
    v_exp_f32 v55, v55
    v_cvt_pk_bf16_f32 v48, v48, v49
    v_cvt_pk_bf16_f32 v49, v50, v51
    v_cvt_pk_bf16_f32 v50, v52, v53
    v_cvt_pk_bf16_f32 v51, v54, v55
    v_exp_f32 v56, v56
    v_exp_f32 v57, v57
    v_exp_f32 v58, v58
    v_exp_f32 v59, v59
    v_mfma_f32_32x32x16_bf16 v[64:79], v[96:99], v[48:51], v[64:79]
    v_exp_f32 v60, v60
    v_exp_f32 v61, v61
    v_exp_f32 v62, v62
    v_exp_f32 v63, v63
    v_cvt_pk_bf16_f32 v56, v56, v57
    v_cvt_pk_bf16_f32 v57, v58, v59
    v_cvt_pk_bf16_f32 v58, v60, v61
    v_cvt_pk_bf16_f32 v59, v62, v63
    v_exp_f32 v32, v32
    v_exp_f32 v33, v33
    v_mfma_f32_32x32x16_bf16 v[64:79], v[100:103], v[56:59], v[64:79]
    v_exp_f32 v34, v34
    v_exp_f32 v35, v35
    v_exp_f32 v36, v36
    v_exp_f32 v37, v37
    v_exp_f32 v38, v38
    s_waitcnt lgkmcnt(0)
    v_mfma_f32_32x32x16_bf16 v[48:63], v[84:87], v[4:7], v[16:31]
    ds_read_b128 v[80:83], v12 offset:4096
    s_mov_b64 exec, s[14:15]
    ds_read_b128 v[96:99], v13 offset:3072
    ds_read_b128 v[100:103], v13 offset:3584
    s_mov_b64 exec, -1
    buffer_load_dwordx4 v[196:199], v104, s[56:59], s5 offen offset:64
    v_exp_f32 v39, v39
    v_cvt_pk_bf16_f32 v32, v32, v33
    v_cvt_pk_bf16_f32 v33, v34, v35
    v_cvt_pk_bf16_f32 v34, v36, v37
    v_cvt_pk_bf16_f32 v35, v38, v39
    v_exp_f32 v40, v40
    v_exp_f32 v41, v41
    v_exp_f32 v42, v42
    v_exp_f32 v43, v43
    v_mfma_f32_32x32x16_bf16 v[64:79], v[88:91], v[32:35], v[64:79]
    v_exp_f32 v44, v44
    v_exp_f32 v45, v45
    v_exp_f32 v46, v46
    v_exp_f32 v47, v47
    v_cvt_pk_bf16_f32 v40, v40, v41
    v_cvt_pk_bf16_f32 v41, v42, v43
    v_cvt_pk_bf16_f32 v42, v44, v45
    v_cvt_pk_bf16_f32 v43, v46, v47
    v_exp_f32 v48, v48
    v_exp_f32 v49, v49
    v_mfma_f32_32x32x16_bf16 v[64:79], v[92:95], v[40:43], v[64:79]
    v_exp_f32 v50, v50
    v_exp_f32 v51, v51
    v_exp_f32 v52, v52
    v_exp_f32 v53, v53
    v_exp_f32 v54, v54
    s_waitcnt lgkmcnt(0)
    v_mfma_f32_32x32x16_bf16 v[32:47], v[80:83], v[4:7], v[16:31]
    ds_read_b128 v[84:87], v12 offset:5120
    s_mov_b64 exec, s[14:15]
    ds_read_b128 v[88:91], v13 offset:4096
    ds_read_b128 v[92:95], v13 offset:4608
    s_mov_b64 exec, -1
    s_add_u32 s5, s91, 1
    s_and_b32 s5, s5, 7
    s_lshl_b32 s5, s5, 7
    s_add_u32 s5, s5, 65536
    buffer_load_dwordx4 v[200:203], v104, s[56:59], s5 offen offset:0
    v_exp_f32 v55, v55
    v_cvt_pk_bf16_f32 v48, v48, v49
    v_cvt_pk_bf16_f32 v49, v50, v51
    v_cvt_pk_bf16_f32 v50, v52, v53
    v_cvt_pk_bf16_f32 v51, v54, v55
    v_exp_f32 v56, v56
    v_exp_f32 v57, v57
    v_exp_f32 v58, v58
    v_exp_f32 v59, v59
    v_mfma_f32_32x32x16_bf16 v[64:79], v[96:99], v[48:51], v[64:79]
    v_exp_f32 v60, v60
    v_exp_f32 v61, v61
    v_exp_f32 v62, v62
    v_exp_f32 v63, v63
    v_cvt_pk_bf16_f32 v56, v56, v57
    v_cvt_pk_bf16_f32 v57, v58, v59
    v_cvt_pk_bf16_f32 v58, v60, v61
    v_cvt_pk_bf16_f32 v59, v62, v63
    v_exp_f32 v32, v32
    v_exp_f32 v33, v33
    v_mfma_f32_32x32x16_bf16 v[64:79], v[100:103], v[56:59], v[64:79]
    v_exp_f32 v34, v34
    v_exp_f32 v35, v35
    v_exp_f32 v36, v36
    v_exp_f32 v37, v37
    v_exp_f32 v38, v38
    s_waitcnt lgkmcnt(0)
    v_mfma_f32_32x32x16_bf16 v[48:63], v[84:87], v[4:7], v[16:31]
    ds_read_b128 v[80:83], v12 offset:6144
    s_mov_b64 exec, s[14:15]
    ds_read_b128 v[96:99], v13 offset:5120
    ds_read_b128 v[100:103], v13 offset:5632
    s_mov_b64 exec, -1
    v_exp_f32 v39, v39
    v_cvt_pk_bf16_f32 v32, v32, v33
    v_cvt_pk_bf16_f32 v33, v34, v35
    v_cvt_pk_bf16_f32 v34, v36, v37
    v_cvt_pk_bf16_f32 v35, v38, v39
    v_exp_f32 v40, v40
    v_exp_f32 v41, v41
    v_exp_f32 v42, v42
    v_exp_f32 v43, v43
    v_mfma_f32_32x32x16_bf16 v[64:79], v[88:91], v[32:35], v[64:79]
    v_exp_f32 v44, v44
    v_exp_f32 v45, v45
    v_exp_f32 v46, v46
    v_exp_f32 v47, v47
    v_cvt_pk_bf16_f32 v40, v40, v41
    v_cvt_pk_bf16_f32 v41, v42, v43
    v_cvt_pk_bf16_f32 v42, v44, v45
    v_cvt_pk_bf16_f32 v43, v46, v47
    v_exp_f32 v48, v48
    v_exp_f32 v49, v49
    v_mfma_f32_32x32x16_bf16 v[64:79], v[92:95], v[40:43], v[64:79]
    v_exp_f32 v50, v50
    v_exp_f32 v51, v51
    v_exp_f32 v52, v52
    v_exp_f32 v53, v53
    v_exp_f32 v54, v54
    s_waitcnt lgkmcnt(0)
    v_mfma_f32_32x32x16_bf16 v[32:47], v[80:83], v[4:7], v[16:31]
    ds_read_b128 v[84:87], v12 offset:7168
    s_mov_b64 exec, s[14:15]
    ds_read_b128 v[88:91], v13 offset:6144
    ds_read_b128 v[92:95], v13 offset:6656
    s_mov_b64 exec, -1
    buffer_load_dwordx4 v[204:207], v104, s[56:59], s5 offen offset:64
    v_exp_f32 v55, v55
    v_cvt_pk_bf16_f32 v48, v48, v49
    v_cvt_pk_bf16_f32 v49, v50, v51
    v_cvt_pk_bf16_f32 v50, v52, v53
    v_cvt_pk_bf16_f32 v51, v54, v55
    v_exp_f32 v56, v56
    v_exp_f32 v57, v57
    v_exp_f32 v58, v58
    v_exp_f32 v59, v59
    v_mfma_f32_32x32x16_bf16 v[64:79], v[96:99], v[48:51], v[64:79]
    v_exp_f32 v60, v60
    v_exp_f32 v61, v61
    v_exp_f32 v62, v62
    v_exp_f32 v63, v63
    v_cvt_pk_bf16_f32 v56, v56, v57
    v_cvt_pk_bf16_f32 v57, v58, v59
    v_cvt_pk_bf16_f32 v58, v60, v61
    v_cvt_pk_bf16_f32 v59, v62, v63
    v_exp_f32 v32, v32
    v_exp_f32 v33, v33
    v_mfma_f32_32x32x16_bf16 v[64:79], v[100:103], v[56:59], v[64:79]
    v_exp_f32 v34, v34
    v_exp_f32 v35, v35
    v_exp_f32 v36, v36
    v_exp_f32 v37, v37
    v_exp_f32 v38, v38
    s_waitcnt lgkmcnt(0)
    v_mfma_f32_32x32x16_bf16 v[48:63], v[84:87], v[4:7], v[16:31]
    ds_read_b128 v[80:83], v12 offset:8192
    s_mov_b64 exec, s[14:15]
    ds_read_b128 v[96:99], v13 offset:7168
    ds_read_b128 v[100:103], v13 offset:7680
    s_mov_b64 exec, -1
    s_add_u32 s5, s91, 2
    s_and_b32 s5, s5, 7
    s_lshl_b32 s5, s5, 7
    s_add_u32 s5, s5, 65536
    buffer_load_dwordx4 v[208:211], v104, s[56:59], s5 offen offset:0
    v_exp_f32 v39, v39
    v_cvt_pk_bf16_f32 v32, v32, v33
    v_cvt_pk_bf16_f32 v33, v34, v35
    v_cvt_pk_bf16_f32 v34, v36, v37
    v_cvt_pk_bf16_f32 v35, v38, v39
    v_exp_f32 v40, v40
    v_exp_f32 v41, v41
    v_exp_f32 v42, v42
    v_exp_f32 v43, v43
    v_mfma_f32_32x32x16_bf16 v[64:79], v[88:91], v[32:35], v[64:79]
    v_exp_f32 v44, v44
    v_exp_f32 v45, v45
    v_exp_f32 v46, v46
    v_exp_f32 v47, v47
    v_cvt_pk_bf16_f32 v40, v40, v41
    v_cvt_pk_bf16_f32 v41, v42, v43
    v_cvt_pk_bf16_f32 v42, v44, v45
    v_cvt_pk_bf16_f32 v43, v46, v47
    v_exp_f32 v48, v48
    v_exp_f32 v49, v49
    v_mfma_f32_32x32x16_bf16 v[64:79], v[92:95], v[40:43], v[64:79]
    v_exp_f32 v50, v50
    v_exp_f32 v51, v51
    v_exp_f32 v52, v52
    v_exp_f32 v53, v53
    v_exp_f32 v54, v54
    s_waitcnt lgkmcnt(0)
    v_mfma_f32_32x32x16_bf16 v[32:47], v[80:83], v[4:7], v[16:31]
    ds_read_b128 v[84:87], v12 offset:9216
    s_mov_b64 exec, s[14:15]
    ds_read_b128 v[88:91], v13 offset:8192
    ds_read_b128 v[92:95], v13 offset:8704
    s_mov_b64 exec, -1
    v_exp_f32 v55, v55
    v_cvt_pk_bf16_f32 v48, v48, v49
    v_cvt_pk_bf16_f32 v49, v50, v51
    v_cvt_pk_bf16_f32 v50, v52, v53
    v_cvt_pk_bf16_f32 v51, v54, v55
    v_exp_f32 v56, v56
    v_exp_f32 v57, v57
    v_exp_f32 v58, v58
    v_exp_f32 v59, v59
    v_mfma_f32_32x32x16_bf16 v[64:79], v[96:99], v[48:51], v[64:79]
    v_exp_f32 v60, v60
    v_exp_f32 v61, v61
    v_exp_f32 v62, v62
    v_exp_f32 v63, v63
    v_cvt_pk_bf16_f32 v56, v56, v57
    v_cvt_pk_bf16_f32 v57, v58, v59
    v_cvt_pk_bf16_f32 v58, v60, v61
    v_cvt_pk_bf16_f32 v59, v62, v63
    v_add_u32 v12, 8192, v12
    v_add_u32 v13, 8192, v13
    s_cmp_ge_u32 s3, 4
    s_cbranch_scc0 pr_17013_a
    s_setprio 1
    s_branch pr_17013_b
pr_17013_a:
    s_setprio 0
pr_17013_b:
    v_exp_f32 v32, v32
    v_exp_f32 v33, v33
    v_mfma_f32_32x32x16_bf16 v[64:79], v[100:103], v[56:59], v[64:79]
    v_exp_f32 v34, v34
    v_exp_f32 v35, v35
    v_exp_f32 v36, v36
    v_exp_f32 v37, v37
    v_exp_f32 v38, v38
    s_waitcnt lgkmcnt(0)
    v_mfma_f32_32x32x16_bf16 v[48:63], v[84:87], v[4:7], v[16:31]
    ds_read_b128 v[80:83], v12 offset:2048
    s_mov_b64 exec, s[14:15]
    ds_read_b128 v[96:99], v13 offset:1024
    ds_read_b128 v[100:103], v13 offset:1536
    s_mov_b64 exec, -1
    buffer_load_dwordx4 v[212:215], v104, s[56:59], s5 offen offset:64
    v_exp_f32 v39, v39
    v_cvt_pk_bf16_f32 v32, v32, v33
    v_cvt_pk_bf16_f32 v33, v34, v35
    v_cvt_pk_bf16_f32 v34, v36, v37
    v_cvt_pk_bf16_f32 v35, v38, v39
    v_exp_f32 v40, v40
    v_exp_f32 v41, v41
    v_exp_f32 v42, v42
    v_exp_f32 v43, v43
    v_mfma_f32_32x32x16_bf16 v[64:79], v[88:91], v[32:35], v[64:79]
    v_exp_f32 v44, v44
    v_exp_f32 v45, v45
    v_exp_f32 v46, v46
    v_exp_f32 v47, v47
    v_cvt_pk_bf16_f32 v40, v40, v41
    v_cvt_pk_bf16_f32 v41, v42, v43
    v_cvt_pk_bf16_f32 v42, v44, v45
    v_cvt_pk_bf16_f32 v43, v46, v47
    v_exp_f32 v48, v48
    v_exp_f32 v49, v49
    v_mfma_f32_32x32x16_bf16 v[64:79], v[92:95], v[40:43], v[64:79]
    v_exp_f32 v50, v50
    v_exp_f32 v51, v51
    v_exp_f32 v52, v52
    v_exp_f32 v53, v53
    v_exp_f32 v54, v54
    s_waitcnt lgkmcnt(0)
    v_mfma_f32_32x32x16_bf16 v[32:47], v[80:83], v[4:7], v[16:31]
    ds_read_b128 v[84:87], v12 offset:3072
    s_mov_b64 exec, s[14:15]
    ds_read_b128 v[88:91], v13 offset:2048
    ds_read_b128 v[92:95], v13 offset:2560
    s_mov_b64 exec, -1
    s_add_u32 s5, s91, 3
    s_and_b32 s5, s5, 7
    s_lshl_b32 s5, s5, 7
    s_add_u32 s5, s5, 65536
    buffer_load_dwordx4 v[216:219], v104, s[56:59], s5 offen offset:0
    v_exp_f32 v55, v55
    v_cvt_pk_bf16_f32 v48, v48, v49
    v_cvt_pk_bf16_f32 v49, v50, v51
    v_cvt_pk_bf16_f32 v50, v52, v53
    v_cvt_pk_bf16_f32 v51, v54, v55
    v_exp_f32 v56, v56
    v_exp_f32 v57, v57
    v_exp_f32 v58, v58
    v_exp_f32 v59, v59
    v_mfma_f32_32x32x16_bf16 v[64:79], v[96:99], v[48:51], v[64:79]
    v_exp_f32 v60, v60
    v_exp_f32 v61, v61
    v_exp_f32 v62, v62
    v_exp_f32 v63, v63
    v_cvt_pk_bf16_f32 v56, v56, v57
    v_cvt_pk_bf16_f32 v57, v58, v59
    v_cvt_pk_bf16_f32 v58, v60, v61
    v_cvt_pk_bf16_f32 v59, v62, v63
    v_exp_f32 v32, v32
    v_exp_f32 v33, v33
    v_mfma_f32_32x32x16_bf16 v[64:79], v[100:103], v[56:59], v[64:79]
    v_exp_f32 v34, v34
    v_exp_f32 v35, v35
    v_exp_f32 v36, v36
    v_exp_f32 v37, v37
    v_exp_f32 v38, v38
    s_waitcnt lgkmcnt(0)
    v_mfma_f32_32x32x16_bf16 v[48:63], v[84:87], v[4:7], v[16:31]
    ds_read_b128 v[80:83], v12 offset:4096
    s_mov_b64 exec, s[14:15]
    ds_read_b128 v[96:99], v13 offset:3072
    ds_read_b128 v[100:103], v13 offset:3584
    s_mov_b64 exec, -1
    v_exp_f32 v39, v39
    v_cvt_pk_bf16_f32 v32, v32, v33
    v_cvt_pk_bf16_f32 v33, v34, v35
    v_cvt_pk_bf16_f32 v34, v36, v37
    v_cvt_pk_bf16_f32 v35, v38, v39
    v_exp_f32 v40, v40
    v_exp_f32 v41, v41
    v_exp_f32 v42, v42
    v_exp_f32 v43, v43
    v_mfma_f32_32x32x16_bf16 v[64:79], v[88:91], v[32:35], v[64:79]
    v_exp_f32 v44, v44
    v_exp_f32 v45, v45
    v_exp_f32 v46, v46
    v_exp_f32 v47, v47
    v_cvt_pk_bf16_f32 v40, v40, v41
    v_cvt_pk_bf16_f32 v41, v42, v43
    v_cvt_pk_bf16_f32 v42, v44, v45
    v_cvt_pk_bf16_f32 v43, v46, v47
    v_exp_f32 v48, v48
    v_exp_f32 v49, v49
    v_mfma_f32_32x32x16_bf16 v[64:79], v[92:95], v[40:43], v[64:79]
    v_exp_f32 v50, v50
    v_exp_f32 v51, v51
    v_exp_f32 v52, v52
    v_exp_f32 v53, v53
    v_exp_f32 v54, v54
    s_waitcnt lgkmcnt(0)
    v_mfma_f32_32x32x16_bf16 v[32:47], v[80:83], v[4:7], v[16:31]
    ds_read_b128 v[84:87], v12 offset:5120
    s_mov_b64 exec, s[14:15]
    ds_read_b128 v[88:91], v13 offset:4096
    ds_read_b128 v[92:95], v13 offset:4608
    s_mov_b64 exec, -1
    buffer_load_dwordx4 v[220:223], v104, s[56:59], s5 offen offset:64
    v_exp_f32 v55, v55
    v_cvt_pk_bf16_f32 v48, v48, v49
    v_cvt_pk_bf16_f32 v49, v50, v51
    v_cvt_pk_bf16_f32 v50, v52, v53
    v_cvt_pk_bf16_f32 v51, v54, v55
    v_exp_f32 v56, v56
    v_exp_f32 v57, v57
    v_exp_f32 v58, v58
    v_exp_f32 v59, v59
    v_mfma_f32_32x32x16_bf16 v[64:79], v[96:99], v[48:51], v[64:79]
    v_exp_f32 v60, v60
    v_exp_f32 v61, v61
    v_exp_f32 v62, v62
    v_exp_f32 v63, v63
    v_cvt_pk_bf16_f32 v56, v56, v57
    v_cvt_pk_bf16_f32 v57, v58, v59
    v_cvt_pk_bf16_f32 v58, v60, v61
    v_cvt_pk_bf16_f32 v59, v62, v63
    v_exp_f32 v32, v32
    v_exp_f32 v33, v33
    v_mfma_f32_32x32x16_bf16 v[64:79], v[100:103], v[56:59], v[64:79]
    v_exp_f32 v34, v34
    v_exp_f32 v35, v35
    v_exp_f32 v36, v36
    v_exp_f32 v37, v37
    v_exp_f32 v38, v38
    s_waitcnt lgkmcnt(0)
    v_mfma_f32_32x32x16_bf16 v[48:63], v[84:87], v[4:7], v[16:31]
    ds_read_b128 v[80:83], v12 offset:6144
    s_mov_b64 exec, s[14:15]
    ds_read_b128 v[96:99], v13 offset:5120
    ds_read_b128 v[100:103], v13 offset:5632
    s_mov_b64 exec, -1
    v_exp_f32 v39, v39
    v_cvt_pk_bf16_f32 v32, v32, v33
    v_cvt_pk_bf16_f32 v33, v34, v35
    v_cvt_pk_bf16_f32 v34, v36, v37
    v_cvt_pk_bf16_f32 v35, v38, v39
    v_exp_f32 v40, v40
    v_exp_f32 v41, v41
    v_exp_f32 v42, v42
    v_exp_f32 v43, v43
    v_mfma_f32_32x32x16_bf16 v[64:79], v[88:91], v[32:35], v[64:79]
    v_exp_f32 v44, v44
    v_exp_f32 v45, v45
    v_exp_f32 v46, v46
    v_exp_f32 v47, v47
    v_cvt_pk_bf16_f32 v40, v40, v41
    v_cvt_pk_bf16_f32 v41, v42, v43
    v_cvt_pk_bf16_f32 v42, v44, v45
    v_cvt_pk_bf16_f32 v43, v46, v47
    v_exp_f32 v48, v48
    v_exp_f32 v49, v49
    v_mfma_f32_32x32x16_bf16 v[64:79], v[92:95], v[40:43], v[64:79]
    v_exp_f32 v50, v50
    v_exp_f32 v51, v51
    v_exp_f32 v52, v52
    v_exp_f32 v53, v53
    v_exp_f32 v54, v54
    s_waitcnt lgkmcnt(0)
    v_mfma_f32_32x32x16_bf16 v[32:47], v[80:83], v[4:7], v[16:31]
    ds_read_b128 v[84:87], v12 offset:7168
    s_mov_b64 exec, s[14:15]
    ds_read_b128 v[88:91], v13 offset:6144
    ds_read_b128 v[92:95], v13 offset:6656
    s_mov_b64 exec, -1
    s_add_u32 s5, s91, 4
    s_and_b32 s5, s5, 7
    s_lshl_b32 s5, s5, 7
    s_add_u32 s5, s5, 65536
    buffer_load_dwordx4 v[224:227], v104, s[56:59], s5 offen offset:0
    v_exp_f32 v55, v55
    v_cvt_pk_bf16_f32 v48, v48, v49
    v_cvt_pk_bf16_f32 v49, v50, v51
    v_cvt_pk_bf16_f32 v50, v52, v53
    v_cvt_pk_bf16_f32 v51, v54, v55
    v_exp_f32 v56, v56
    v_exp_f32 v57, v57
    v_exp_f32 v58, v58
    v_exp_f32 v59, v59
    v_mfma_f32_32x32x16_bf16 v[64:79], v[96:99], v[48:51], v[64:79]
    v_exp_f32 v60, v60
    v_exp_f32 v61, v61
    v_exp_f32 v62, v62
    v_exp_f32 v63, v63
    v_cvt_pk_bf16_f32 v56, v56, v57
    v_cvt_pk_bf16_f32 v57, v58, v59
    v_cvt_pk_bf16_f32 v58, v60, v61
    v_cvt_pk_bf16_f32 v59, v62, v63
    v_exp_f32 v32, v32
    v_exp_f32 v33, v33
    v_mfma_f32_32x32x16_bf16 v[64:79], v[100:103], v[56:59], v[64:79]
    v_exp_f32 v34, v34
    v_exp_f32 v35, v35
    v_exp_f32 v36, v36
    v_exp_f32 v37, v37
    v_exp_f32 v38, v38
    s_waitcnt lgkmcnt(0)
    v_mfma_f32_32x32x16_bf16 v[48:63], v[84:87], v[4:7], v[16:31]
    ds_read_b128 v[80:83], v12 offset:8192
    s_mov_b64 exec, s[14:15]
    ds_read_b128 v[96:99], v13 offset:7168
    ds_read_b128 v[100:103], v13 offset:7680
    s_mov_b64 exec, -1
    buffer_load_dwordx4 v[228:231], v104, s[56:59], s5 offen offset:64
    v_exp_f32 v39, v39
    v_cvt_pk_bf16_f32 v32, v32, v33
    v_cvt_pk_bf16_f32 v33, v34, v35
    v_cvt_pk_bf16_f32 v34, v36, v37
    v_cvt_pk_bf16_f32 v35, v38, v39
    v_exp_f32 v40, v40
    v_exp_f32 v41, v41
    v_exp_f32 v42, v42
    v_exp_f32 v43, v43
    v_mfma_f32_32x32x16_bf16 v[64:79], v[88:91], v[32:35], v[64:79]
    v_exp_f32 v44, v44
    v_exp_f32 v45, v45
    v_exp_f32 v46, v46
    v_exp_f32 v47, v47
    v_cvt_pk_bf16_f32 v40, v40, v41
    v_cvt_pk_bf16_f32 v41, v42, v43
    v_cvt_pk_bf16_f32 v42, v44, v45
    v_cvt_pk_bf16_f32 v43, v46, v47
    v_exp_f32 v48, v48
    v_exp_f32 v49, v49
    v_mfma_f32_32x32x16_bf16 v[64:79], v[92:95], v[40:43], v[64:79]
    v_exp_f32 v50, v50
    v_exp_f32 v51, v51
    v_exp_f32 v52, v52
    v_exp_f32 v53, v53
    v_exp_f32 v54, v54
    s_waitcnt lgkmcnt(0)
    v_mfma_f32_32x32x16_bf16 v[32:47], v[80:83], v[4:7], v[16:31]
    ds_read_b128 v[84:87], v12 offset:9216
    s_mov_b64 exec, s[14:15]
    ds_read_b128 v[88:91], v13 offset:8192
    ds_read_b128 v[92:95], v13 offset:8704
    s_mov_b64 exec, -1
    v_exp_f32 v55, v55
    v_cvt_pk_bf16_f32 v48, v48, v49
    v_cvt_pk_bf16_f32 v49, v50, v51
    v_cvt_pk_bf16_f32 v50, v52, v53
    v_cvt_pk_bf16_f32 v51, v54, v55
    v_exp_f32 v56, v56
    v_exp_f32 v57, v57
    v_exp_f32 v58, v58
    v_exp_f32 v59, v59
    v_mfma_f32_32x32x16_bf16 v[64:79], v[96:99], v[48:51], v[64:79]
    v_exp_f32 v60, v60
    v_exp_f32 v61, v61
    v_exp_f32 v62, v62
    v_exp_f32 v63, v63
    v_cvt_pk_bf16_f32 v56, v56, v57
    v_cvt_pk_bf16_f32 v57, v58, v59
    v_cvt_pk_bf16_f32 v58, v60, v61
    v_cvt_pk_bf16_f32 v59, v62, v63
    v_add_u32 v12, 8192, v12
    v_add_u32 v13, 8192, v13
    s_cmp_ge_u32 s3, 4
    s_cbranch_scc1 pr_17014_a
    s_setprio 1
    s_branch pr_17014_b
pr_17014_a:
    s_setprio 0
pr_17014_b:
    v_exp_f32 v32, v32
    v_exp_f32 v33, v33
    v_mfma_f32_32x32x16_bf16 v[64:79], v[100:103], v[56:59], v[64:79]
    v_exp_f32 v34, v34
    v_exp_f32 v35, v35
    v_exp_f32 v36, v36
    v_exp_f32 v37, v37
    v_exp_f32 v38, v38
    s_waitcnt lgkmcnt(0)
    v_mfma_f32_32x32x16_bf16 v[48:63], v[84:87], v[4:7], v[16:31]
    ds_read_b128 v[80:83], v12 offset:2048
    s_mov_b64 exec, s[14:15]
    ds_read_b128 v[96:99], v13 offset:1024
    ds_read_b128 v[100:103], v13 offset:1536
    s_mov_b64 exec, -1
    s_add_u32 s5, s91, 5
    s_and_b32 s5, s5, 7
    s_lshl_b32 s5, s5, 7
    s_add_u32 s5, s5, 65536
    buffer_load_dwordx4 v[232:235], v104, s[56:59], s5 offen offset:0
    v_exp_f32 v39, v39
    v_cvt_pk_bf16_f32 v32, v32, v33
    v_cvt_pk_bf16_f32 v33, v34, v35
    v_cvt_pk_bf16_f32 v34, v36, v37
    v_cvt_pk_bf16_f32 v35, v38, v39
    v_exp_f32 v40, v40
    v_exp_f32 v41, v41
    v_exp_f32 v42, v42
    v_exp_f32 v43, v43
    v_mfma_f32_32x32x16_bf16 v[64:79], v[88:91], v[32:35], v[64:79]
    v_exp_f32 v44, v44
    v_exp_f32 v45, v45
    v_exp_f32 v46, v46
    v_exp_f32 v47, v47
    v_cvt_pk_bf16_f32 v40, v40, v41
    v_cvt_pk_bf16_f32 v41, v42, v43
    v_cvt_pk_bf16_f32 v42, v44, v45
    v_cvt_pk_bf16_f32 v43, v46, v47
    v_exp_f32 v48, v48
    v_exp_f32 v49, v49
    v_mfma_f32_32x32x16_bf16 v[64:79], v[92:95], v[40:43], v[64:79]
    v_exp_f32 v50, v50
    v_exp_f32 v51, v51
    v_exp_f32 v52, v52
    v_exp_f32 v53, v53
    v_exp_f32 v54, v54
    s_waitcnt lgkmcnt(0)
    v_mfma_f32_32x32x16_bf16 v[32:47], v[80:83], v[4:7], v[16:31]
    ds_read_b128 v[84:87], v12 offset:3072
    s_mov_b64 exec, s[14:15]
    ds_read_b128 v[88:91], v13 offset:2048
    ds_read_b128 v[92:95], v13 offset:2560
    s_mov_b64 exec, -1
    buffer_load_dwordx4 v[236:239], v104, s[56:59], s5 offen offset:64
    v_exp_f32 v55, v55
    v_cvt_pk_bf16_f32 v48, v48, v49
    v_cvt_pk_bf16_f32 v49, v50, v51
    v_cvt_pk_bf16_f32 v50, v52, v53
    v_cvt_pk_bf16_f32 v51, v54, v55
    v_exp_f32 v56, v56
    v_exp_f32 v57, v57
    v_exp_f32 v58, v58
    v_exp_f32 v59, v59
    v_mfma_f32_32x32x16_bf16 v[64:79], v[96:99], v[48:51], v[64:79]
    v_exp_f32 v60, v60
    v_exp_f32 v61, v61
    v_exp_f32 v62, v62
    v_exp_f32 v63, v63
    v_cvt_pk_bf16_f32 v56, v56, v57
    v_cvt_pk_bf16_f32 v57, v58, v59
    v_cvt_pk_bf16_f32 v58, v60, v61
    v_cvt_pk_bf16_f32 v59, v62, v63
    v_exp_f32 v32, v32
    v_exp_f32 v33, v33
    v_mfma_f32_32x32x16_bf16 v[64:79], v[100:103], v[56:59], v[64:79]
    v_exp_f32 v34, v34
    v_exp_f32 v35, v35
    v_exp_f32 v36, v36
    v_exp_f32 v37, v37
    v_exp_f32 v38, v38
    s_waitcnt lgkmcnt(0)
    v_mfma_f32_32x32x16_bf16 v[48:63], v[84:87], v[4:7], v[16:31]
    ds_read_b128 v[80:83], v12 offset:4096
    s_mov_b64 exec, s[14:15]
    ds_read_b128 v[96:99], v13 offset:3072
    ds_read_b128 v[100:103], v13 offset:3584
    s_mov_b64 exec, -1
    v_exp_f32 v39, v39
    v_cvt_pk_bf16_f32 v32, v32, v33
    v_cvt_pk_bf16_f32 v33, v34, v35
    v_cvt_pk_bf16_f32 v34, v36, v37
    v_cvt_pk_bf16_f32 v35, v38, v39
    v_exp_f32 v40, v40
    v_exp_f32 v41, v41
    v_exp_f32 v42, v42
    v_exp_f32 v43, v43
    v_mfma_f32_32x32x16_bf16 v[64:79], v[88:91], v[32:35], v[64:79]
    v_exp_f32 v44, v44
    v_exp_f32 v45, v45
    v_exp_f32 v46, v46
    v_exp_f32 v47, v47
    v_cvt_pk_bf16_f32 v40, v40, v41
    v_cvt_pk_bf16_f32 v41, v42, v43
    v_cvt_pk_bf16_f32 v42, v44, v45
    v_cvt_pk_bf16_f32 v43, v46, v47
    v_exp_f32 v48, v48
    v_exp_f32 v49, v49
    v_mfma_f32_32x32x16_bf16 v[64:79], v[92:95], v[40:43], v[64:79]
    v_exp_f32 v50, v50
    v_exp_f32 v51, v51
    v_exp_f32 v52, v52
    v_exp_f32 v53, v53
    v_exp_f32 v54, v54
    s_waitcnt lgkmcnt(0)
    v_mfma_f32_32x32x16_bf16 v[32:47], v[80:83], v[4:7], v[16:31]
    ds_read_b128 v[84:87], v12 offset:5120
    s_mov_b64 exec, s[14:15]
    ds_read_b128 v[88:91], v13 offset:4096
    ds_read_b128 v[92:95], v13 offset:4608
    s_mov_b64 exec, -1
    s_add_u32 s5, s91, 6
    s_and_b32 s5, s5, 7
    s_lshl_b32 s5, s5, 7
    s_add_u32 s5, s5, 65536
    buffer_load_dwordx4 v[240:243], v104, s[56:59], s5 offen offset:0
    v_exp_f32 v55, v55
    v_cvt_pk_bf16_f32 v48, v48, v49
    v_cvt_pk_bf16_f32 v49, v50, v51
    v_cvt_pk_bf16_f32 v50, v52, v53
    v_cvt_pk_bf16_f32 v51, v54, v55
    v_exp_f32 v56, v56
    v_exp_f32 v57, v57
    v_exp_f32 v58, v58
    v_exp_f32 v59, v59
    v_mfma_f32_32x32x16_bf16 v[64:79], v[96:99], v[48:51], v[64:79]
    v_exp_f32 v60, v60
    v_exp_f32 v61, v61
    v_exp_f32 v62, v62
    v_exp_f32 v63, v63
    v_cvt_pk_bf16_f32 v56, v56, v57
    v_cvt_pk_bf16_f32 v57, v58, v59
    v_cvt_pk_bf16_f32 v58, v60, v61
    v_cvt_pk_bf16_f32 v59, v62, v63
    v_exp_f32 v32, v32
    v_exp_f32 v33, v33
    v_mfma_f32_32x32x16_bf16 v[64:79], v[100:103], v[56:59], v[64:79]
    v_exp_f32 v34, v34
    v_exp_f32 v35, v35
    v_exp_f32 v36, v36
    v_exp_f32 v37, v37
    v_exp_f32 v38, v38
    s_waitcnt lgkmcnt(0)
    v_mfma_f32_32x32x16_bf16 v[48:63], v[84:87], v[4:7], v[16:31]
    ds_read_b128 v[80:83], v12 offset:6144
    s_mov_b64 exec, s[14:15]
    ds_read_b128 v[96:99], v13 offset:5120
    ds_read_b128 v[100:103], v13 offset:5632
    s_mov_b64 exec, -1
    buffer_load_dwordx4 v[244:247], v104, s[56:59], s5 offen offset:64
    v_exp_f32 v39, v39
    v_cvt_pk_bf16_f32 v32, v32, v33
    v_cvt_pk_bf16_f32 v33, v34, v35
    v_cvt_pk_bf16_f32 v34, v36, v37
    v_cvt_pk_bf16_f32 v35, v38, v39
    v_exp_f32 v40, v40
    v_exp_f32 v41, v41
    v_exp_f32 v42, v42
    v_exp_f32 v43, v43
    v_mfma_f32_32x32x16_bf16 v[64:79], v[88:91], v[32:35], v[64:79]
    v_exp_f32 v44, v44
    v_exp_f32 v45, v45
    v_exp_f32 v46, v46
    v_exp_f32 v47, v47
    v_cvt_pk_bf16_f32 v40, v40, v41
    v_cvt_pk_bf16_f32 v41, v42, v43
    v_cvt_pk_bf16_f32 v42, v44, v45
    v_cvt_pk_bf16_f32 v43, v46, v47
    v_exp_f32 v48, v48
    v_exp_f32 v49, v49
    v_mfma_f32_32x32x16_bf16 v[64:79], v[92:95], v[40:43], v[64:79]
    v_exp_f32 v50, v50
    v_exp_f32 v51, v51
    v_exp_f32 v52, v52
    v_exp_f32 v53, v53
    v_exp_f32 v54, v54
    s_waitcnt lgkmcnt(0)
    v_mfma_f32_32x32x16_bf16 v[32:47], v[80:83], v[4:7], v[16:31]
    ds_read_b128 v[84:87], v12 offset:7168
    s_mov_b64 exec, s[14:15]
    ds_read_b128 v[88:91], v13 offset:6144
    ds_read_b128 v[92:95], v13 offset:6656
    s_mov_b64 exec, -1
    v_exp_f32 v55, v55
    v_cvt_pk_bf16_f32 v48, v48, v49
    v_cvt_pk_bf16_f32 v49, v50, v51
    v_cvt_pk_bf16_f32 v50, v52, v53
    v_cvt_pk_bf16_f32 v51, v54, v55
    v_exp_f32 v56, v56
    v_exp_f32 v57, v57
    v_exp_f32 v58, v58
    v_exp_f32 v59, v59
    v_mfma_f32_32x32x16_bf16 v[64:79], v[96:99], v[48:51], v[64:79]
    v_exp_f32 v60, v60
    v_exp_f32 v61, v61
    v_exp_f32 v62, v62
    v_exp_f32 v63, v63
    v_cvt_pk_bf16_f32 v56, v56, v57
    v_cvt_pk_bf16_f32 v57, v58, v59
    v_cvt_pk_bf16_f32 v58, v60, v61
    v_cvt_pk_bf16_f32 v59, v62, v63
    v_exp_f32 v32, v32
    v_exp_f32 v33, v33
    v_mfma_f32_32x32x16_bf16 v[64:79], v[100:103], v[56:59], v[64:79]
    v_exp_f32 v34, v34
    v_exp_f32 v35, v35
    v_exp_f32 v36, v36
    v_exp_f32 v37, v37
    v_exp_f32 v38, v38
    s_waitcnt lgkmcnt(0)
    v_mfma_f32_32x32x16_bf16 v[48:63], v[84:87], v[4:7], v[16:31]
    ds_read_b128 v[80:83], v12 offset:8192
    s_mov_b64 exec, s[14:15]
    ds_read_b128 v[96:99], v13 offset:7168
    ds_read_b128 v[100:103], v13 offset:7680
    s_mov_b64 exec, -1
    s_add_u32 s5, s91, 7
    s_and_b32 s5, s5, 7
    s_lshl_b32 s5, s5, 7
    s_add_u32 s5, s5, 65536
    buffer_load_dwordx4 v[248:251], v104, s[56:59], s5 offen offset:0
    v_exp_f32 v39, v39
    v_cvt_pk_bf16_f32 v32, v32, v33
    v_cvt_pk_bf16_f32 v33, v34, v35
    v_cvt_pk_bf16_f32 v34, v36, v37
    v_cvt_pk_bf16_f32 v35, v38, v39
    v_exp_f32 v40, v40
    v_exp_f32 v41, v41
    v_exp_f32 v42, v42
    v_exp_f32 v43, v43
    v_mfma_f32_32x32x16_bf16 v[64:79], v[88:91], v[32:35], v[64:79]
    v_exp_f32 v44, v44
    v_exp_f32 v45, v45
    v_exp_f32 v46, v46
    v_exp_f32 v47, v47
    v_cvt_pk_bf16_f32 v40, v40, v41
    v_cvt_pk_bf16_f32 v41, v42, v43
    v_cvt_pk_bf16_f32 v42, v44, v45
    v_cvt_pk_bf16_f32 v43, v46, v47
    v_exp_f32 v48, v48
    v_exp_f32 v49, v49
    v_mfma_f32_32x32x16_bf16 v[64:79], v[92:95], v[40:43], v[64:79]
    v_exp_f32 v50, v50
    v_exp_f32 v51, v51
    v_exp_f32 v52, v52
    v_exp_f32 v53, v53
    v_exp_f32 v54, v54
    s_waitcnt lgkmcnt(0)
    v_mfma_f32_32x32x16_bf16 v[32:47], v[80:83], v[4:7], v[16:31]
    ds_read_b128 v[84:87], v12 offset:9216
    s_mov_b64 exec, s[14:15]
    ds_read_b128 v[88:91], v13 offset:8192
    ds_read_b128 v[92:95], v13 offset:8704
    s_mov_b64 exec, -1
    buffer_load_dwordx4 v[252:255], v104, s[56:59], s5 offen offset:64
    v_exp_f32 v55, v55
    v_cvt_pk_bf16_f32 v48, v48, v49
    v_cvt_pk_bf16_f32 v49, v50, v51
    v_cvt_pk_bf16_f32 v50, v52, v53
    v_cvt_pk_bf16_f32 v51, v54, v55
    v_exp_f32 v56, v56
    v_exp_f32 v57, v57
    v_exp_f32 v58, v58
    v_exp_f32 v59, v59
    v_mfma_f32_32x32x16_bf16 v[64:79], v[96:99], v[48:51], v[64:79]
    v_exp_f32 v60, v60
    v_exp_f32 v61, v61
    v_exp_f32 v62, v62
    v_exp_f32 v63, v63
    v_cvt_pk_bf16_f32 v56, v56, v57
    v_cvt_pk_bf16_f32 v57, v58, v59
    v_cvt_pk_bf16_f32 v58, v60, v61
    v_cvt_pk_bf16_f32 v59, v62, v63
    v_add_u32 v12, 8192, v12
    v_add_u32 v13, 8192, v13
    s_cmp_ge_u32 s3, 4
    s_cbranch_scc1 pr_17015_a
    s_setprio 1
    s_branch pr_17015_b
pr_17015_a:
    s_setprio 0
pr_17015_b:
    v_exp_f32 v32, v32
    v_exp_f32 v33, v33
    v_mfma_f32_32x32x16_bf16 v[64:79], v[100:103], v[56:59], v[64:79]
    v_exp_f32 v34, v34
    v_exp_f32 v35, v35
    v_exp_f32 v36, v36
    v_exp_f32 v37, v37
    v_exp_f32 v38, v38
    s_waitcnt lgkmcnt(0)
    v_mfma_f32_32x32x16_bf16 v[48:63], v[84:87], v[4:7], v[16:31]
    ds_read_b128 v[80:83], v12 offset:2048
    s_mov_b64 exec, s[14:15]
    ds_read_b128 v[96:99], v13 offset:1024
    ds_read_b128 v[100:103], v13 offset:1536
    s_mov_b64 exec, -1
    v_exp_f32 v39, v39
    v_cvt_pk_bf16_f32 v32, v32, v33
    v_cvt_pk_bf16_f32 v33, v34, v35
    v_cvt_pk_bf16_f32 v34, v36, v37
    v_cvt_pk_bf16_f32 v35, v38, v39
    v_exp_f32 v40, v40
    v_exp_f32 v41, v41
    v_exp_f32 v42, v42
    v_exp_f32 v43, v43
    v_mfma_f32_32x32x16_bf16 v[64:79], v[88:91], v[32:35], v[64:79]
    v_exp_f32 v44, v44
    v_exp_f32 v45, v45
    v_exp_f32 v46, v46
    v_exp_f32 v47, v47
    v_cvt_pk_bf16_f32 v40, v40, v41
    v_cvt_pk_bf16_f32 v41, v42, v43
    v_cvt_pk_bf16_f32 v42, v44, v45
    v_cvt_pk_bf16_f32 v43, v46, v47
    v_exp_f32 v48, v48
    v_exp_f32 v49, v49
    v_mfma_f32_32x32x16_bf16 v[64:79], v[92:95], v[40:43], v[64:79]
    v_exp_f32 v50, v50
    v_exp_f32 v51, v51
    v_exp_f32 v52, v52
    v_exp_f32 v53, v53
    v_exp_f32 v54, v54
    s_waitcnt lgkmcnt(0)
    v_mfma_f32_32x32x16_bf16 v[32:47], v[80:83], v[4:7], v[16:31]
    ds_read_b128 v[84:87], v12 offset:3072
    s_mov_b64 exec, s[14:15]
    ds_read_b128 v[88:91], v13 offset:2048
    ds_read_b128 v[92:95], v13 offset:2560
    s_mov_b64 exec, -1
    s_lshl_b32 s5, s91, 16
    buffer_load_dwordx4 v[108:111], v105, s[60:63], s5 offen
    v_exp_f32 v55, v55
    v_cvt_pk_bf16_f32 v48, v48, v49
    v_cvt_pk_bf16_f32 v49, v50, v51
    v_cvt_pk_bf16_f32 v50, v52, v53
    v_cvt_pk_bf16_f32 v51, v54, v55
    v_exp_f32 v56, v56
    v_exp_f32 v57, v57
    v_exp_f32 v58, v58
    v_exp_f32 v59, v59
    v_mfma_f32_32x32x16_bf16 v[64:79], v[96:99], v[48:51], v[64:79]
    v_exp_f32 v60, v60
    v_exp_f32 v61, v61
    v_exp_f32 v62, v62
    v_exp_f32 v63, v63
    v_cvt_pk_bf16_f32 v56, v56, v57
    v_cvt_pk_bf16_f32 v57, v58, v59
    v_cvt_pk_bf16_f32 v58, v60, v61
    v_cvt_pk_bf16_f32 v59, v62, v63
    v_exp_f32 v32, v32
    v_exp_f32 v33, v33
    v_mfma_f32_32x32x16_bf16 v[64:79], v[100:103], v[56:59], v[64:79]
    v_exp_f32 v34, v34
    v_exp_f32 v35, v35
    v_exp_f32 v36, v36
    v_exp_f32 v37, v37
    v_exp_f32 v38, v38
    s_waitcnt lgkmcnt(0)
    v_mfma_f32_32x32x16_bf16 v[48:63], v[84:87], v[4:7], v[16:31]
    ds_read_b128 v[80:83], v12 offset:4096
    s_mov_b64 exec, s[14:15]
    ds_read_b128 v[96:99], v13 offset:3072
    ds_read_b128 v[100:103], v13 offset:3584
    s_mov_b64 exec, -1
    s_mul_i32 s5, s91, 114688
    buffer_load_dwordx4 v[108:111], v105, s[64:67], s5 offen
    v_exp_f32 v39, v39
    v_cvt_pk_bf16_f32 v32, v32, v33
    v_cvt_pk_bf16_f32 v33, v34, v35
    v_cvt_pk_bf16_f32 v34, v36, v37
    v_cvt_pk_bf16_f32 v35, v38, v39
    v_exp_f32 v40, v40
    v_exp_f32 v41, v41
    v_exp_f32 v42, v42
    v_exp_f32 v43, v43
    v_mfma_f32_32x32x16_bf16 v[64:79], v[88:91], v[32:35], v[64:79]
    v_exp_f32 v44, v44
    v_exp_f32 v45, v45
    v_exp_f32 v46, v46
    v_exp_f32 v47, v47
    v_cvt_pk_bf16_f32 v40, v40, v41
    v_cvt_pk_bf16_f32 v41, v42, v43
    v_cvt_pk_bf16_f32 v42, v44, v45
    v_cvt_pk_bf16_f32 v43, v46, v47
    v_exp_f32 v48, v48
    v_exp_f32 v49, v49
    v_mfma_f32_32x32x16_bf16 v[64:79], v[92:95], v[40:43], v[64:79]
    v_exp_f32 v50, v50
    v_exp_f32 v51, v51
    v_exp_f32 v52, v52
    v_exp_f32 v53, v53
    v_exp_f32 v54, v54
    s_waitcnt lgkmcnt(0)
    v_mfma_f32_32x32x16_bf16 v[32:47], v[80:83], v[4:7], v[16:31]
    ds_read_b128 v[84:87], v12 offset:5120
    s_mov_b64 exec, s[14:15]
    ds_read_b128 v[88:91], v13 offset:4096
    ds_read_b128 v[92:95], v13 offset:4608
    s_mov_b64 exec, -1
    v_exp_f32 v55, v55
    v_cvt_pk_bf16_f32 v48, v48, v49
    v_cvt_pk_bf16_f32 v49, v50, v51
    v_cvt_pk_bf16_f32 v50, v52, v53
    v_cvt_pk_bf16_f32 v51, v54, v55
    v_exp_f32 v56, v56
    v_exp_f32 v57, v57
    v_exp_f32 v58, v58
    v_exp_f32 v59, v59
    v_mfma_f32_32x32x16_bf16 v[64:79], v[96:99], v[48:51], v[64:79]
    v_exp_f32 v60, v60
    v_exp_f32 v61, v61
    v_exp_f32 v62, v62
    v_exp_f32 v63, v63
    v_cvt_pk_bf16_f32 v56, v56, v57
    v_cvt_pk_bf16_f32 v57, v58, v59
    v_cvt_pk_bf16_f32 v58, v60, v61
    v_cvt_pk_bf16_f32 v59, v62, v63
    v_exp_f32 v32, v32
    v_exp_f32 v33, v33
    v_mfma_f32_32x32x16_bf16 v[64:79], v[100:103], v[56:59], v[64:79]
    v_exp_f32 v34, v34
    v_exp_f32 v35, v35
    v_exp_f32 v36, v36
    v_exp_f32 v37, v37
    v_exp_f32 v38, v38
    s_waitcnt lgkmcnt(0)
    v_mfma_f32_32x32x16_bf16 v[48:63], v[84:87], v[4:7], v[16:31]
    ds_read_b128 v[80:83], v12 offset:6144
    s_mov_b64 exec, s[14:15]
    ds_read_b128 v[96:99], v13 offset:5120
    ds_read_b128 v[100:103], v13 offset:5632
    s_mov_b64 exec, -1
    s_add_u32 s5, s5, 0xc000
    buffer_load_dwordx4 v[108:111], v105, s[64:67], s5 offen
    v_exp_f32 v39, v39
    v_cvt_pk_bf16_f32 v32, v32, v33
    v_cvt_pk_bf16_f32 v33, v34, v35
    v_cvt_pk_bf16_f32 v34, v36, v37
    v_cvt_pk_bf16_f32 v35, v38, v39
    v_exp_f32 v40, v40
    v_exp_f32 v41, v41
    v_exp_f32 v42, v42
    v_exp_f32 v43, v43
    v_mfma_f32_32x32x16_bf16 v[64:79], v[88:91], v[32:35], v[64:79]
    v_exp_f32 v44, v44
    v_exp_f32 v45, v45
    v_exp_f32 v46, v46
    v_exp_f32 v47, v47
    v_cvt_pk_bf16_f32 v40, v40, v41
    v_cvt_pk_bf16_f32 v41, v42, v43
    v_cvt_pk_bf16_f32 v42, v44, v45
    v_cvt_pk_bf16_f32 v43, v46, v47
    v_exp_f32 v48, v48
    v_exp_f32 v49, v49
    v_mfma_f32_32x32x16_bf16 v[64:79], v[92:95], v[40:43], v[64:79]
    v_exp_f32 v50, v50
    v_exp_f32 v51, v51
    v_exp_f32 v52, v52
    v_exp_f32 v53, v53
    v_exp_f32 v54, v54
    s_waitcnt lgkmcnt(0)
    v_mfma_f32_32x32x16_bf16 v[32:47], v[80:83], v[4:7], v[16:31]
    ds_read_b128 v[84:87], v12 offset:7168
    s_mov_b64 exec, s[14:15]
    ds_read_b128 v[88:91], v13 offset:6144
    ds_read_b128 v[92:95], v13 offset:6656
    s_mov_b64 exec, -1
    v_exp_f32 v55, v55
    v_cvt_pk_bf16_f32 v48, v48, v49
    v_cvt_pk_bf16_f32 v49, v50, v51
    v_cvt_pk_bf16_f32 v50, v52, v53
    v_cvt_pk_bf16_f32 v51, v54, v55
    v_exp_f32 v56, v56
    v_exp_f32 v57, v57
    v_exp_f32 v58, v58
    v_exp_f32 v59, v59
    v_mfma_f32_32x32x16_bf16 v[64:79], v[96:99], v[48:51], v[64:79]
    v_exp_f32 v60, v60
    v_exp_f32 v61, v61
    v_exp_f32 v62, v62
    v_exp_f32 v63, v63
    v_cvt_pk_bf16_f32 v56, v56, v57
    v_cvt_pk_bf16_f32 v57, v58, v59
    v_cvt_pk_bf16_f32 v58, v60, v61
    v_cvt_pk_bf16_f32 v59, v62, v63
    v_exp_f32 v32, v32
    v_exp_f32 v33, v33
    v_mfma_f32_32x32x16_bf16 v[64:79], v[100:103], v[56:59], v[64:79]
    v_exp_f32 v34, v34
    v_exp_f32 v35, v35
    v_exp_f32 v36, v36
    v_exp_f32 v37, v37
    v_exp_f32 v38, v38
    s_waitcnt lgkmcnt(0)
    v_mfma_f32_32x32x16_bf16 v[48:63], v[84:87], v[4:7], v[16:31]
    ds_read_b128 v[80:83], v12 offset:8192
    s_mov_b64 exec, s[14:15]
    ds_read_b128 v[96:99], v13 offset:7168
    ds_read_b128 v[100:103], v13 offset:7680
    s_mov_b64 exec, -1
    v_exp_f32 v39, v39
    v_cvt_pk_bf16_f32 v32, v32, v33
    v_cvt_pk_bf16_f32 v33, v34, v35
    v_cvt_pk_bf16_f32 v34, v36, v37
    v_cvt_pk_bf16_f32 v35, v38, v39
    v_exp_f32 v40, v40
    v_exp_f32 v41, v41
    v_exp_f32 v42, v42
    v_exp_f32 v43, v43
    v_mfma_f32_32x32x16_bf16 v[64:79], v[88:91], v[32:35], v[64:79]
    v_exp_f32 v44, v44
    v_exp_f32 v45, v45
    v_exp_f32 v46, v46
    v_exp_f32 v47, v47
    v_cvt_pk_bf16_f32 v40, v40, v41
    v_cvt_pk_bf16_f32 v41, v42, v43
    v_cvt_pk_bf16_f32 v42, v44, v45
    v_cvt_pk_bf16_f32 v43, v46, v47
    v_exp_f32 v48, v48
    v_exp_f32 v49, v49
    v_mfma_f32_32x32x16_bf16 v[64:79], v[92:95], v[40:43], v[64:79]
    v_exp_f32 v50, v50
    v_exp_f32 v51, v51
    v_exp_f32 v52, v52
    v_exp_f32 v53, v53
    v_exp_f32 v54, v54
    s_waitcnt lgkmcnt(0)
    v_mfma_f32_32x32x16_bf16 v[32:47], v[80:83], v[4:7], v[16:31]
    ds_read_b128 v[84:87], v12 offset:9216
    s_mov_b64 exec, s[14:15]
    ds_read_b128 v[88:91], v13 offset:8192
    ds_read_b128 v[92:95], v13 offset:8704
    s_mov_b64 exec, -1
    v_exp_f32 v55, v55
    v_cvt_pk_bf16_f32 v48, v48, v49
    v_cvt_pk_bf16_f32 v49, v50, v51
    v_cvt_pk_bf16_f32 v50, v52, v53
    v_cvt_pk_bf16_f32 v51, v54, v55
    v_exp_f32 v56, v56
    v_exp_f32 v57, v57
    v_exp_f32 v58, v58
    v_exp_f32 v59, v59
    v_mfma_f32_32x32x16_bf16 v[64:79], v[96:99], v[48:51], v[64:79]
    v_exp_f32 v60, v60
    v_exp_f32 v61, v61
    v_exp_f32 v62, v62
    v_exp_f32 v63, v63
    v_cvt_pk_bf16_f32 v56, v56, v57
    v_cvt_pk_bf16_f32 v57, v58, v59
    v_cvt_pk_bf16_f32 v58, v60, v61
    v_cvt_pk_bf16_f32 v59, v62, v63
    v_add_u32 v12, 8192, v12
    v_add_u32 v13, 8192, v13
    s_setprio 0
    s_nop 1
    v_mfma_f32_32x32x16_bf16 v[64:79], v[100:103], v[56:59], v[64:79]
    s_waitcnt lgkmcnt(0)
    s_nop 10
    v_rcp_f32 v8, v72
    s_nop 0
    v_mul_f32 v64, v64, v8
    v_mul_f32 v65, v65, v8
    v_mul_f32 v66, v66, v8
    v_mul_f32 v67, v67, v8
    v_mul_f32 v68, v68, v8
    v_mul_f32 v69, v69, v8
    v_mul_f32 v70, v70, v8
    v_mul_f32 v71, v71, v8
    v_cvt_pk_bf16_f32 v16, v64, v65
    v_cvt_pk_bf16_f32 v17, v66, v67
    v_cvt_pk_bf16_f32 v18, v68, v69
    v_cvt_pk_bf16_f32 v19, v70, v71
    v_bfe_u32 v9, v1, 4, 1
    v_lshlrev_b32 v9, 14, v9
    v_lshrrev_b32 v10, 5, v1
    v_lshl_add_u32 v9, v10, 8, v9
    v_and_b32 v10, 15, v1
    v_lshl_add_u32 v9, v10, 4, v9
    s_lshl_b32 s5, s89, 4
    s_lshl_b32 s6, s3, 1
    s_add_u32 s5, s5, s6
    s_lshl_b32 s5, s5, 14
    s_lshr_b32 s6, s88, 1
    s_lshl_b32 s6, s6, 10
    s_add_u32 s5, s5, s6
    s_and_b32 s6, s88, 1
    s_lshl_b32 s6, s6, 9
    s_add_u32 s5, s5, s6
    buffer_store_dwordx4 v[16:19], v9, s[52:55], s5 offen sc1
    s_waitcnt vmcnt(0)
    s_barrier
    s_cmp_eq_u32 s3, 0
    s_cbranch_scc0 pub_17016
    s_add_u32 s5, s89, 0
    s_lshl_b32 s5, s5, 8
    s_lshl_b32 s6, s88, 2
    s_add_u32 s5, s5, s6
    v_mov_b32 v5, 1
    s_mov_b64 exec, 1
    buffer_store_dword v5, off, s[84:87], s5 sc1
    s_mov_b64 exec, -1
pub_17016:
    s_mov_b32 s44, s16
    s_mov_b32 s45, s17
    s_mov_b32 s46, 0x200000
    s_mov_b32 s47, 0x00020000
    s_add_u32 s48, s40, 0xa00000
    s_addc_u32 s49, s41, 0
    s_mov_b32 s50, 0x200000
    s_mov_b32 s51, 0x00020000
    s_mov_b32 s52, s40
    s_mov_b32 s53, s41
    s_mov_b32 s54, 0x3000
    s_mov_b32 s55, 0x00020000
    s_mov_b32 s56, s20
    s_mov_b32 s57, s21
    s_mov_b32 s58, 0x80000
    s_mov_b32 s59, 0x00020000
    s_add_u32 s60, s40, 0xc00000
    s_addc_u32 s61, s41, 0
    s_mov_b32 s62, 0x200000
    s_mov_b32 s63, 0x00020000
    s_add_u32 s64, s40, 0x140000
    s_addc_u32 s65, s41, 0
    s_mov_b32 s66, 0x40000
    s_mov_b32 s67, 0x00020000
    v_lshrrev_b32 v5, 3, v1
    s_lshl_b32 s5, s3, 3
    v_add_u32 v5, s5, v5
    v_mul_u32_u24 v24, 1024, v5
    v_bfe_u32 v5, v1, 4, 2
    v_lshlrev_b32 v5, 1, v5
    v_and_b32 v6, 7, v1
    v_xor_b32 v5, v5, v6
    v_lshl_add_u32 v24, v5, 4, v24
    s_lshl_b32 s5, s9, 7
    v_add_u32 v24, s5, v24
    s_lshl_b32 s10, s8, 16
    s_lshl_b32 s11, s3, 10
    s_lshr_b32 s90, s8, 2
    s_mov_b32 s5, 0
    s_add_u32 s6, s11, 65536
    s_mov_b32 m0, s6
    s_nop 0
    buffer_load_dwordx4 v24, s[56:59], s5 offen lds
    s_mov_b32 s5, 65536
    s_add_u32 s6, s11, 73728
    s_mov_b32 m0, s6
    s_nop 0
    buffer_load_dwordx4 v24, s[56:59], s5 offen lds
    s_mov_b32 s5, 131072
    s_add_u32 s6, s11, 81920
    s_mov_b32 m0, s6
    s_nop 0
    buffer_load_dwordx4 v24, s[56:59], s5 offen lds
    s_mov_b32 s5, 196608
    s_add_u32 s6, s11, 90112
    s_mov_b32 m0, s6
    s_nop 0
    buffer_load_dwordx4 v24, s[56:59], s5 offen lds
    s_mov_b32 s5, 262144
    s_add_u32 s6, s11, 98304
    s_mov_b32 m0, s6
    s_nop 0
    buffer_load_dwordx4 v24, s[56:59], s5 offen lds
    s_mov_b32 s5, 327680
    s_add_u32 s6, s11, 106496
    s_mov_b32 m0, s6
    s_nop 0
    buffer_load_dwordx4 v24, s[56:59], s5 offen lds
    s_mov_b32 s5, 393216
    s_add_u32 s6, s11, 114688
    s_mov_b32 m0, s6
    s_nop 0
    buffer_load_dwordx4 v24, s[56:59], s5 offen lds
    s_mov_b32 s5, 458752
    s_add_u32 s6, s11, 122880
    s_mov_b32 m0, s6
    s_nop 0
    buffer_load_dwordx4 v24, s[56:59], s5 offen lds
    v_and_b32 v5, 15, v1
    s_and_b32 s5, s3, 3
    s_lshl_b32 s5, s5, 4
    s_lshl_b32 s6, s8, 6
    s_add_u32 s5, s5, s6
    v_add_u32 v5, s5, v5
    v_mov_b32 v11, v5
    v_bfe_u32 v6, v1, 4, 1
    v_lshrrev_b32 v7, 5, v1
    v_lshlrev_b32 v6, 4, v6
    v_lshl_add_u32 v6, v7, 3, v6
    s_lshr_b32 s5, s3, 2
    s_lshl_b32 s5, s5, 5
    s_lshl_b32 s6, s9, 6
    s_add_u32 s5, s5, s6
    v_add_u32 v6, s5, v6
    v_lshlrev_b32 v10, 10, v5
    v_lshl_add_u32 v10, v6, 1, v10
    v_lshlrev_b32 v6, 2, v6
    buffer_load_dwordx4 v[12:15], v10, s[44:47], 0 offen
    s_mov_b32 s5, 4096
    buffer_load_dwordx4 v[16:19], v6, s[52:55], s5 offen sc1
    buffer_load_dwordx4 v[20:23], v6, s[52:55], s5 offen offset:16 sc1
    s_cmp_eq_u32 s3, 0
    s_cbranch_scc0 pd_17018
    s_add_u32 s5, s90, 0
    s_lshl_b32 s5, s5, 8
    v_lshlrev_b32 v6, 2, v1
    s_mov_b32 s6, 0
    s_mov_b32 exec_lo, 0xffffffff
    s_mov_b32 exec_hi, 0
poll_17017:
    buffer_load_dword v5, v6, s[84:87], s5 offen sc0 sc1
    s_waitcnt vmcnt(0)
    v_cmp_ne_u32 vcc, 0, v5
    s_add_u32 s6, s6, 1
    s_cmp_gt_u32 s6, 0x20000
    s_cbranch_scc1 poll_17017_x
    s_cmp_eq_u64 vcc, exec
    s_cbranch_scc1 poll_17017_x
    s_sleep 6
    s_branch poll_17017
poll_17017_x:
    s_mov_b64 exec, -1
pd_17018:
    s_barrier
    s_lshr_b32 s4, s3, 1
    s_lshl_b32 s4, s4, 14
    s_and_b32 s5, s3, 1
    s_lshl_b32 s5, s5, 11
    s_add_u32 s12, s4, s5
    s_add_u32 s6, s12, 0
    s_add_u32 s5, s6, s10
    s_mov_b32 m0, s6
    s_nop 0
    buffer_load_dwordx4 v2, s[48:51], s5 offen sc1 lds
    s_add_u32 s6, s12, 1024
    s_add_u32 s5, s6, s10
    s_mov_b32 m0, s6
    s_nop 0
    buffer_load_dwordx4 v2, s[48:51], s5 offen sc1 lds
    s_add_u32 s6, s12, 4096
    s_add_u32 s5, s6, s10
    s_mov_b32 m0, s6
    s_nop 0
    buffer_load_dwordx4 v2, s[48:51], s5 offen sc1 lds
    s_add_u32 s6, s12, 5120
    s_add_u32 s5, s6, s10
    s_mov_b32 m0, s6
    s_nop 0
    buffer_load_dwordx4 v2, s[48:51], s5 offen sc1 lds
    s_add_u32 s6, s12, 8192
    s_add_u32 s5, s6, s10
    s_mov_b32 m0, s6
    s_nop 0
    buffer_load_dwordx4 v2, s[48:51], s5 offen sc1 lds
    s_add_u32 s6, s12, 9216
    s_add_u32 s5, s6, s10
    s_mov_b32 m0, s6
    s_nop 0
    buffer_load_dwordx4 v2, s[48:51], s5 offen sc1 lds
    s_add_u32 s6, s12, 12288
    s_add_u32 s5, s6, s10
    s_mov_b32 m0, s6
    s_nop 0
    buffer_load_dwordx4 v2, s[48:51], s5 offen sc1 lds
    s_add_u32 s6, s12, 13312
    s_add_u32 s5, s6, s10
    s_mov_b32 m0, s6
    s_nop 0
    buffer_load_dwordx4 v2, s[48:51], s5 offen sc1 lds
    v_lshrrev_b32 v5, 4, v1
    v_bfe_u32 v6, v1, 2, 2
    v_lshrrev_b32 v7, 1, v5
    v_lshlrev_b32 v7, 4, v7
    v_and_b32 v8, 1, v5
    v_lshl_add_u32 v7, v8, 2, v7
    v_add_u32 v7, v7, v6
    v_bfe_u32 v8, v7, 1, 2
    v_lshlrev_b32 v7, 7, v7
    v_and_b32 v9, 3, v1
    v_lshl_add_u32 v7, v9, 3, v7
    v_add_u32 v7, 65536, v7
    s_lshr_b32 s5, s3, 2
    s_lshl_b32 s5, s5, 1
    v_xor_b32 v9, s5, v8
    v_lshl_add_u32 v25, v9, 5, v7
    s_add_u32 s5, s5, 1
    v_xor_b32 v9, s5, v8
    v_lshl_add_u32 v26, v9, 5, v7
    s_and_b32 s5, s3, 3
    s_lshl_b32 s5, s5, 14
    v_add_u32 v27, s5, v2
    v_mov_b32 v32, 0
    v_mov_b32 v33, 0
    v_mov_b32 v34, 0
    v_mov_b32 v35, 0
    v_mov_b32 v36, 0
    v_mov_b32 v37, 0
    v_mov_b32 v38, 0
    v_mov_b32 v39, 0
    s_waitcnt lgkmcnt(0)
    s_waitcnt vmcnt(6)
    s_barrier
    ds_read_b128 v[40:43], v27 offset:0
    ds_read_b64_tr_b16 v[48:49], v25 offset:0
    ds_read_b64_tr_b16 v[50:51], v25 offset:1024
    ds_read_b64_tr_b16 v[52:53], v26 offset:0
    ds_read_b64_tr_b16 v[54:55], v26 offset:1024
    ds_read_b128 v[44:47], v27 offset:1024
    ds_read_b64_tr_b16 v[56:57], v25 offset:4096
    ds_read_b64_tr_b16 v[58:59], v25 offset:5120
    ds_read_b64_tr_b16 v[60:61], v26 offset:4096
    ds_read_b64_tr_b16 v[62:63], v26 offset:5120
    ds_read_b128 v[64:67], v27 offset:2048
    ds_read_b64_tr_b16 v[72:73], v25 offset:8192
    ds_read_b64_tr_b16 v[74:75], v25 offset:9216
    ds_read_b64_tr_b16 v[76:77], v26 offset:8192
    ds_read_b64_tr_b16 v[78:79], v26 offset:9216
    ds_read_b128 v[68:71], v27 offset:3072
    ds_read_b64_tr_b16 v[80:81], v25 offset:12288
    ds_read_b64_tr_b16 v[82:83], v25 offset:13312
    ds_read_b64_tr_b16 v[84:85], v26 offset:12288
    ds_read_b64_tr_b16 v[86:87], v26 offset:13312
    s_waitcnt lgkmcnt(10)
    v_mfma_f32_16x16x32_bf16 v[32:35], v[48:51], v[40:43], v[32:35]
    s_waitcnt vmcnt(4)
    s_barrier
    ds_read_b128 v[96:99], v27 offset:4096
    ds_read_b64_tr_b16 v[104:105], v25 offset:16384
    ds_read_b64_tr_b16 v[106:107], v25 offset:17408
    v_mfma_f32_16x16x32_bf16 v[36:39], v[52:55], v[40:43], v[36:39]
    ds_read_b64_tr_b16 v[108:109], v26 offset:16384
    ds_read_b64_tr_b16 v[110:111], v26 offset:17408
    ds_read_b128 v[100:103], v27 offset:5120
    v_mfma_f32_16x16x32_bf16 v[32:35], v[56:59], v[44:47], v[32:35]
    ds_read_b64_tr_b16 v[112:113], v25 offset:20480
    ds_read_b64_tr_b16 v[114:115], v25 offset:21504
    ds_read_b64_tr_b16 v[116:117], v26 offset:20480
    v_mfma_f32_16x16x32_bf16 v[36:39], v[60:63], v[44:47], v[36:39]
    ds_read_b64_tr_b16 v[118:119], v26 offset:21504
    s_waitcnt lgkmcnt(10)
    v_mfma_f32_16x16x32_bf16 v[32:35], v[72:75], v[64:67], v[32:35]
    ds_read_b128 v[40:43], v27 offset:6144
    ds_read_b64_tr_b16 v[48:49], v25 offset:24576
    ds_read_b64_tr_b16 v[50:51], v25 offset:25600
    v_mfma_f32_16x16x32_bf16 v[36:39], v[76:79], v[64:67], v[36:39]
    ds_read_b64_tr_b16 v[52:53], v26 offset:24576
    ds_read_b64_tr_b16 v[54:55], v26 offset:25600
    ds_read_b128 v[44:47], v27 offset:7168
    v_mfma_f32_16x16x32_bf16 v[32:35], v[80:83], v[68:71], v[32:35]
    ds_read_b64_tr_b16 v[56:57], v25 offset:28672
    ds_read_b64_tr_b16 v[58:59], v25 offset:29696
    ds_read_b64_tr_b16 v[60:61], v26 offset:28672
    v_mfma_f32_16x16x32_bf16 v[36:39], v[84:87], v[68:71], v[36:39]
    ds_read_b64_tr_b16 v[62:63], v26 offset:29696
    s_waitcnt lgkmcnt(10)
    v_mfma_f32_16x16x32_bf16 v[32:35], v[104:107], v[96:99], v[32:35]
    s_waitcnt vmcnt(2)
    s_barrier
    ds_read_b128 v[64:67], v27 offset:8192
    ds_read_b64_tr_b16 v[72:73], v25 offset:32768
    ds_read_b64_tr_b16 v[74:75], v25 offset:33792
    v_mfma_f32_16x16x32_bf16 v[36:39], v[108:111], v[96:99], v[36:39]
    ds_read_b64_tr_b16 v[76:77], v26 offset:32768
    ds_read_b64_tr_b16 v[78:79], v26 offset:33792
    ds_read_b128 v[68:71], v27 offset:9216
    v_mfma_f32_16x16x32_bf16 v[32:35], v[112:115], v[100:103], v[32:35]
    ds_read_b64_tr_b16 v[80:81], v25 offset:36864
    ds_read_b64_tr_b16 v[82:83], v25 offset:37888
    ds_read_b64_tr_b16 v[84:85], v26 offset:36864
    v_mfma_f32_16x16x32_bf16 v[36:39], v[116:119], v[100:103], v[36:39]
    ds_read_b64_tr_b16 v[86:87], v26 offset:37888
    s_waitcnt lgkmcnt(10)
    v_mfma_f32_16x16x32_bf16 v[32:35], v[48:51], v[40:43], v[32:35]
    ds_read_b128 v[96:99], v27 offset:10240
    ds_read_b64_tr_b16 v[104:105], v25 offset:40960
    ds_read_b64_tr_b16 v[106:107], v25 offset:41984
    v_mfma_f32_16x16x32_bf16 v[36:39], v[52:55], v[40:43], v[36:39]
    ds_read_b64_tr_b16 v[108:109], v26 offset:40960
    ds_read_b64_tr_b16 v[110:111], v26 offset:41984
    ds_read_b128 v[100:103], v27 offset:11264
    v_mfma_f32_16x16x32_bf16 v[32:35], v[56:59], v[44:47], v[32:35]
    ds_read_b64_tr_b16 v[112:113], v25 offset:45056
    ds_read_b64_tr_b16 v[114:115], v25 offset:46080
    ds_read_b64_tr_b16 v[116:117], v26 offset:45056
    v_mfma_f32_16x16x32_bf16 v[36:39], v[60:63], v[44:47], v[36:39]
    ds_read_b64_tr_b16 v[118:119], v26 offset:46080
    s_waitcnt lgkmcnt(10)
    v_mfma_f32_16x16x32_bf16 v[32:35], v[72:75], v[64:67], v[32:35]
    s_waitcnt vmcnt(0)
    s_barrier
    ds_read_b128 v[40:43], v27 offset:12288
    ds_read_b64_tr_b16 v[48:49], v25 offset:49152
    ds_read_b64_tr_b16 v[50:51], v25 offset:50176
    v_mfma_f32_16x16x32_bf16 v[36:39], v[76:79], v[64:67], v[36:39]
    ds_read_b64_tr_b16 v[52:53], v26 offset:49152
    ds_read_b64_tr_b16 v[54:55], v26 offset:50176
    ds_read_b128 v[44:47], v27 offset:13312
    v_mfma_f32_16x16x32_bf16 v[32:35], v[80:83], v[68:71], v[32:35]
    ds_read_b64_tr_b16 v[56:57], v25 offset:53248
    ds_read_b64_tr_b16 v[58:59], v25 offset:54272
    ds_read_b64_tr_b16 v[60:61], v26 offset:53248
    v_mfma_f32_16x16x32_bf16 v[36:39], v[84:87], v[68:71], v[36:39]
    ds_read_b64_tr_b16 v[62:63], v26 offset:54272
    s_waitcnt lgkmcnt(10)
    v_mfma_f32_16x16x32_bf16 v[32:35], v[104:107], v[96:99], v[32:35]
    ds_read_b128 v[64:67], v27 offset:14336
    ds_read_b64_tr_b16 v[72:73], v25 offset:57344
    ds_read_b64_tr_b16 v[74:75], v25 offset:58368
    v_mfma_f32_16x16x32_bf16 v[36:39], v[108:111], v[96:99], v[36:39]
    ds_read_b64_tr_b16 v[76:77], v26 offset:57344
    ds_read_b64_tr_b16 v[78:79], v26 offset:58368
    ds_read_b128 v[68:71], v27 offset:15360
    v_mfma_f32_16x16x32_bf16 v[32:35], v[112:115], v[100:103], v[32:35]
    ds_read_b64_tr_b16 v[80:81], v25 offset:61440
    ds_read_b64_tr_b16 v[82:83], v25 offset:62464
    ds_read_b64_tr_b16 v[84:85], v26 offset:61440
    v_mfma_f32_16x16x32_bf16 v[36:39], v[116:119], v[100:103], v[36:39]
    ds_read_b64_tr_b16 v[86:87], v26 offset:62464
    s_waitcnt lgkmcnt(10)
    v_mfma_f32_16x16x32_bf16 v[32:35], v[48:51], v[40:43], v[32:35]
    v_mfma_f32_16x16x32_bf16 v[36:39], v[52:55], v[40:43], v[36:39]
    v_mfma_f32_16x16x32_bf16 v[32:35], v[56:59], v[44:47], v[32:35]
    v_mfma_f32_16x16x32_bf16 v[36:39], v[60:63], v[44:47], v[36:39]
    s_waitcnt lgkmcnt(0)
    v_mfma_f32_16x16x32_bf16 v[32:35], v[72:75], v[64:67], v[32:35]
    v_mfma_f32_16x16x32_bf16 v[36:39], v[76:79], v[64:67], v[36:39]
    v_mfma_f32_16x16x32_bf16 v[32:35], v[80:83], v[68:71], v[32:35]
    v_mfma_f32_16x16x32_bf16 v[36:39], v[84:87], v[68:71], v[36:39]
    s_nop 7
    v_permlane16_swap_b32 v32, v36
    v_permlane16_swap_b32 v33, v37
    v_permlane16_swap_b32 v34, v38
    v_permlane16_swap_b32 v35, v39
    s_waitcnt vmcnt(0)
    v_lshlrev_b32 v6, 16, v12
    v_and_b32 v7, 0xffff0000, v12
    v_fma_f32 v6, v32, v16, v6
    v_fma_f32 v7, v33, v17, v7
    v_cvt_pk_bf16_f32 v12, v6, v7
    v_lshlrev_b32 v6, 16, v13
    v_and_b32 v7, 0xffff0000, v13
    v_fma_f32 v6, v34, v18, v6
    v_fma_f32 v7, v35, v19, v7
    v_cvt_pk_bf16_f32 v13, v6, v7
    v_lshlrev_b32 v6, 16, v14
    v_and_b32 v7, 0xffff0000, v14
    v_fma_f32 v6, v36, v20, v6
    v_fma_f32 v7, v37, v21, v7
    v_cvt_pk_bf16_f32 v14, v6, v7
    v_lshlrev_b32 v6, 16, v15
    v_and_b32 v7, 0xffff0000, v15
    v_fma_f32 v6, v38, v22, v6
    v_fma_f32 v7, v39, v23, v7
    v_cvt_pk_bf16_f32 v15, v6, v7
    buffer_store_dwordx4 v[12:15], v10, s[60:63], 0 offen sc1
    v_mov_b32 v8, 0
    v_mov_b32 v9, 0
    v_lshlrev_b32 v6, 16, v12
    v_and_b32 v7, 0xffff0000, v12
    v_add_f32 v8, v8, v6
    v_fmac_f32 v9, v6, v6
    v_add_f32 v8, v8, v7
    v_fmac_f32 v9, v7, v7
    v_lshlrev_b32 v6, 16, v13
    v_and_b32 v7, 0xffff0000, v13
    v_add_f32 v8, v8, v6
    v_fmac_f32 v9, v6, v6
    v_add_f32 v8, v8, v7
    v_fmac_f32 v9, v7, v7
    v_lshlrev_b32 v6, 16, v14
    v_and_b32 v7, 0xffff0000, v14
    v_add_f32 v8, v8, v6
    v_fmac_f32 v9, v6, v6
    v_add_f32 v8, v8, v7
    v_fmac_f32 v9, v7, v7
    v_lshlrev_b32 v6, 16, v15
    v_and_b32 v7, 0xffff0000, v15
    v_add_f32 v8, v8, v6
    v_fmac_f32 v9, v6, v6
    v_add_f32 v8, v8, v7
    v_fmac_f32 v9, v7, v7
    v_mov_b32 v6, v8
    s_nop 1
    v_permlane16_swap_b32 v8, v6
    v_add_f32 v8, v8, v6
    v_mov_b32 v6, v9
    s_nop 1
    v_permlane16_swap_b32 v9, v6
    v_add_f32 v9, v9, v6
    v_mov_b32 v6, v8
    s_nop 1
    v_permlane32_swap_b32 v8, v6
    v_add_f32 v8, v8, v6
    v_mov_b32 v6, v9
    s_nop 1
    v_permlane32_swap_b32 v9, v6
    v_add_f32 v9, v9, v6
    s_lshr_b32 s5, s3, 2
    s_lshl_b32 s6, s9, 1
    s_add_u32 s5, s5, s6
    s_lshl_b32 s5, s5, 3
    v_lshlrev_b32 v5, 7, v11
    v_cmp_gt_u32 vcc, 16, v1
    s_nop 0
    s_and_saveexec_b64 s[12:13], vcc
    buffer_store_dwordx2 v[8:9], v5, s[64:67], s5 offen sc1
    s_mov_b64 exec, s[12:13]
    s_waitcnt vmcnt(0)
    s_barrier
    s_cmp_eq_u32 s3, 0
    s_cbranch_scc0 pub_17019
    s_add_u32 s5, s8, 8
    s_lshl_b32 s5, s5, 8
    s_lshl_b32 s6, s9, 2
    s_add_u32 s5, s5, s6
    v_mov_b32 v5, 1
    s_mov_b64 exec, 1
    buffer_store_dword v5, off, s[84:87], s5 sc1
    s_mov_b64 exec, -1
pub_17019:
    s_add_u32 s44, s40, 0xc00000
    s_addc_u32 s45, s41, 0
    s_mov_b32 s46, 0x200000
    s_mov_b32 s47, 0x00020000
    s_add_u32 s48, s40, 0x140000
    s_addc_u32 s49, s41, 0
    s_mov_b32 s50, 0x40000
    s_mov_b32 s51, 0x00020000
    s_mov_b32 s52, s40
    s_mov_b32 s53, s41
    s_mov_b32 s54, 0x3000
    s_mov_b32 s55, 0x00020000
    s_add_u32 s56, s40, 0x200000
    s_addc_u32 s57, s41, 0
    s_mov_b32 s58, 0x1c0000
    s_mov_b32 s59, 0x00020000
    s_add_u32 s60, s40, 0x180000
    s_addc_u32 s61, s41, 0
    s_mov_b32 s62, 0x40000
    s_mov_b32 s63, 0x00020000
    s_mul_i32 s14, s3, 1792
    s_mul_i32 s15, s9, 229376
    s_add_u32 s15, s15, s14
    s_add_u32 s14, s14, 65536
    s_lshl_b32 s10, s8, 6
    s_mov_b32 s12, -1
    s_mov_b32 s13, 0x0000ffff
    v_lshlrev_b32 v3, 5, v1
    s_mov_b32 s5, 8192
    buffer_load_dwordx4 v[48:51], v3, s[52:55], s5 offen offset:0 sc1
    buffer_load_dwordx4 v[52:55], v3, s[52:55], s5 offen offset:16 sc1
    s_mov_b32 s5, 6144
    buffer_load_dwordx4 v[56:59], v3, s[52:55], s5 offen offset:0 sc1
    buffer_load_dwordx4 v[60:63], v3, s[52:55], s5 offen offset:16 sc1
    s_add_u32 s5, s15, 0
    s_add_u32 m0, s14, 0
    s_nop 0
    buffer_load_dwordx4 v2, s[56:59], s5 offen offset:0 sc1 lds
    s_mov_b64 exec, s[12:13]
    buffer_load_dwordx4 v2, s[56:59], s5 offen offset:1024 sc1 lds
    s_mov_b64 exec, -1
    s_add_u32 s5, s15, 14336
    s_add_u32 m0, s14, 14336
    s_nop 0
    buffer_load_dwordx4 v2, s[56:59], s5 offen offset:0 sc1 lds
    s_mov_b64 exec, s[12:13]
    buffer_load_dwordx4 v2, s[56:59], s5 offen offset:1024 sc1 lds
    s_mov_b64 exec, -1
    s_add_u32 s5, s15, 28672
    s_add_u32 m0, s14, 28672
    s_nop 0
    buffer_load_dwordx4 v2, s[56:59], s5 offen offset:0 sc1 lds
    s_mov_b64 exec, s[12:13]
    buffer_load_dwordx4 v2, s[56:59], s5 offen offset:1024 sc1 lds
    s_mov_b64 exec, -1
    s_add_u32 s5, s15, 43008
    s_add_u32 m0, s14, 43008
    s_nop 0
    buffer_load_dwordx4 v2, s[56:59], s5 offen offset:0 sc1 lds
    s_mov_b64 exec, s[12:13]
    buffer_load_dwordx4 v2, s[56:59], s5 offen offset:1024 sc1 lds
    s_mov_b64 exec, -1
    s_add_u32 s5, s15, 57344
    s_add_u32 m0, s14, 57344
    s_nop 0
    buffer_load_dwordx4 v2, s[56:59], s5 offen offset:0 sc1 lds
    s_mov_b64 exec, s[12:13]
    buffer_load_dwordx4 v2, s[56:59], s5 offen offset:1024 sc1 lds
    s_mov_b64 exec, -1
    s_add_u32 s5, s15, 71680
    s_add_u32 m0, s14, 71680
    s_nop 0
    buffer_load_dwordx4 v2, s[56:59], s5 offen offset:0 sc1 lds
    s_mov_b64 exec, s[12:13]
    buffer_load_dwordx4 v2, s[56:59], s5 offen offset:1024 sc1 lds
    s_mov_b64 exec, -1
    s_cmp_eq_u32 s3, 0
    s_cbranch_scc0 pd_17021
    s_add_u32 s5, s8, 8
    s_lshl_b32 s5, s5, 8
    v_lshlrev_b32 v6, 2, v1
    s_mov_b32 s6, 0
    s_mov_b32 exec_lo, 0xff
    s_mov_b32 exec_hi, 0
poll_17020:
    buffer_load_dword v5, v6, s[84:87], s5 offen sc0 sc1
    s_waitcnt vmcnt(0)
    v_cmp_ne_u32 vcc, 0, v5
    s_add_u32 s6, s6, 1
    s_cmp_gt_u32 s6, 0x20000
    s_cbranch_scc1 poll_17020_x
    s_cmp_eq_u64 vcc, exec
    s_cbranch_scc1 poll_17020_x
    s_sleep 6
    s_branch poll_17020
poll_17020_x:
    s_mov_b64 exec, -1
pd_17021:
    s_barrier
    s_lshl_b32 s5, s3, 3
    s_add_u32 s5, s5, s10
    s_lshl_b32 s6, s5, 10
    s_lshl_b32 s7, s5, 7
    v_lshlrev_b32 v2, 4, v1
    buffer_load_dwordx4 v[8:11], v2, s[48:51], s7 offen sc1
    s_add_u32 s7, s6, 4096
    buffer_load_dwordx4 v[16:19], v2, s[44:47], s6 offen offset:0 sc1
    buffer_load_dwordx4 v[20:23], v2, s[44:47], s6 offen offset:1024 sc1
    buffer_load_dwordx4 v[24:27], v2, s[44:47], s6 offen offset:2048 sc1
    buffer_load_dwordx4 v[28:31], v2, s[44:47], s6 offen offset:3072 sc1
    buffer_load_dwordx4 v[32:35], v2, s[44:47], s7 offen offset:0 sc1
    buffer_load_dwordx4 v[36:39], v2, s[44:47], s7 offen offset:1024 sc1
    buffer_load_dwordx4 v[40:43], v2, s[44:47], s7 offen offset:2048 sc1
    buffer_load_dwordx4 v[44:47], v2, s[44:47], s7 offen offset:3072 sc1
    s_waitcnt vmcnt(8)
    v_add_f32 v8, v8, v10
    v_add_f32 v9, v9, v11
    s_nop 0
    v_add_f32_dpp v8, v8, v8 quad_perm:[1,0,3,2] row_mask:0xf bank_mask:0xf
    v_add_f32_dpp v9, v9, v9 quad_perm:[1,0,3,2] row_mask:0xf bank_mask:0xf
    s_nop 0
    v_add_f32_dpp v8, v8, v8 quad_perm:[2,3,0,1] row_mask:0xf bank_mask:0xf
    v_add_f32_dpp v9, v9, v9 quad_perm:[2,3,0,1] row_mask:0xf bank_mask:0xf
    s_nop 0
    v_add_f32_dpp v8, v8, v8 row_half_mirror row_mask:0xf bank_mask:0xf
    v_add_f32_dpp v9, v9, v9 row_half_mirror row_mask:0xf bank_mask:0xf
    v_mul_f32 v8, 0x3b000000, v8
    v_mul_f32 v9, 0x3b000000, v9
    v_fma_f32 v9, -v8, v8, v9
    v_max_f32 v9, 0, v9
    v_add_f32 v9, 0x3727c5ac, v9
    v_rsq_f32 v9, v9
    s_nop 0
    v_mul_f32 v8, v8, v9
    v_sub_f32 v8, 0, v8
    v_readlane_b32 s68, v9, 0
    v_readlane_b32 s69, v8, 0
    v_readlane_b32 s70, v9, 8
    v_readlane_b32 s71, v8, 8
    v_readlane_b32 s72, v9, 16
    v_readlane_b32 s73, v8, 16
    v_readlane_b32 s74, v9, 24
    v_readlane_b32 s75, v8, 24
    v_readlane_b32 s76, v9, 32
    v_readlane_b32 s77, v8, 32
    v_readlane_b32 s78, v9, 40
    v_readlane_b32 s79, v8, 40
    v_readlane_b32 s80, v9, 48
    v_readlane_b32 s81, v8, 48
    v_readlane_b32 s82, v9, 56
    v_readlane_b32 s83, v8, 56
    v_lshrrev_b32 v4, 2, v1
    v_lshlrev_b32 v4, 10, v4
    v_and_b32 v5, 3, v1
    v_lshl_add_u32 v4, v5, 8, v4
    v_and_b32 v5, 15, v1
    v_lshl_add_u32 v4, v5, 4, v4
    s_lshr_b32 s5, s3, 1
    s_lshl_b32 s5, s5, 14
    s_add_u32 s5, s5, 0
    s_and_b32 s6, s3, 1
    s_lshl_b32 s6, s6, 7
    v_xor_b32 v4, s6, v4
    v_add_u32 v4, s5, v4
    s_waitcnt vmcnt(0)
    v_lshlrev_b32 v72, 16, v16
    v_and_b32 v73, 0xffff0000, v16
    v_lshlrev_b32 v74, 16, v17
    v_and_b32 v75, 0xffff0000, v17
    v_lshlrev_b32 v76, 16, v18
    v_and_b32 v77, 0xffff0000, v18
    v_lshlrev_b32 v78, 16, v19
    v_and_b32 v79, 0xffff0000, v19
    v_pk_fma_f32 v[72:73], v[72:73], s[68:69], s[68:69] op_sel:[0,0,1] op_sel_hi:[1,0,1]
    v_pk_fma_f32 v[74:75], v[74:75], s[68:69], s[68:69] op_sel:[0,0,1] op_sel_hi:[1,0,1]
    v_pk_fma_f32 v[76:77], v[76:77], s[68:69], s[68:69] op_sel:[0,0,1] op_sel_hi:[1,0,1]
    v_pk_fma_f32 v[78:79], v[78:79], s[68:69], s[68:69] op_sel:[0,0,1] op_sel_hi:[1,0,1]
    v_pk_fma_f32 v[72:73], v[72:73], v[48:49], v[56:57]
    v_pk_fma_f32 v[74:75], v[74:75], v[50:51], v[58:59]
    v_pk_fma_f32 v[76:77], v[76:77], v[52:53], v[60:61]
    v_pk_fma_f32 v[78:79], v[78:79], v[54:55], v[62:63]
    v_cvt_pk_bf16_f32 v16, v72, v73
    v_cvt_pk_bf16_f32 v17, v74, v75
    v_cvt_pk_bf16_f32 v18, v76, v77
    v_cvt_pk_bf16_f32 v19, v78, v79
    v_xor_b32 v12, 0, v4
    ds_write_b128 v12, v[16:19]
    v_lshlrev_b32 v80, 16, v20
    v_and_b32 v81, 0xffff0000, v20
    v_lshlrev_b32 v82, 16, v21
    v_and_b32 v83, 0xffff0000, v21
    v_lshlrev_b32 v84, 16, v22
    v_and_b32 v85, 0xffff0000, v22
    v_lshlrev_b32 v86, 16, v23
    v_and_b32 v87, 0xffff0000, v23
    v_pk_fma_f32 v[80:81], v[80:81], s[70:71], s[70:71] op_sel:[0,0,1] op_sel_hi:[1,0,1]
    v_pk_fma_f32 v[82:83], v[82:83], s[70:71], s[70:71] op_sel:[0,0,1] op_sel_hi:[1,0,1]
    v_pk_fma_f32 v[84:85], v[84:85], s[70:71], s[70:71] op_sel:[0,0,1] op_sel_hi:[1,0,1]
    v_pk_fma_f32 v[86:87], v[86:87], s[70:71], s[70:71] op_sel:[0,0,1] op_sel_hi:[1,0,1]
    v_pk_fma_f32 v[80:81], v[80:81], v[48:49], v[56:57]
    v_pk_fma_f32 v[82:83], v[82:83], v[50:51], v[58:59]
    v_pk_fma_f32 v[84:85], v[84:85], v[52:53], v[60:61]
    v_pk_fma_f32 v[86:87], v[86:87], v[54:55], v[62:63]
    v_cvt_pk_bf16_f32 v20, v80, v81
    v_cvt_pk_bf16_f32 v21, v82, v83
    v_cvt_pk_bf16_f32 v22, v84, v85
    v_cvt_pk_bf16_f32 v23, v86, v87
    v_xor_b32 v12, 16, v4
    ds_write_b128 v12, v[20:23]
    v_lshlrev_b32 v72, 16, v24
    v_and_b32 v73, 0xffff0000, v24
    v_lshlrev_b32 v74, 16, v25
    v_and_b32 v75, 0xffff0000, v25
    v_lshlrev_b32 v76, 16, v26
    v_and_b32 v77, 0xffff0000, v26
    v_lshlrev_b32 v78, 16, v27
    v_and_b32 v79, 0xffff0000, v27
    v_pk_fma_f32 v[72:73], v[72:73], s[72:73], s[72:73] op_sel:[0,0,1] op_sel_hi:[1,0,1]
    v_pk_fma_f32 v[74:75], v[74:75], s[72:73], s[72:73] op_sel:[0,0,1] op_sel_hi:[1,0,1]
    v_pk_fma_f32 v[76:77], v[76:77], s[72:73], s[72:73] op_sel:[0,0,1] op_sel_hi:[1,0,1]
    v_pk_fma_f32 v[78:79], v[78:79], s[72:73], s[72:73] op_sel:[0,0,1] op_sel_hi:[1,0,1]
    v_pk_fma_f32 v[72:73], v[72:73], v[48:49], v[56:57]
    v_pk_fma_f32 v[74:75], v[74:75], v[50:51], v[58:59]
    v_pk_fma_f32 v[76:77], v[76:77], v[52:53], v[60:61]
    v_pk_fma_f32 v[78:79], v[78:79], v[54:55], v[62:63]
    v_cvt_pk_bf16_f32 v24, v72, v73
    v_cvt_pk_bf16_f32 v25, v74, v75
    v_cvt_pk_bf16_f32 v26, v76, v77
    v_cvt_pk_bf16_f32 v27, v78, v79
    v_xor_b32 v12, 32, v4
    ds_write_b128 v12, v[24:27]
    v_lshlrev_b32 v80, 16, v28
    v_and_b32 v81, 0xffff0000, v28
    v_lshlrev_b32 v82, 16, v29
    v_and_b32 v83, 0xffff0000, v29
    v_lshlrev_b32 v84, 16, v30
    v_and_b32 v85, 0xffff0000, v30
    v_lshlrev_b32 v86, 16, v31
    v_and_b32 v87, 0xffff0000, v31
    v_pk_fma_f32 v[80:81], v[80:81], s[74:75], s[74:75] op_sel:[0,0,1] op_sel_hi:[1,0,1]
    v_pk_fma_f32 v[82:83], v[82:83], s[74:75], s[74:75] op_sel:[0,0,1] op_sel_hi:[1,0,1]
    v_pk_fma_f32 v[84:85], v[84:85], s[74:75], s[74:75] op_sel:[0,0,1] op_sel_hi:[1,0,1]
    v_pk_fma_f32 v[86:87], v[86:87], s[74:75], s[74:75] op_sel:[0,0,1] op_sel_hi:[1,0,1]
    v_pk_fma_f32 v[80:81], v[80:81], v[48:49], v[56:57]
    v_pk_fma_f32 v[82:83], v[82:83], v[50:51], v[58:59]
    v_pk_fma_f32 v[84:85], v[84:85], v[52:53], v[60:61]
    v_pk_fma_f32 v[86:87], v[86:87], v[54:55], v[62:63]
    v_cvt_pk_bf16_f32 v28, v80, v81
    v_cvt_pk_bf16_f32 v29, v82, v83
    v_cvt_pk_bf16_f32 v30, v84, v85
    v_cvt_pk_bf16_f32 v31, v86, v87
    v_xor_b32 v12, 48, v4
    ds_write_b128 v12, v[28:31]
    v_lshlrev_b32 v72, 16, v32
    v_and_b32 v73, 0xffff0000, v32
    v_lshlrev_b32 v74, 16, v33
    v_and_b32 v75, 0xffff0000, v33
    v_lshlrev_b32 v76, 16, v34
    v_and_b32 v77, 0xffff0000, v34
    v_lshlrev_b32 v78, 16, v35
    v_and_b32 v79, 0xffff0000, v35
    v_pk_fma_f32 v[72:73], v[72:73], s[76:77], s[76:77] op_sel:[0,0,1] op_sel_hi:[1,0,1]
    v_pk_fma_f32 v[74:75], v[74:75], s[76:77], s[76:77] op_sel:[0,0,1] op_sel_hi:[1,0,1]
    v_pk_fma_f32 v[76:77], v[76:77], s[76:77], s[76:77] op_sel:[0,0,1] op_sel_hi:[1,0,1]
    v_pk_fma_f32 v[78:79], v[78:79], s[76:77], s[76:77] op_sel:[0,0,1] op_sel_hi:[1,0,1]
    v_pk_fma_f32 v[72:73], v[72:73], v[48:49], v[56:57]
    v_pk_fma_f32 v[74:75], v[74:75], v[50:51], v[58:59]
    v_pk_fma_f32 v[76:77], v[76:77], v[52:53], v[60:61]
    v_pk_fma_f32 v[78:79], v[78:79], v[54:55], v[62:63]
    v_cvt_pk_bf16_f32 v32, v72, v73
    v_cvt_pk_bf16_f32 v33, v74, v75
    v_cvt_pk_bf16_f32 v34, v76, v77
    v_cvt_pk_bf16_f32 v35, v78, v79
    v_xor_b32 v12, 64, v4
    ds_write_b128 v12, v[32:35]
    v_lshlrev_b32 v80, 16, v36
    v_and_b32 v81, 0xffff0000, v36
    v_lshlrev_b32 v82, 16, v37
    v_and_b32 v83, 0xffff0000, v37
    v_lshlrev_b32 v84, 16, v38
    v_and_b32 v85, 0xffff0000, v38
    v_lshlrev_b32 v86, 16, v39
    v_and_b32 v87, 0xffff0000, v39
    v_pk_fma_f32 v[80:81], v[80:81], s[78:79], s[78:79] op_sel:[0,0,1] op_sel_hi:[1,0,1]
    v_pk_fma_f32 v[82:83], v[82:83], s[78:79], s[78:79] op_sel:[0,0,1] op_sel_hi:[1,0,1]
    v_pk_fma_f32 v[84:85], v[84:85], s[78:79], s[78:79] op_sel:[0,0,1] op_sel_hi:[1,0,1]
    v_pk_fma_f32 v[86:87], v[86:87], s[78:79], s[78:79] op_sel:[0,0,1] op_sel_hi:[1,0,1]
    v_pk_fma_f32 v[80:81], v[80:81], v[48:49], v[56:57]
    v_pk_fma_f32 v[82:83], v[82:83], v[50:51], v[58:59]
    v_pk_fma_f32 v[84:85], v[84:85], v[52:53], v[60:61]
    v_pk_fma_f32 v[86:87], v[86:87], v[54:55], v[62:63]
    v_cvt_pk_bf16_f32 v36, v80, v81
    v_cvt_pk_bf16_f32 v37, v82, v83
    v_cvt_pk_bf16_f32 v38, v84, v85
    v_cvt_pk_bf16_f32 v39, v86, v87
    v_xor_b32 v12, 80, v4
    ds_write_b128 v12, v[36:39]
    v_lshlrev_b32 v72, 16, v40
    v_and_b32 v73, 0xffff0000, v40
    v_lshlrev_b32 v74, 16, v41
    v_and_b32 v75, 0xffff0000, v41
    v_lshlrev_b32 v76, 16, v42
    v_and_b32 v77, 0xffff0000, v42
    v_lshlrev_b32 v78, 16, v43
    v_and_b32 v79, 0xffff0000, v43
    v_pk_fma_f32 v[72:73], v[72:73], s[80:81], s[80:81] op_sel:[0,0,1] op_sel_hi:[1,0,1]
    v_pk_fma_f32 v[74:75], v[74:75], s[80:81], s[80:81] op_sel:[0,0,1] op_sel_hi:[1,0,1]
    v_pk_fma_f32 v[76:77], v[76:77], s[80:81], s[80:81] op_sel:[0,0,1] op_sel_hi:[1,0,1]
    v_pk_fma_f32 v[78:79], v[78:79], s[80:81], s[80:81] op_sel:[0,0,1] op_sel_hi:[1,0,1]
    v_pk_fma_f32 v[72:73], v[72:73], v[48:49], v[56:57]
    v_pk_fma_f32 v[74:75], v[74:75], v[50:51], v[58:59]
    v_pk_fma_f32 v[76:77], v[76:77], v[52:53], v[60:61]
    v_pk_fma_f32 v[78:79], v[78:79], v[54:55], v[62:63]
    v_cvt_pk_bf16_f32 v40, v72, v73
    v_cvt_pk_bf16_f32 v41, v74, v75
    v_cvt_pk_bf16_f32 v42, v76, v77
    v_cvt_pk_bf16_f32 v43, v78, v79
    v_xor_b32 v12, 96, v4
    ds_write_b128 v12, v[40:43]
    v_lshlrev_b32 v80, 16, v44
    v_and_b32 v81, 0xffff0000, v44
    v_lshlrev_b32 v82, 16, v45
    v_and_b32 v83, 0xffff0000, v45
    v_lshlrev_b32 v84, 16, v46
    v_and_b32 v85, 0xffff0000, v46
    v_lshlrev_b32 v86, 16, v47
    v_and_b32 v87, 0xffff0000, v47
    v_pk_fma_f32 v[80:81], v[80:81], s[82:83], s[82:83] op_sel:[0,0,1] op_sel_hi:[1,0,1]
    v_pk_fma_f32 v[82:83], v[82:83], s[82:83], s[82:83] op_sel:[0,0,1] op_sel_hi:[1,0,1]
    v_pk_fma_f32 v[84:85], v[84:85], s[82:83], s[82:83] op_sel:[0,0,1] op_sel_hi:[1,0,1]
    v_pk_fma_f32 v[86:87], v[86:87], s[82:83], s[82:83] op_sel:[0,0,1] op_sel_hi:[1,0,1]
    v_pk_fma_f32 v[80:81], v[80:81], v[48:49], v[56:57]
    v_pk_fma_f32 v[82:83], v[82:83], v[50:51], v[58:59]
    v_pk_fma_f32 v[84:85], v[84:85], v[52:53], v[60:61]
    v_pk_fma_f32 v[86:87], v[86:87], v[54:55], v[62:63]
    v_cvt_pk_bf16_f32 v44, v80, v81
    v_cvt_pk_bf16_f32 v45, v82, v83
    v_cvt_pk_bf16_f32 v46, v84, v85
    v_cvt_pk_bf16_f32 v47, v86, v87
    v_xor_b32 v12, 112, v4
    ds_write_b128 v12, v[44:47]
    s_and_b32 s5, s3, 3
    s_lshl_b32 s5, s5, 14
    v_lshrrev_b32 v5, 4, v1
    v_and_b32 v6, 15, v1
    v_xor_b32 v6, v5, v6
    v_lshlrev_b32 v6, 4, v6
    v_lshl_add_u32 v6, v5, 8, v6
    v_xor_b32 v64, 0, v6
    v_add_u32 v64, s5, v64
    v_xor_b32 v65, 64, v6
    v_add_u32 v65, s5, v65
    v_xor_b32 v66, 128, v6
    v_add_u32 v66, s5, v66
    v_xor_b32 v67, 192, v6
    v_add_u32 v67, s5, v67
    v_lshrrev_b32 v5, 5, v1
    v_lshlrev_b32 v5, 4, v5
    v_bfe_u32 v6, v1, 4, 1
    v_lshl_add_u32 v5, v6, 2, v5
    v_bfe_u32 v6, v1, 2, 2
    v_add_u32 v5, v5, v6
    v_mul_u32_u24 v5, 224, v5
    v_and_b32 v6, 3, v1
    v_lshl_add_u32 v5, v6, 3, v5
    s_lshr_b32 s5, s3, 2
    s_lshl_b32 s5, s5, 7
    s_add_u32 s5, s5, 65536
    v_add_u32 v68, s5, v5
    v_add_u32 v69, 43008, v68
    v_mov_b32 v72, 0
    v_mov_b32 v73, 0
    v_mov_b32 v74, 0
    v_mov_b32 v75, 0
    v_mov_b32 v76, 0
    v_mov_b32 v77, 0
    v_mov_b32 v78, 0
    v_mov_b32 v79, 0
    v_mov_b32 v80, 0
    v_mov_b32 v81, 0
    v_mov_b32 v82, 0
    v_mov_b32 v83, 0
    v_mov_b32 v84, 0
    v_mov_b32 v85, 0
    v_mov_b32 v86, 0
    v_mov_b32 v87, 0
    v_mov_b32 v88, 0
    v_mov_b32 v89, 0
    v_mov_b32 v90, 0
    v_mov_b32 v91, 0
    v_mov_b32 v92, 0
    v_mov_b32 v93, 0
    v_mov_b32 v94, 0
    v_mov_b32 v95, 0
    v_mov_b32 v96, 0
    v_mov_b32 v97, 0
    v_mov_b32 v98, 0
    v_mov_b32 v99, 0
    v_mov_b32 v100, 0
    v_mov_b32 v101, 0
    v_mov_b32 v102, 0
    v_mov_b32 v103, 0
    s_mov_b32 s90, 0xbdd2d3e8
    v_mov_b32 v70, 0xc0135761
    s_waitcnt lgkmcnt(0)
    s_waitcnt vmcnt(0)
    s_barrier
    ds_read_b128 v[12:15], v64 offset:0
    ds_read_b64_tr_b16 v[16:17], v68 offset:0
    ds_read_b64_tr_b16 v[18:19], v68 offset:1792
    ds_read_b64_tr_b16 v[20:21], v68 offset:32
    ds_read_b64_tr_b16 v[22:23], v68 offset:1824
    ds_read_b64_tr_b16 v[24:25], v68 offset:64
    ds_read_b64_tr_b16 v[26:27], v68 offset:1856
    ds_read_b64_tr_b16 v[28:29], v68 offset:96
    ds_read_b64_tr_b16 v[30:31], v68 offset:1888
    ds_read_b128 v[32:35], v65 offset:1024
    ds_read_b64_tr_b16 v[36:37], v68 offset:7168
    ds_read_b64_tr_b16 v[38:39], v68 offset:8960
    ds_read_b64_tr_b16 v[40:41], v68 offset:7200
    ds_read_b64_tr_b16 v[42:43], v68 offset:8992
    ds_read_b64_tr_b16 v[44:45], v68 offset:7232
    ds_read_b64_tr_b16 v[46:47], v68 offset:9024
    ds_read_b64_tr_b16 v[48:49], v68 offset:7264
    ds_read_b64_tr_b16 v[50:51], v68 offset:9056
    s_waitcnt lgkmcnt(9)
    v_mfma_f32_16x16x32_bf16 v[72:75], v[16:19], v[12:15], v[72:75]
    s_waitcnt vmcnt(0)
    s_barrier
    ds_read_b128 v[104:107], v66 offset:2048
    ds_read_b64_tr_b16 v[108:109], v68 offset:14336
    ds_read_b64_tr_b16 v[110:111], v68 offset:16128
    v_mfma_f32_16x16x32_bf16 v[76:79], v[20:23], v[12:15], v[76:79]
    ds_read_b64_tr_b16 v[112:113], v68 offset:14368
    ds_read_b64_tr_b16 v[114:115], v68 offset:16160
    ds_read_b64_tr_b16 v[116:117], v68 offset:14400
    v_mfma_f32_16x16x32_bf16 v[80:83], v[24:27], v[12:15], v[80:83]
    ds_read_b64_tr_b16 v[118:119], v68 offset:16192
    ds_read_b64_tr_b16 v[120:121], v68 offset:14432
    ds_read_b64_tr_b16 v[122:123], v68 offset:16224
    v_mfma_f32_16x16x32_bf16 v[84:87], v[28:31], v[12:15], v[84:87]
    s_waitcnt lgkmcnt(9)
    v_mfma_f32_16x16x32_bf16 v[72:75], v[36:39], v[32:35], v[72:75]
    ds_read_b128 v[12:15], v67 offset:3072
    ds_read_b64_tr_b16 v[16:17], v68 offset:21504
    ds_read_b64_tr_b16 v[18:19], v68 offset:23296
    v_mfma_f32_16x16x32_bf16 v[76:79], v[40:43], v[32:35], v[76:79]
    ds_read_b64_tr_b16 v[20:21], v68 offset:21536
    ds_read_b64_tr_b16 v[22:23], v68 offset:23328
    ds_read_b64_tr_b16 v[24:25], v68 offset:21568
    v_mfma_f32_16x16x32_bf16 v[80:83], v[44:47], v[32:35], v[80:83]
    ds_read_b64_tr_b16 v[26:27], v68 offset:23360
    ds_read_b64_tr_b16 v[28:29], v68 offset:21600
    ds_read_b64_tr_b16 v[30:31], v68 offset:23392
    v_mfma_f32_16x16x32_bf16 v[84:87], v[48:51], v[32:35], v[84:87]
    s_waitcnt lgkmcnt(9)
    v_mfma_f32_16x16x32_bf16 v[72:75], v[108:111], v[104:107], v[72:75]
    s_waitcnt vmcnt(0)
    s_barrier
    ds_read_b128 v[32:35], v64 offset:4096
    ds_read_b64_tr_b16 v[36:37], v68 offset:28672
    ds_read_b64_tr_b16 v[38:39], v68 offset:30464
    v_mfma_f32_16x16x32_bf16 v[76:79], v[112:115], v[104:107], v[76:79]
    ds_read_b64_tr_b16 v[40:41], v68 offset:28704
    ds_read_b64_tr_b16 v[42:43], v68 offset:30496
    ds_read_b64_tr_b16 v[44:45], v68 offset:28736
    v_mfma_f32_16x16x32_bf16 v[80:83], v[116:119], v[104:107], v[80:83]
    ds_read_b64_tr_b16 v[46:47], v68 offset:30528
    ds_read_b64_tr_b16 v[48:49], v68 offset:28768
    ds_read_b64_tr_b16 v[50:51], v68 offset:30560
    v_mfma_f32_16x16x32_bf16 v[84:87], v[120:123], v[104:107], v[84:87]
    s_add_u32 s5, s15, 86016
    s_add_u32 m0, s14, 0
    s_nop 0
    buffer_load_dwordx4 v2, s[56:59], s5 offen offset:0 sc1 lds
    s_mov_b64 exec, s[12:13]
    buffer_load_dwordx4 v2, s[56:59], s5 offen offset:1024 sc1 lds
    s_mov_b64 exec, -1
    s_waitcnt lgkmcnt(9)
    v_mfma_f32_16x16x32_bf16 v[72:75], v[16:19], v[12:15], v[72:75]
    ds_read_b128 v[104:107], v65 offset:5120
    ds_read_b64_tr_b16 v[108:109], v68 offset:35840
    ds_read_b64_tr_b16 v[110:111], v68 offset:37632
    v_mfma_f32_16x16x32_bf16 v[76:79], v[20:23], v[12:15], v[76:79]
    ds_read_b64_tr_b16 v[112:113], v68 offset:35872
    ds_read_b64_tr_b16 v[114:115], v68 offset:37664
    ds_read_b64_tr_b16 v[116:117], v68 offset:35904
    v_mfma_f32_16x16x32_bf16 v[80:83], v[24:27], v[12:15], v[80:83]
    ds_read_b64_tr_b16 v[118:119], v68 offset:37696
    ds_read_b64_tr_b16 v[120:121], v68 offset:35936
    ds_read_b64_tr_b16 v[122:123], v68 offset:37728
    v_mfma_f32_16x16x32_bf16 v[84:87], v[28:31], v[12:15], v[84:87]
    s_waitcnt lgkmcnt(9)
    v_mfma_f32_16x16x32_bf16 v[72:75], v[36:39], v[32:35], v[72:75]
    s_waitcnt vmcnt(2)
    s_barrier
    ds_read_b128 v[12:15], v66 offset:6144
    ds_read_b64_tr_b16 v[16:17], v69 offset:0
    ds_read_b64_tr_b16 v[18:19], v69 offset:1792
    v_mfma_f32_16x16x32_bf16 v[76:79], v[40:43], v[32:35], v[76:79]
    ds_read_b64_tr_b16 v[20:21], v69 offset:32
    ds_read_b64_tr_b16 v[22:23], v69 offset:1824
    ds_read_b64_tr_b16 v[24:25], v69 offset:64
    v_mfma_f32_16x16x32_bf16 v[80:83], v[44:47], v[32:35], v[80:83]
    ds_read_b64_tr_b16 v[26:27], v69 offset:1856
    ds_read_b64_tr_b16 v[28:29], v69 offset:96
    ds_read_b64_tr_b16 v[30:31], v69 offset:1888
    v_mfma_f32_16x16x32_bf16 v[84:87], v[48:51], v[32:35], v[84:87]
    s_add_u32 s5, s15, 100352
    s_add_u32 m0, s14, 14336
    s_nop 0
    buffer_load_dwordx4 v2, s[56:59], s5 offen offset:0 sc1 lds
    s_mov_b64 exec, s[12:13]
    buffer_load_dwordx4 v2, s[56:59], s5 offen offset:1024 sc1 lds
    s_mov_b64 exec, -1
    s_waitcnt lgkmcnt(9)
    v_mfma_f32_16x16x32_bf16 v[72:75], v[108:111], v[104:107], v[72:75]
    ds_read_b128 v[32:35], v67 offset:7168
    ds_read_b64_tr_b16 v[36:37], v69 offset:7168
    ds_read_b64_tr_b16 v[38:39], v69 offset:8960
    v_mfma_f32_16x16x32_bf16 v[76:79], v[112:115], v[104:107], v[76:79]
    ds_read_b64_tr_b16 v[40:41], v69 offset:7200
    ds_read_b64_tr_b16 v[42:43], v69 offset:8992
    ds_read_b64_tr_b16 v[44:45], v69 offset:7232
    v_mfma_f32_16x16x32_bf16 v[80:83], v[116:119], v[104:107], v[80:83]
    ds_read_b64_tr_b16 v[46:47], v69 offset:9024
    ds_read_b64_tr_b16 v[48:49], v69 offset:7264
    ds_read_b64_tr_b16 v[50:51], v69 offset:9056
    v_mfma_f32_16x16x32_bf16 v[84:87], v[120:123], v[104:107], v[84:87]
    s_waitcnt lgkmcnt(9)
    v_mfma_f32_16x16x32_bf16 v[72:75], v[16:19], v[12:15], v[72:75]
    s_waitcnt vmcnt(4)
    s_barrier
    ds_read_b128 v[104:107], v64 offset:8192
    ds_read_b64_tr_b16 v[108:109], v69 offset:14336
    ds_read_b64_tr_b16 v[110:111], v69 offset:16128
    v_mfma_f32_16x16x32_bf16 v[76:79], v[20:23], v[12:15], v[76:79]
    ds_read_b64_tr_b16 v[112:113], v69 offset:14368
    ds_read_b64_tr_b16 v[114:115], v69 offset:16160
    ds_read_b64_tr_b16 v[116:117], v69 offset:14400
    v_mfma_f32_16x16x32_bf16 v[80:83], v[24:27], v[12:15], v[80:83]
    ds_read_b64_tr_b16 v[118:119], v69 offset:16192
    ds_read_b64_tr_b16 v[120:121], v69 offset:14432
    ds_read_b64_tr_b16 v[122:123], v69 offset:16224
    v_mfma_f32_16x16x32_bf16 v[84:87], v[28:31], v[12:15], v[84:87]
    s_add_u32 s5, s15, 114688
    s_add_u32 m0, s14, 28672
    s_nop 0
    buffer_load_dwordx4 v2, s[56:59], s5 offen offset:0 sc1 lds
    s_mov_b64 exec, s[12:13]
    buffer_load_dwordx4 v2, s[56:59], s5 offen offset:1024 sc1 lds
    s_mov_b64 exec, -1
    s_waitcnt lgkmcnt(9)
    v_mfma_f32_16x16x32_bf16 v[72:75], v[36:39], v[32:35], v[72:75]
    ds_read_b128 v[12:15], v65 offset:9216
    ds_read_b64_tr_b16 v[16:17], v69 offset:21504
    ds_read_b64_tr_b16 v[18:19], v69 offset:23296
    v_mfma_f32_16x16x32_bf16 v[76:79], v[40:43], v[32:35], v[76:79]
    ds_read_b64_tr_b16 v[20:21], v69 offset:21536
    ds_read_b64_tr_b16 v[22:23], v69 offset:23328
    ds_read_b64_tr_b16 v[24:25], v69 offset:21568
    v_mfma_f32_16x16x32_bf16 v[80:83], v[44:47], v[32:35], v[80:83]
    ds_read_b64_tr_b16 v[26:27], v69 offset:23360
    ds_read_b64_tr_b16 v[28:29], v69 offset:21600
    ds_read_b64_tr_b16 v[30:31], v69 offset:23392
    v_mfma_f32_16x16x32_bf16 v[84:87], v[48:51], v[32:35], v[84:87]
    s_waitcnt lgkmcnt(9)
    v_mfma_f32_16x16x32_bf16 v[72:75], v[108:111], v[104:107], v[72:75]
    s_waitcnt vmcnt(6)
    s_barrier
    ds_read_b128 v[32:35], v66 offset:10240
    ds_read_b64_tr_b16 v[36:37], v69 offset:28672
    ds_read_b64_tr_b16 v[38:39], v69 offset:30464
    v_mfma_f32_16x16x32_bf16 v[76:79], v[112:115], v[104:107], v[76:79]
    ds_read_b64_tr_b16 v[40:41], v69 offset:28704
    ds_read_b64_tr_b16 v[42:43], v69 offset:30496
    ds_read_b64_tr_b16 v[44:45], v69 offset:28736
    v_mfma_f32_16x16x32_bf16 v[80:83], v[116:119], v[104:107], v[80:83]
    ds_read_b64_tr_b16 v[46:47], v69 offset:30528
    ds_read_b64_tr_b16 v[48:49], v69 offset:28768
    ds_read_b64_tr_b16 v[50:51], v69 offset:30560
    v_mfma_f32_16x16x32_bf16 v[84:87], v[120:123], v[104:107], v[84:87]
    s_add_u32 s5, s15, 129024
    s_add_u32 m0, s14, 43008
    s_nop 0
    buffer_load_dwordx4 v2, s[56:59], s5 offen offset:0 sc1 lds
    s_mov_b64 exec, s[12:13]
    buffer_load_dwordx4 v2, s[56:59], s5 offen offset:1024 sc1 lds
    s_mov_b64 exec, -1
    s_waitcnt lgkmcnt(9)
    v_mfma_f32_16x16x32_bf16 v[72:75], v[16:19], v[12:15], v[72:75]
    ds_read_b128 v[104:107], v67 offset:11264
    ds_read_b64_tr_b16 v[108:109], v69 offset:35840
    ds_read_b64_tr_b16 v[110:111], v69 offset:37632
    v_mfma_f32_16x16x32_bf16 v[76:79], v[20:23], v[12:15], v[76:79]
    ds_read_b64_tr_b16 v[112:113], v69 offset:35872
    ds_read_b64_tr_b16 v[114:115], v69 offset:37664
    ds_read_b64_tr_b16 v[116:117], v69 offset:35904
    v_mfma_f32_16x16x32_bf16 v[80:83], v[24:27], v[12:15], v[80:83]
    ds_read_b64_tr_b16 v[118:119], v69 offset:37696
    ds_read_b64_tr_b16 v[120:121], v69 offset:35936
    ds_read_b64_tr_b16 v[122:123], v69 offset:37728
    v_mfma_f32_16x16x32_bf16 v[84:87], v[28:31], v[12:15], v[84:87]
    s_waitcnt lgkmcnt(9)
    v_mfma_f32_16x16x32_bf16 v[72:75], v[36:39], v[32:35], v[72:75]
    s_waitcnt vmcnt(6)
    s_barrier
    ds_read_b128 v[12:15], v64 offset:12288
    ds_read_b64_tr_b16 v[16:17], v68 offset:0
    ds_read_b64_tr_b16 v[18:19], v68 offset:1792
    v_mfma_f32_16x16x32_bf16 v[76:79], v[40:43], v[32:35], v[76:79]
    ds_read_b64_tr_b16 v[20:21], v68 offset:32
    ds_read_b64_tr_b16 v[22:23], v68 offset:1824
    ds_read_b64_tr_b16 v[24:25], v68 offset:64
    v_mfma_f32_16x16x32_bf16 v[80:83], v[44:47], v[32:35], v[80:83]
    ds_read_b64_tr_b16 v[26:27], v68 offset:1856
    ds_read_b64_tr_b16 v[28:29], v68 offset:96
    ds_read_b64_tr_b16 v[30:31], v68 offset:1888
    v_mfma_f32_16x16x32_bf16 v[84:87], v[48:51], v[32:35], v[84:87]
    s_add_u32 s5, s15, 143360
    s_add_u32 m0, s14, 57344
    s_nop 0
    buffer_load_dwordx4 v2, s[56:59], s5 offen offset:0 sc1 lds
    s_mov_b64 exec, s[12:13]
    buffer_load_dwordx4 v2, s[56:59], s5 offen offset:1024 sc1 lds
    s_mov_b64 exec, -1
    s_waitcnt lgkmcnt(9)
    v_mfma_f32_16x16x32_bf16 v[72:75], v[108:111], v[104:107], v[72:75]
    ds_read_b128 v[32:35], v65 offset:13312
    ds_read_b64_tr_b16 v[36:37], v68 offset:7168
    ds_read_b64_tr_b16 v[38:39], v68 offset:8960
    v_mfma_f32_16x16x32_bf16 v[76:79], v[112:115], v[104:107], v[76:79]
    ds_read_b64_tr_b16 v[40:41], v68 offset:7200
    ds_read_b64_tr_b16 v[42:43], v68 offset:8992
    ds_read_b64_tr_b16 v[44:45], v68 offset:7232
    v_mfma_f32_16x16x32_bf16 v[80:83], v[116:119], v[104:107], v[80:83]
    ds_read_b64_tr_b16 v[46:47], v68 offset:9024
    ds_read_b64_tr_b16 v[48:49], v68 offset:7264
    ds_read_b64_tr_b16 v[50:51], v68 offset:9056
    v_mfma_f32_16x16x32_bf16 v[84:87], v[120:123], v[104:107], v[84:87]
    s_waitcnt lgkmcnt(9)
    v_mfma_f32_16x16x32_bf16 v[72:75], v[16:19], v[12:15], v[72:75]
    s_waitcnt vmcnt(6)
    s_barrier
    ds_read_b128 v[104:107], v66 offset:14336
    ds_read_b64_tr_b16 v[108:109], v68 offset:14336
    ds_read_b64_tr_b16 v[110:111], v68 offset:16128
    v_mfma_f32_16x16x32_bf16 v[76:79], v[20:23], v[12:15], v[76:79]
    ds_read_b64_tr_b16 v[112:113], v68 offset:14368
    ds_read_b64_tr_b16 v[114:115], v68 offset:16160
    ds_read_b64_tr_b16 v[116:117], v68 offset:14400
    v_mfma_f32_16x16x32_bf16 v[80:83], v[24:27], v[12:15], v[80:83]
    ds_read_b64_tr_b16 v[118:119], v68 offset:16192
    ds_read_b64_tr_b16 v[120:121], v68 offset:14432
    ds_read_b64_tr_b16 v[122:123], v68 offset:16224
    v_mfma_f32_16x16x32_bf16 v[84:87], v[28:31], v[12:15], v[84:87]
    s_add_u32 s5, s15, 157696
    s_add_u32 m0, s14, 71680
    s_nop 0
    buffer_load_dwordx4 v2, s[56:59], s5 offen offset:0 sc1 lds
    s_mov_b64 exec, s[12:13]
    buffer_load_dwordx4 v2, s[56:59], s5 offen offset:1024 sc1 lds
    s_mov_b64 exec, -1
    s_waitcnt lgkmcnt(9)
    v_mfma_f32_16x16x32_bf16 v[72:75], v[36:39], v[32:35], v[72:75]
    ds_read_b128 v[12:15], v67 offset:15360
    ds_read_b64_tr_b16 v[16:17], v68 offset:21504
    ds_read_b64_tr_b16 v[18:19], v68 offset:23296
    v_mfma_f32_16x16x32_bf16 v[76:79], v[40:43], v[32:35], v[76:79]
    ds_read_b64_tr_b16 v[20:21], v68 offset:21536
    ds_read_b64_tr_b16 v[22:23], v68 offset:23328
    ds_read_b64_tr_b16 v[24:25], v68 offset:21568
    v_mfma_f32_16x16x32_bf16 v[80:83], v[44:47], v[32:35], v[80:83]
    ds_read_b64_tr_b16 v[26:27], v68 offset:23360
    ds_read_b64_tr_b16 v[28:29], v68 offset:21600
    ds_read_b64_tr_b16 v[30:31], v68 offset:23392
    v_mfma_f32_16x16x32_bf16 v[84:87], v[48:51], v[32:35], v[84:87]
    s_waitcnt lgkmcnt(9)
    v_mfma_f32_16x16x32_bf16 v[72:75], v[108:111], v[104:107], v[72:75]
    s_waitcnt vmcnt(6)
    s_barrier
    ds_read_b128 v[32:35], v64 offset:0
    ds_read_b64_tr_b16 v[36:37], v68 offset:28672
    ds_read_b64_tr_b16 v[38:39], v68 offset:30464
    v_mfma_f32_16x16x32_bf16 v[76:79], v[112:115], v[104:107], v[76:79]
    ds_read_b64_tr_b16 v[40:41], v68 offset:28704
    ds_read_b64_tr_b16 v[42:43], v68 offset:30496
    ds_read_b64_tr_b16 v[44:45], v68 offset:28736
    v_mfma_f32_16x16x32_bf16 v[80:83], v[116:119], v[104:107], v[80:83]
    ds_read_b64_tr_b16 v[46:47], v68 offset:30528
    ds_read_b64_tr_b16 v[48:49], v68 offset:28768
    ds_read_b64_tr_b16 v[50:51], v68 offset:30560
    v_mfma_f32_16x16x32_bf16 v[84:87], v[120:123], v[104:107], v[84:87]
    s_add_u32 s5, s15, 172032
    s_add_u32 m0, s14, 0
    s_nop 0
    buffer_load_dwordx4 v2, s[56:59], s5 offen offset:0 sc1 lds
    s_mov_b64 exec, s[12:13]
    buffer_load_dwordx4 v2, s[56:59], s5 offen offset:1024 sc1 lds
    s_mov_b64 exec, -1
    s_waitcnt lgkmcnt(9)
    v_mfma_f32_16x16x32_bf16 v[72:75], v[16:19], v[12:15], v[72:75]
    ds_read_b128 v[104:107], v65 offset:1024
    ds_read_b64_tr_b16 v[108:109], v68 offset:35840
    ds_read_b64_tr_b16 v[110:111], v68 offset:37632
    v_mfma_f32_16x16x32_bf16 v[76:79], v[20:23], v[12:15], v[76:79]
    ds_read_b64_tr_b16 v[112:113], v68 offset:35872
    ds_read_b64_tr_b16 v[114:115], v68 offset:37664
    ds_read_b64_tr_b16 v[116:117], v68 offset:35904
    v_mfma_f32_16x16x32_bf16 v[80:83], v[24:27], v[12:15], v[80:83]
    ds_read_b64_tr_b16 v[118:119], v68 offset:37696
    ds_read_b64_tr_b16 v[120:121], v68 offset:35936
    ds_read_b64_tr_b16 v[122:123], v68 offset:37728
    v_mfma_f32_16x16x32_bf16 v[84:87], v[28:31], v[12:15], v[84:87]
    v_pk_mul_f32 v[8:9], v[72:73], v[72:73]
    v_pk_mul_f32 v[10:11], v[74:75], v[74:75]
    v_pk_fma_f32 v[8:9], v[8:9], s[90:91], v[70:71] op_sel:[0,0,0] op_sel_hi:[1,0,0]
    v_pk_fma_f32 v[10:11], v[10:11], s[90:91], v[70:71] op_sel:[0,0,0] op_sel_hi:[1,0,0]
    v_pk_mul_f32 v[8:9], v[8:9], v[72:73]
    v_pk_mul_f32 v[10:11], v[10:11], v[74:75]
    v_exp_f32 v8, v8
    v_exp_f32 v9, v9
    v_exp_f32 v10, v10
    v_exp_f32 v11, v11
    v_pk_add_f32 v[8:9], v[8:9], 1.0 op_sel_hi:[1,0]
    v_pk_add_f32 v[10:11], v[10:11], 1.0 op_sel_hi:[1,0]
    v_rcp_f32 v8, v8
    v_rcp_f32 v9, v9
    v_rcp_f32 v10, v10
    v_rcp_f32 v11, v11
    v_pk_mul_f32 v[72:73], v[72:73], v[8:9]
    v_pk_mul_f32 v[74:75], v[74:75], v[10:11]
    v_pk_mul_f32 v[8:9], v[76:77], v[76:77]
    v_pk_mul_f32 v[10:11], v[78:79], v[78:79]
    v_pk_fma_f32 v[8:9], v[8:9], s[90:91], v[70:71] op_sel:[0,0,0] op_sel_hi:[1,0,0]
    v_pk_fma_f32 v[10:11], v[10:11], s[90:91], v[70:71] op_sel:[0,0,0] op_sel_hi:[1,0,0]
    v_pk_mul_f32 v[8:9], v[8:9], v[76:77]
    v_pk_mul_f32 v[10:11], v[10:11], v[78:79]
    v_exp_f32 v8, v8
    v_exp_f32 v9, v9
    v_exp_f32 v10, v10
    v_exp_f32 v11, v11
    v_pk_add_f32 v[8:9], v[8:9], 1.0 op_sel_hi:[1,0]
    v_pk_add_f32 v[10:11], v[10:11], 1.0 op_sel_hi:[1,0]
    v_rcp_f32 v8, v8
    v_rcp_f32 v9, v9
    v_rcp_f32 v10, v10
    v_rcp_f32 v11, v11
    v_pk_mul_f32 v[76:77], v[76:77], v[8:9]
    v_pk_mul_f32 v[78:79], v[78:79], v[10:11]
    v_pk_mul_f32 v[8:9], v[80:81], v[80:81]
    v_pk_mul_f32 v[10:11], v[82:83], v[82:83]
    v_pk_fma_f32 v[8:9], v[8:9], s[90:91], v[70:71] op_sel:[0,0,0] op_sel_hi:[1,0,0]
    v_pk_fma_f32 v[10:11], v[10:11], s[90:91], v[70:71] op_sel:[0,0,0] op_sel_hi:[1,0,0]
    v_pk_mul_f32 v[8:9], v[8:9], v[80:81]
    v_pk_mul_f32 v[10:11], v[10:11], v[82:83]
    v_exp_f32 v8, v8
    v_exp_f32 v9, v9
    v_exp_f32 v10, v10
    v_exp_f32 v11, v11
    v_pk_add_f32 v[8:9], v[8:9], 1.0 op_sel_hi:[1,0]
    v_pk_add_f32 v[10:11], v[10:11], 1.0 op_sel_hi:[1,0]
    v_rcp_f32 v8, v8
    v_rcp_f32 v9, v9
    v_rcp_f32 v10, v10
    v_rcp_f32 v11, v11
    v_pk_mul_f32 v[80:81], v[80:81], v[8:9]
    v_pk_mul_f32 v[82:83], v[82:83], v[10:11]
    v_pk_mul_f32 v[8:9], v[84:85], v[84:85]
    v_pk_mul_f32 v[10:11], v[86:87], v[86:87]
    v_pk_fma_f32 v[8:9], v[8:9], s[90:91], v[70:71] op_sel:[0,0,0] op_sel_hi:[1,0,0]
    v_pk_fma_f32 v[10:11], v[10:11], s[90:91], v[70:71] op_sel:[0,0,0] op_sel_hi:[1,0,0]
    v_pk_mul_f32 v[8:9], v[8:9], v[84:85]
    v_pk_mul_f32 v[10:11], v[10:11], v[86:87]
    v_exp_f32 v8, v8
    v_exp_f32 v9, v9
    v_exp_f32 v10, v10
    v_exp_f32 v11, v11
    v_pk_add_f32 v[8:9], v[8:9], 1.0 op_sel_hi:[1,0]
    v_pk_add_f32 v[10:11], v[10:11], 1.0 op_sel_hi:[1,0]
    v_rcp_f32 v8, v8
    v_rcp_f32 v9, v9
    v_rcp_f32 v10, v10
    v_rcp_f32 v11, v11
    v_pk_mul_f32 v[84:85], v[84:85], v[8:9]
    v_pk_mul_f32 v[86:87], v[86:87], v[10:11]
    v_mov_b32 v8, 0
    v_mov_b32 v9, 0
    v_add_f32 v8, v8, v72
    v_fmac_f32 v9, v72, v72
    v_add_f32 v8, v8, v73
    v_fmac_f32 v9, v73, v73
    v_add_f32 v8, v8, v74
    v_fmac_f32 v9, v74, v74
    v_add_f32 v8, v8, v75
    v_fmac_f32 v9, v75, v75
    v_add_f32 v8, v8, v76
    v_fmac_f32 v9, v76, v76
    v_add_f32 v8, v8, v77
    v_fmac_f32 v9, v77, v77
    v_add_f32 v8, v8, v78
    v_fmac_f32 v9, v78, v78
    v_add_f32 v8, v8, v79
    v_fmac_f32 v9, v79, v79
    v_add_f32 v8, v8, v80
    v_fmac_f32 v9, v80, v80
    v_add_f32 v8, v8, v81
    v_fmac_f32 v9, v81, v81
    v_add_f32 v8, v8, v82
    v_fmac_f32 v9, v82, v82
    v_add_f32 v8, v8, v83
    v_fmac_f32 v9, v83, v83
    s_cmp_ge_u32 s3, 4
    s_cbranch_scc1 es_17022
    v_add_f32 v8, v8, v84
    v_fmac_f32 v9, v84, v84
    v_add_f32 v8, v8, v85
    v_fmac_f32 v9, v85, v85
    v_add_f32 v8, v8, v86
    v_fmac_f32 v9, v86, v86
    v_add_f32 v8, v8, v87
    v_fmac_f32 v9, v87, v87
es_17022:
    v_mov_b32 v6, v8
    s_nop 1
    v_permlane16_swap_b32 v8, v6
    v_add_f32 v8, v8, v6
    v_mov_b32 v6, v9
    s_nop 1
    v_permlane16_swap_b32 v9, v6
    v_add_f32 v9, v9, v6
    v_mov_b32 v6, v8
    s_nop 1
    v_permlane32_swap_b32 v8, v6
    v_add_f32 v8, v8, v6
    v_mov_b32 v6, v9
    s_nop 1
    v_permlane32_swap_b32 v9, v6
    v_add_f32 v9, v9, v6
    v_and_b32 v71, 15, v1
    s_and_b32 s5, s3, 3
    s_lshl_b32 s5, s5, 4
    s_add_u32 s5, s5, s10
    v_add_u32 v71, s5, v71
    s_lshr_b32 s5, s3, 2
    s_lshl_b32 s6, s9, 1
    s_add_u32 s5, s5, s6
    s_lshl_b32 s5, s5, 3
    v_lshlrev_b32 v5, 7, v71
    v_or_b32 v9, 0x80000000, v9
    s_mov_b64 exec, 0xffff
    buffer_store_dwordx2 v[8:9], v5, s[60:63], s5 offen sc0 sc1
    s_mov_b64 exec, -1
    v_lshrrev_b32 v5, 4, v1
    v_lshlrev_b32 v5, 5, v5
    v_lshl_add_u32 v60, v71, 7, v5
    s_waitcnt lgkmcnt(9)
    v_mfma_f32_16x16x32_bf16 v[88:91], v[36:39], v[32:35], v[88:91]
    s_waitcnt vmcnt(7)
    s_barrier
    ds_read_b128 v[12:15], v66 offset:2048
    ds_read_b64_tr_b16 v[16:17], v69 offset:0
    ds_read_b64_tr_b16 v[18:19], v69 offset:1792
    v_mfma_f32_16x16x32_bf16 v[92:95], v[40:43], v[32:35], v[92:95]
    ds_read_b64_tr_b16 v[20:21], v69 offset:32
    ds_read_b64_tr_b16 v[22:23], v69 offset:1824
    ds_read_b64_tr_b16 v[24:25], v69 offset:64
    v_mfma_f32_16x16x32_bf16 v[96:99], v[44:47], v[32:35], v[96:99]
    ds_read_b64_tr_b16 v[26:27], v69 offset:1856
    ds_read_b64_tr_b16 v[28:29], v69 offset:96
    ds_read_b64_tr_b16 v[30:31], v69 offset:1888
    v_mfma_f32_16x16x32_bf16 v[100:103], v[48:51], v[32:35], v[100:103]
    s_add_u32 s5, s15, 186368
    s_add_u32 m0, s14, 14336
    s_nop 0
    buffer_load_dwordx4 v2, s[56:59], s5 offen offset:0 sc1 lds
    s_mov_b64 exec, s[12:13]
    buffer_load_dwordx4 v2, s[56:59], s5 offen offset:1024 sc1 lds
    s_mov_b64 exec, -1
    s_waitcnt lgkmcnt(9)
    v_mfma_f32_16x16x32_bf16 v[88:91], v[108:111], v[104:107], v[88:91]
    ds_read_b128 v[32:35], v67 offset:3072
    ds_read_b64_tr_b16 v[36:37], v69 offset:7168
    ds_read_b64_tr_b16 v[38:39], v69 offset:8960
    v_mfma_f32_16x16x32_bf16 v[92:95], v[112:115], v[104:107], v[92:95]
    ds_read_b64_tr_b16 v[40:41], v69 offset:7200
    ds_read_b64_tr_b16 v[42:43], v69 offset:8992
    ds_read_b64_tr_b16 v[44:45], v69 offset:7232
    v_mfma_f32_16x16x32_bf16 v[96:99], v[116:119], v[104:107], v[96:99]
    ds_read_b64_tr_b16 v[46:47], v69 offset:9024
    ds_read_b64_tr_b16 v[48:49], v69 offset:7264
    ds_read_b64_tr_b16 v[50:51], v69 offset:9056
    v_mfma_f32_16x16x32_bf16 v[100:103], v[120:123], v[104:107], v[100:103]
    s_waitcnt lgkmcnt(9)
    v_mfma_f32_16x16x32_bf16 v[88:91], v[16:19], v[12:15], v[88:91]
    s_waitcnt vmcnt(7)
    s_barrier
    ds_read_b128 v[104:107], v64 offset:4096
    ds_read_b64_tr_b16 v[108:109], v69 offset:14336
    ds_read_b64_tr_b16 v[110:111], v69 offset:16128
    v_mfma_f32_16x16x32_bf16 v[92:95], v[20:23], v[12:15], v[92:95]
    ds_read_b64_tr_b16 v[112:113], v69 offset:14368
    ds_read_b64_tr_b16 v[114:115], v69 offset:16160
    ds_read_b64_tr_b16 v[116:117], v69 offset:14400
    v_mfma_f32_16x16x32_bf16 v[96:99], v[24:27], v[12:15], v[96:99]
    ds_read_b64_tr_b16 v[118:119], v69 offset:16192
    ds_read_b64_tr_b16 v[120:121], v69 offset:14432
    ds_read_b64_tr_b16 v[122:123], v69 offset:16224
    v_mfma_f32_16x16x32_bf16 v[100:103], v[28:31], v[12:15], v[100:103]
    s_add_u32 s5, s15, 200704
    s_add_u32 m0, s14, 28672
    s_nop 0
    buffer_load_dwordx4 v2, s[56:59], s5 offen offset:0 sc1 lds
    s_mov_b64 exec, s[12:13]
    buffer_load_dwordx4 v2, s[56:59], s5 offen offset:1024 sc1 lds
    s_mov_b64 exec, -1
    s_waitcnt lgkmcnt(9)
    v_mfma_f32_16x16x32_bf16 v[88:91], v[36:39], v[32:35], v[88:91]
    ds_read_b128 v[12:15], v65 offset:5120
    ds_read_b64_tr_b16 v[16:17], v69 offset:21504
    ds_read_b64_tr_b16 v[18:19], v69 offset:23296
    v_mfma_f32_16x16x32_bf16 v[92:95], v[40:43], v[32:35], v[92:95]
    ds_read_b64_tr_b16 v[20:21], v69 offset:21536
    ds_read_b64_tr_b16 v[22:23], v69 offset:23328
    ds_read_b64_tr_b16 v[24:25], v69 offset:21568
    v_mfma_f32_16x16x32_bf16 v[96:99], v[44:47], v[32:35], v[96:99]
    ds_read_b64_tr_b16 v[26:27], v69 offset:23360
    ds_read_b64_tr_b16 v[28:29], v69 offset:21600
    ds_read_b64_tr_b16 v[30:31], v69 offset:23392
    v_mfma_f32_16x16x32_bf16 v[100:103], v[48:51], v[32:35], v[100:103]
    s_waitcnt lgkmcnt(9)
    v_mfma_f32_16x16x32_bf16 v[88:91], v[108:111], v[104:107], v[88:91]
    s_waitcnt vmcnt(7)
    s_barrier
    ds_read_b128 v[32:35], v66 offset:6144
    ds_read_b64_tr_b16 v[36:37], v69 offset:28672
    ds_read_b64_tr_b16 v[38:39], v69 offset:30464
    v_mfma_f32_16x16x32_bf16 v[92:95], v[112:115], v[104:107], v[92:95]
    ds_read_b64_tr_b16 v[40:41], v69 offset:28704
    ds_read_b64_tr_b16 v[42:43], v69 offset:30496
    ds_read_b64_tr_b16 v[44:45], v69 offset:28736
    v_mfma_f32_16x16x32_bf16 v[96:99], v[116:119], v[104:107], v[96:99]
    ds_read_b64_tr_b16 v[46:47], v69 offset:30528
    ds_read_b64_tr_b16 v[48:49], v69 offset:28768
    ds_read_b64_tr_b16 v[50:51], v69 offset:30560
    v_mfma_f32_16x16x32_bf16 v[100:103], v[120:123], v[104:107], v[100:103]
    s_add_u32 s5, s15, 215040
    s_add_u32 m0, s14, 43008
    s_nop 0
    buffer_load_dwordx4 v2, s[56:59], s5 offen offset:0 sc1 lds
    s_mov_b64 exec, s[12:13]
    buffer_load_dwordx4 v2, s[56:59], s5 offen offset:1024 sc1 lds
    s_mov_b64 exec, -1
    s_waitcnt lgkmcnt(9)
    v_mfma_f32_16x16x32_bf16 v[88:91], v[16:19], v[12:15], v[88:91]
    ds_read_b128 v[104:107], v67 offset:7168
    ds_read_b64_tr_b16 v[108:109], v69 offset:35840
    ds_read_b64_tr_b16 v[110:111], v69 offset:37632
    v_mfma_f32_16x16x32_bf16 v[92:95], v[20:23], v[12:15], v[92:95]
    ds_read_b64_tr_b16 v[112:113], v69 offset:35872
    ds_read_b64_tr_b16 v[114:115], v69 offset:37664
    ds_read_b64_tr_b16 v[116:117], v69 offset:35904
    v_mfma_f32_16x16x32_bf16 v[96:99], v[24:27], v[12:15], v[96:99]
    ds_read_b64_tr_b16 v[118:119], v69 offset:37696
    ds_read_b64_tr_b16 v[120:121], v69 offset:35936
    ds_read_b64_tr_b16 v[122:123], v69 offset:37728
    v_mfma_f32_16x16x32_bf16 v[100:103], v[28:31], v[12:15], v[100:103]
    s_waitcnt lgkmcnt(9)
    v_mfma_f32_16x16x32_bf16 v[88:91], v[36:39], v[32:35], v[88:91]
    s_waitcnt vmcnt(7)
    s_barrier
    ds_read_b128 v[12:15], v64 offset:8192
    ds_read_b64_tr_b16 v[16:17], v68 offset:0
    ds_read_b64_tr_b16 v[18:19], v68 offset:1792
    v_mfma_f32_16x16x32_bf16 v[92:95], v[40:43], v[32:35], v[92:95]
    ds_read_b64_tr_b16 v[20:21], v68 offset:32
    ds_read_b64_tr_b16 v[22:23], v68 offset:1824
    ds_read_b64_tr_b16 v[24:25], v68 offset:64
    v_mfma_f32_16x16x32_bf16 v[96:99], v[44:47], v[32:35], v[96:99]
    ds_read_b64_tr_b16 v[26:27], v68 offset:1856
    ds_read_b64_tr_b16 v[28:29], v68 offset:96
    ds_read_b64_tr_b16 v[30:31], v68 offset:1888
    v_mfma_f32_16x16x32_bf16 v[100:103], v[48:51], v[32:35], v[100:103]
    s_waitcnt lgkmcnt(9)
    v_mfma_f32_16x16x32_bf16 v[88:91], v[108:111], v[104:107], v[88:91]
    ds_read_b128 v[32:35], v65 offset:9216
    ds_read_b64_tr_b16 v[36:37], v68 offset:7168
    ds_read_b64_tr_b16 v[38:39], v68 offset:8960
    v_mfma_f32_16x16x32_bf16 v[92:95], v[112:115], v[104:107], v[92:95]
    ds_read_b64_tr_b16 v[40:41], v68 offset:7200
    ds_read_b64_tr_b16 v[42:43], v68 offset:8992
    ds_read_b64_tr_b16 v[44:45], v68 offset:7232
    v_mfma_f32_16x16x32_bf16 v[96:99], v[116:119], v[104:107], v[96:99]
    ds_read_b64_tr_b16 v[46:47], v68 offset:9024
    ds_read_b64_tr_b16 v[48:49], v68 offset:7264
    ds_read_b64_tr_b16 v[50:51], v68 offset:9056
    v_mfma_f32_16x16x32_bf16 v[100:103], v[120:123], v[104:107], v[100:103]
    s_waitcnt lgkmcnt(9)
    v_mfma_f32_16x16x32_bf16 v[88:91], v[16:19], v[12:15], v[88:91]
    s_waitcnt vmcnt(4)
    s_barrier
    ds_read_b128 v[104:107], v66 offset:10240
    ds_read_b64_tr_b16 v[108:109], v68 offset:14336
    ds_read_b64_tr_b16 v[110:111], v68 offset:16128
    v_mfma_f32_16x16x32_bf16 v[92:95], v[20:23], v[12:15], v[92:95]
    ds_read_b64_tr_b16 v[112:113], v68 offset:14368
    ds_read_b64_tr_b16 v[114:115], v68 offset:16160
    ds_read_b64_tr_b16 v[116:117], v68 offset:14400
    v_mfma_f32_16x16x32_bf16 v[96:99], v[24:27], v[12:15], v[96:99]
    ds_read_b64_tr_b16 v[118:119], v68 offset:16192
    ds_read_b64_tr_b16 v[120:121], v68 offset:14432
    ds_read_b64_tr_b16 v[122:123], v68 offset:16224
    v_mfma_f32_16x16x32_bf16 v[100:103], v[28:31], v[12:15], v[100:103]
    buffer_load_dwordx4 v[52:55], v60, s[60:63], 0 offen sc0 sc1
    buffer_load_dwordx4 v[56:59], v60, s[60:63], 0 offen offset:16 sc0 sc1
    s_waitcnt lgkmcnt(9)
    v_mfma_f32_16x16x32_bf16 v[88:91], v[36:39], v[32:35], v[88:91]
    ds_read_b128 v[12:15], v67 offset:11264
    ds_read_b64_tr_b16 v[16:17], v68 offset:21504
    ds_read_b64_tr_b16 v[18:19], v68 offset:23296
    v_mfma_f32_16x16x32_bf16 v[92:95], v[40:43], v[32:35], v[92:95]
    ds_read_b64_tr_b16 v[20:21], v68 offset:21536
    ds_read_b64_tr_b16 v[22:23], v68 offset:23328
    ds_read_b64_tr_b16 v[24:25], v68 offset:21568
    v_mfma_f32_16x16x32_bf16 v[96:99], v[44:47], v[32:35], v[96:99]
    ds_read_b64_tr_b16 v[26:27], v68 offset:23360
    ds_read_b64_tr_b16 v[28:29], v68 offset:21600
    ds_read_b64_tr_b16 v[30:31], v68 offset:23392
    v_mfma_f32_16x16x32_bf16 v[100:103], v[48:51], v[32:35], v[100:103]
    s_waitcnt lgkmcnt(9)
    v_mfma_f32_16x16x32_bf16 v[88:91], v[108:111], v[104:107], v[88:91]
    s_waitcnt vmcnt(4)
    s_barrier
    ds_read_b128 v[32:35], v64 offset:12288
    ds_read_b64_tr_b16 v[36:37], v68 offset:28672
    ds_read_b64_tr_b16 v[38:39], v68 offset:30464
    v_mfma_f32_16x16x32_bf16 v[92:95], v[112:115], v[104:107], v[92:95]
    ds_read_b64_tr_b16 v[40:41], v68 offset:28704
    ds_read_b64_tr_b16 v[42:43], v68 offset:30496
    ds_read_b64_tr_b16 v[44:45], v68 offset:28736
    v_mfma_f32_16x16x32_bf16 v[96:99], v[116:119], v[104:107], v[96:99]
    ds_read_b64_tr_b16 v[46:47], v68 offset:30528
    ds_read_b64_tr_b16 v[48:49], v68 offset:28768
    ds_read_b64_tr_b16 v[50:51], v68 offset:30560
    v_mfma_f32_16x16x32_bf16 v[100:103], v[120:123], v[104:107], v[100:103]
    s_waitcnt lgkmcnt(9)
    v_mfma_f32_16x16x32_bf16 v[88:91], v[16:19], v[12:15], v[88:91]
    ds_read_b128 v[104:107], v65 offset:13312
    ds_read_b64_tr_b16 v[108:109], v68 offset:35840
    ds_read_b64_tr_b16 v[110:111], v68 offset:37632
    v_mfma_f32_16x16x32_bf16 v[92:95], v[20:23], v[12:15], v[92:95]
    ds_read_b64_tr_b16 v[112:113], v68 offset:35872
    ds_read_b64_tr_b16 v[114:115], v68 offset:37664
    ds_read_b64_tr_b16 v[116:117], v68 offset:35904
    v_mfma_f32_16x16x32_bf16 v[96:99], v[24:27], v[12:15], v[96:99]
    ds_read_b64_tr_b16 v[118:119], v68 offset:37696
    ds_read_b64_tr_b16 v[120:121], v68 offset:35936
    ds_read_b64_tr_b16 v[122:123], v68 offset:37728
    v_mfma_f32_16x16x32_bf16 v[100:103], v[28:31], v[12:15], v[100:103]
    s_waitcnt lgkmcnt(9)
    v_mfma_f32_16x16x32_bf16 v[88:91], v[36:39], v[32:35], v[88:91]
    s_waitcnt vmcnt(2)
    s_barrier
    ds_read_b128 v[12:15], v66 offset:14336
    ds_read_b64_tr_b16 v[16:17], v69 offset:0
    ds_read_b64_tr_b16 v[18:19], v69 offset:1792
    v_mfma_f32_16x16x32_bf16 v[92:95], v[40:43], v[32:35], v[92:95]
    ds_read_b64_tr_b16 v[20:21], v69 offset:32
    ds_read_b64_tr_b16 v[22:23], v69 offset:1824
    ds_read_b64_tr_b16 v[24:25], v69 offset:64
    v_mfma_f32_16x16x32_bf16 v[96:99], v[44:47], v[32:35], v[96:99]
    ds_read_b64_tr_b16 v[26:27], v69 offset:1856
    ds_read_b64_tr_b16 v[28:29], v69 offset:96
    ds_read_b64_tr_b16 v[30:31], v69 offset:1888
    v_mfma_f32_16x16x32_bf16 v[100:103], v[48:51], v[32:35], v[100:103]
    s_waitcnt lgkmcnt(9)
    v_mfma_f32_16x16x32_bf16 v[88:91], v[108:111], v[104:107], v[88:91]
    ds_read_b128 v[32:35], v67 offset:15360
    ds_read_b64_tr_b16 v[36:37], v69 offset:7168
    ds_read_b64_tr_b16 v[38:39], v69 offset:8960
    v_mfma_f32_16x16x32_bf16 v[92:95], v[112:115], v[104:107], v[92:95]
    ds_read_b64_tr_b16 v[40:41], v69 offset:7200
    ds_read_b64_tr_b16 v[42:43], v69 offset:8992
    ds_read_b64_tr_b16 v[44:45], v69 offset:7232
    v_mfma_f32_16x16x32_bf16 v[96:99], v[116:119], v[104:107], v[96:99]
    ds_read_b64_tr_b16 v[46:47], v69 offset:9024
    ds_read_b64_tr_b16 v[48:49], v69 offset:7264
    ds_read_b64_tr_b16 v[50:51], v69 offset:9056
    v_mfma_f32_16x16x32_bf16 v[100:103], v[120:123], v[104:107], v[100:103]
    s_waitcnt lgkmcnt(9)
    v_mfma_f32_16x16x32_bf16 v[88:91], v[16:19], v[12:15], v[88:91]
    v_mfma_f32_16x16x32_bf16 v[92:95], v[20:23], v[12:15], v[92:95]
    v_mfma_f32_16x16x32_bf16 v[96:99], v[24:27], v[12:15], v[96:99]
    v_mfma_f32_16x16x32_bf16 v[100:103], v[28:31], v[12:15], v[100:103]
    s_waitcnt lgkmcnt(0)
    v_mfma_f32_16x16x32_bf16 v[88:91], v[36:39], v[32:35], v[88:91]
    v_mfma_f32_16x16x32_bf16 v[92:95], v[40:43], v[32:35], v[92:95]
    v_mfma_f32_16x16x32_bf16 v[96:99], v[44:47], v[32:35], v[96:99]
    v_mfma_f32_16x16x32_bf16 v[100:103], v[48:51], v[32:35], v[100:103]
    s_add_u32 s48, s40, 0xe00000
    s_addc_u32 s49, s41, 0
    s_mov_b32 s50, 0x380000
    s_mov_b32 s51, 0x00020000
    v_bfe_u32 v5, v1, 4, 1
    v_lshlrev_b32 v5, 5, v5
    v_lshrrev_b32 v6, 5, v1
    v_lshl_add_u32 v5, v6, 4, v5
    s_lshr_b32 s5, s3, 2
    s_lshl_b32 s5, s5, 7
    v_add_u32 v16, s5, v5
    v_and_b32 v5, 0xfffffff3, v71
    v_bfe_u32 v6, v71, 3, 1
    v_lshl_or_b32 v5, v6, 2, v5
    v_bfe_u32 v6, v71, 2, 1
    v_lshl_or_b32 v5, v6, 3, v5
    v_mul_u32_u24 v5, 224, v5
    v_add_u32 v16, v16, v5
    s_mul_i32 s14, s9, 458752
    s_mov_b32 s6, 0
zp_17023:
    s_waitcnt vmcnt(0)
    v_and_b32 v61, v53, v55
    v_and_b32 v62, v57, v59
    v_and_b32 v61, v61, v62
    v_cmp_gt_i32 vcc, 0, v61
    s_nop 0
    s_cmp_eq_u64 vcc, -1
    s_cbranch_scc1 zp_17023_x
    s_add_u32 s6, s6, 1
    s_cmp_gt_u32 s6, 0x20000
    s_cbranch_scc1 zp_17023_x
    buffer_load_dwordx4 v[52:55], v60, s[60:63], 0 offen sc0 sc1
    buffer_load_dwordx4 v[56:59], v60, s[60:63], 0 offen offset:16 sc0 sc1
    s_branch zp_17023
zp_17023_x:
    v_add_f32 v8, v52, v54
    v_add_f32 v9, |v53|, |v55|
    v_add_f32 v12, v56, v58
    v_add_f32 v13, |v57|, |v59|
    v_add_f32 v8, v8, v12
    v_add_f32 v9, v9, v13
    v_mov_b32 v6, v8
    s_nop 1
    v_permlane16_swap_b32 v8, v6
    v_add_f32 v8, v8, v6
    v_mov_b32 v6, v9
    s_nop 1
    v_permlane16_swap_b32 v9, v6
    v_add_f32 v9, v9, v6
    v_mov_b32 v7, v8
    s_nop 1
    v_permlane32_swap_b32 v8, v7
    v_add_f32 v8, v8, v7
    v_mov_b32 v7, v9
    s_nop 1
    v_permlane32_swap_b32 v9, v7
    v_add_f32 v9, v9, v7
    v_mul_f32 v8, 0x3a924925, v8
    v_mul_f32 v9, 0x3a924925, v9
    v_fma_f32 v9, -v8, v8, v9
    v_max_f32 v9, 0, v9
    v_add_f32 v9, 0x3727c5ac, v9
    v_rsq_f32 v9, v9
    s_nop 0
    v_mul_f32 v8, v8, v9
    v_sub_f32 v8, 0, v8
    v_pk_fma_f32 v[72:73], v[72:73], v[8:9], v[8:9] op_sel:[0,1,0] op_sel_hi:[1,1,0]
    v_pk_fma_f32 v[74:75], v[74:75], v[8:9], v[8:9] op_sel:[0,1,0] op_sel_hi:[1,1,0]
    v_pk_fma_f32 v[76:77], v[76:77], v[8:9], v[8:9] op_sel:[0,1,0] op_sel_hi:[1,1,0]
    v_pk_fma_f32 v[78:79], v[78:79], v[8:9], v[8:9] op_sel:[0,1,0] op_sel_hi:[1,1,0]
    v_pk_fma_f32 v[80:81], v[80:81], v[8:9], v[8:9] op_sel:[0,1,0] op_sel_hi:[1,1,0]
    v_pk_fma_f32 v[82:83], v[82:83], v[8:9], v[8:9] op_sel:[0,1,0] op_sel_hi:[1,1,0]
    v_pk_fma_f32 v[84:85], v[84:85], v[8:9], v[8:9] op_sel:[0,1,0] op_sel_hi:[1,1,0]
    v_pk_fma_f32 v[86:87], v[86:87], v[8:9], v[8:9] op_sel:[0,1,0] op_sel_hi:[1,1,0]
    v_cvt_pk_bf16_f32 v104, v72, v73
    v_cvt_pk_bf16_f32 v105, v74, v75
    v_cvt_pk_bf16_f32 v106, v76, v77
    v_cvt_pk_bf16_f32 v107, v78, v79
    v_cvt_pk_bf16_f32 v108, v80, v81
    v_cvt_pk_bf16_f32 v109, v82, v83
    v_cvt_pk_bf16_f32 v110, v84, v85
    v_cvt_pk_bf16_f32 v111, v86, v87
    v_permlane16_swap_b32 v104, v106
    v_permlane16_swap_b32 v105, v107
    v_permlane16_swap_b32 v108, v110
    v_permlane16_swap_b32 v109, v111
    buffer_store_dwordx4 v[104:107], v16, s[48:51], s14 offen sc1
    s_lshr_b32 s5, s3, 2
    v_bfe_u32 v5, v1, 4, 1
    v_and_b32 v5, s5, v5
    v_cmp_eq_u32 vcc, 0, v5
    s_nop 0
    s_and_saveexec_b64 s[12:13], vcc
    buffer_store_dwordx4 v[108:111], v16, s[48:51], s14 offen offset:64 sc1
    s_mov_b64 exec, s[12:13]
    v_pk_mul_f32 v[8:9], v[88:89], v[88:89]
    v_pk_mul_f32 v[10:11], v[90:91], v[90:91]
    v_pk_fma_f32 v[8:9], v[8:9], s[90:91], v[70:71] op_sel:[0,0,0] op_sel_hi:[1,0,0]
    v_pk_fma_f32 v[10:11], v[10:11], s[90:91], v[70:71] op_sel:[0,0,0] op_sel_hi:[1,0,0]
    v_pk_mul_f32 v[8:9], v[8:9], v[88:89]
    v_pk_mul_f32 v[10:11], v[10:11], v[90:91]
    v_exp_f32 v8, v8
    v_exp_f32 v9, v9
    v_exp_f32 v10, v10
    v_exp_f32 v11, v11
    v_pk_add_f32 v[8:9], v[8:9], 1.0 op_sel_hi:[1,0]
    v_pk_add_f32 v[10:11], v[10:11], 1.0 op_sel_hi:[1,0]
    v_rcp_f32 v8, v8
    v_rcp_f32 v9, v9
    v_rcp_f32 v10, v10
    v_rcp_f32 v11, v11
    v_pk_mul_f32 v[88:89], v[88:89], v[8:9]
    v_pk_mul_f32 v[90:91], v[90:91], v[10:11]
    v_pk_mul_f32 v[8:9], v[92:93], v[92:93]
    v_pk_mul_f32 v[10:11], v[94:95], v[94:95]
    v_pk_fma_f32 v[8:9], v[8:9], s[90:91], v[70:71] op_sel:[0,0,0] op_sel_hi:[1,0,0]
    v_pk_fma_f32 v[10:11], v[10:11], s[90:91], v[70:71] op_sel:[0,0,0] op_sel_hi:[1,0,0]
    v_pk_mul_f32 v[8:9], v[8:9], v[92:93]
    v_pk_mul_f32 v[10:11], v[10:11], v[94:95]
    v_exp_f32 v8, v8
    v_exp_f32 v9, v9
    v_exp_f32 v10, v10
    v_exp_f32 v11, v11
    v_pk_add_f32 v[8:9], v[8:9], 1.0 op_sel_hi:[1,0]
    v_pk_add_f32 v[10:11], v[10:11], 1.0 op_sel_hi:[1,0]
    v_rcp_f32 v8, v8
    v_rcp_f32 v9, v9
    v_rcp_f32 v10, v10
    v_rcp_f32 v11, v11
    v_pk_mul_f32 v[92:93], v[92:93], v[8:9]
    v_pk_mul_f32 v[94:95], v[94:95], v[10:11]
    v_pk_mul_f32 v[8:9], v[96:97], v[96:97]
    v_pk_mul_f32 v[10:11], v[98:99], v[98:99]
    v_pk_fma_f32 v[8:9], v[8:9], s[90:91], v[70:71] op_sel:[0,0,0] op_sel_hi:[1,0,0]
    v_pk_fma_f32 v[10:11], v[10:11], s[90:91], v[70:71] op_sel:[0,0,0] op_sel_hi:[1,0,0]
    v_pk_mul_f32 v[8:9], v[8:9], v[96:97]
    v_pk_mul_f32 v[10:11], v[10:11], v[98:99]
    v_exp_f32 v8, v8
    v_exp_f32 v9, v9
    v_exp_f32 v10, v10
    v_exp_f32 v11, v11
    v_pk_add_f32 v[8:9], v[8:9], 1.0 op_sel_hi:[1,0]
    v_pk_add_f32 v[10:11], v[10:11], 1.0 op_sel_hi:[1,0]
    v_rcp_f32 v8, v8
    v_rcp_f32 v9, v9
    v_rcp_f32 v10, v10
    v_rcp_f32 v11, v11
    v_pk_mul_f32 v[96:97], v[96:97], v[8:9]
    v_pk_mul_f32 v[98:99], v[98:99], v[10:11]
    v_pk_mul_f32 v[8:9], v[100:101], v[100:101]
    v_pk_mul_f32 v[10:11], v[102:103], v[102:103]
    v_pk_fma_f32 v[8:9], v[8:9], s[90:91], v[70:71] op_sel:[0,0,0] op_sel_hi:[1,0,0]
    v_pk_fma_f32 v[10:11], v[10:11], s[90:91], v[70:71] op_sel:[0,0,0] op_sel_hi:[1,0,0]
    v_pk_mul_f32 v[8:9], v[8:9], v[100:101]
    v_pk_mul_f32 v[10:11], v[10:11], v[102:103]
    v_exp_f32 v8, v8
    v_exp_f32 v9, v9
    v_exp_f32 v10, v10
    v_exp_f32 v11, v11
    v_pk_add_f32 v[8:9], v[8:9], 1.0 op_sel_hi:[1,0]
    v_pk_add_f32 v[10:11], v[10:11], 1.0 op_sel_hi:[1,0]
    v_rcp_f32 v8, v8
    v_rcp_f32 v9, v9
    v_rcp_f32 v10, v10
    v_rcp_f32 v11, v11
    v_pk_mul_f32 v[100:101], v[100:101], v[8:9]
    v_pk_mul_f32 v[102:103], v[102:103], v[10:11]
    v_cvt_pk_bf16_f32 v112, v88, v89
    v_cvt_pk_bf16_f32 v113, v90, v91
    v_cvt_pk_bf16_f32 v114, v92, v93
    v_cvt_pk_bf16_f32 v115, v94, v95
    v_cvt_pk_bf16_f32 v116, v96, v97
    v_cvt_pk_bf16_f32 v117, v98, v99
    v_cvt_pk_bf16_f32 v118, v100, v101
    v_cvt_pk_bf16_f32 v119, v102, v103
    v_mov_b32 v120, v71
    s_waitcnt vmcnt(0)
    s_barrier
    s_cmp_eq_u32 s3, 0
    s_cbranch_scc0 pub_17024
    s_add_u32 s5, s9, 72
    s_lshl_b32 s5, s5, 8
    s_lshl_b32 s6, s8, 2
    s_add_u32 s5, s5, s6
    v_mov_b32 v5, 1
    s_mov_b64 exec, 1
    buffer_store_dword v5, off, s[84:87], s5 sc1
    s_mov_b64 exec, -1
pub_17024:
    s_add_u32 s48, s40, 0xe00000
    s_addc_u32 s49, s41, 0
    s_mov_b32 s50, 0x380000
    s_mov_b32 s51, 0x00020000
    s_mov_b32 s56, s28
    s_mov_b32 s57, s29
    s_mov_b32 s58, 0x1000
    s_mov_b32 s59, 0x00020000
    s_add_u32 s60, s40, 0x1600000
    s_addc_u32 s61, s41, 0
    s_mov_b32 s62, 0x380000
    s_mov_b32 s63, 0x00020000
    s_lshr_b32 s5, s3, 1
    s_mul_i32 s15, s5, 114688
    s_mul_i32 s14, s5, 7168
    s_and_b32 s6, s3, 1
    s_lshl_b32 s6, s6, 12
    s_add_u32 s15, s15, s6
    s_add_u32 s14, s14, s6
    s_mul_i32 s6, s9, 458752
    s_add_u32 s15, s15, s6
    s_and_b32 s6, s3, 1
    s_sub_u32 s10, s6, 1
    s_mov_b32 s11, s10
    v_lshlrev_b32 v121, 1, v120
    buffer_load_ushort v121, v121, s[56:59], 0 offen
    s_cmp_eq_u32 s3, 0
    s_cbranch_scc0 pd_17026
    s_add_u32 s5, s9, 72
    s_lshl_b32 s5, s5, 8
    v_lshlrev_b32 v6, 2, v1
    s_mov_b32 s6, 0
    s_mov_b32 exec_lo, 0xffffffff
    s_mov_b32 exec_hi, 0
poll_17025:
    buffer_load_dword v5, v6, s[84:87], s5 offen sc0 sc1
    s_waitcnt vmcnt(0)
    v_cmp_ne_u32 vcc, 0, v5
    s_add_u32 s6, s6, 1
    s_cmp_gt_u32 s6, 0x20000
    s_cbranch_scc1 poll_17025_x
    s_cmp_eq_u64 vcc, exec
    s_cbranch_scc1 poll_17025_x
    s_sleep 6
    s_branch poll_17025
poll_17025_x:
    s_mov_b64 exec, -1
pd_17026:
    s_barrier
    s_lshl_b32 s7, s91, 1
    s_mul_i32 s7, s7, 7168
    s_add_u32 s7, s7, s15
    s_add_u32 s13, s15, 114688
    s_add_u32 m0, s14, 0
    s_nop 0
    buffer_load_dwordx4 v2, s[48:51], s7 offen offset:0 sc1 lds
    buffer_load_dwordx4 v2, s[48:51], s7 offen offset:1024 sc1 lds
    buffer_load_dwordx4 v2, s[48:51], s7 offen offset:2048 sc1 lds
    s_mov_b64 exec, s[10:11]
    buffer_load_dwordx4 v2, s[48:51], s7 offen offset:3072 sc1 lds
    s_mov_b64 exec, -1
    s_add_u32 s7, s7, 7168
    s_cmp_eq_u32 s7, s13
    s_cselect_b32 s7, s15, s7
    s_add_u32 m0, s14, 28672
    s_nop 0
    buffer_load_dwordx4 v2, s[48:51], s7 offen offset:0 sc1 lds
    buffer_load_dwordx4 v2, s[48:51], s7 offen offset:1024 sc1 lds
    buffer_load_dwordx4 v2, s[48:51], s7 offen offset:2048 sc1 lds
    s_mov_b64 exec, s[10:11]
    buffer_load_dwordx4 v2, s[48:51], s7 offen offset:3072 sc1 lds
    s_mov_b64 exec, -1
    s_add_u32 s7, s7, 7168
    s_cmp_eq_u32 s7, s13
    s_cselect_b32 s7, s15, s7
    s_add_u32 m0, s14, 57344
    s_nop 0
    buffer_load_dwordx4 v2, s[48:51], s7 offen offset:0 sc1 lds
    buffer_load_dwordx4 v2, s[48:51], s7 offen offset:1024 sc1 lds
    buffer_load_dwordx4 v2, s[48:51], s7 offen offset:2048 sc1 lds
    s_mov_b64 exec, s[10:11]
    buffer_load_dwordx4 v2, s[48:51], s7 offen offset:3072 sc1 lds
    s_mov_b64 exec, -1
    s_add_u32 s7, s7, 7168
    s_cmp_eq_u32 s7, s13
    s_cselect_b32 s7, s15, s7
    s_add_u32 m0, s14, 86016
    s_nop 0
    buffer_load_dwordx4 v2, s[48:51], s7 offen offset:0 sc1 lds
    buffer_load_dwordx4 v2, s[48:51], s7 offen offset:1024 sc1 lds
    buffer_load_dwordx4 v2, s[48:51], s7 offen offset:2048 sc1 lds
    s_mov_b64 exec, s[10:11]
    buffer_load_dwordx4 v2, s[48:51], s7 offen offset:3072 sc1 lds
    s_mov_b64 exec, -1
    s_add_u32 s7, s7, 7168
    s_cmp_eq_u32 s7, s13
    s_cselect_b32 s7, s15, s7
    s_add_u32 m0, s14, 114688
    s_nop 0
    buffer_load_dwordx4 v2, s[48:51], s7 offen offset:0 sc1 lds
    buffer_load_dwordx4 v2, s[48:51], s7 offen offset:1024 sc1 lds
    buffer_load_dwordx4 v2, s[48:51], s7 offen offset:2048 sc1 lds
    s_mov_b64 exec, s[10:11]
    buffer_load_dwordx4 v2, s[48:51], s7 offen offset:3072 sc1 lds
    s_mov_b64 exec, -1
    s_add_u32 s7, s7, 7168
    s_cmp_eq_u32 s7, s13
    s_cselect_b32 s7, s15, s7
    v_lshrrev_b32 v5, 5, v1
    v_lshlrev_b32 v5, 4, v5
    v_bfe_u32 v6, v1, 4, 1
    v_lshl_add_u32 v5, v6, 2, v5
    v_bfe_u32 v6, v1, 2, 2
    v_add_u32 v5, v5, v6
    v_mul_u32_u24 v5, 224, v5
    v_and_b32 v6, 3, v1
    v_lshl_add_u32 v5, v6, 3, v5
    s_and_b32 s5, s3, 1
    s_lshr_b32 s6, s3, 2
    s_lshl_b32 s6, s6, 1
    s_or_b32 s4, s5, s6
    s_mul_i32 s5, s4, 7168
    v_add_u32 v122, s5, v5
    v_add_u32 v123, 57344, v122
    v_add_u32 v124, 114688, v122
    v_mov_b32 v8, 0
    v_mov_b32 v9, 0
    v_mov_b32 v10, 0
    v_mov_b32 v11, 0
    v_mov_b32 v12, 0
    v_mov_b32 v13, 0
    v_mov_b32 v14, 0
    v_mov_b32 v15, 0
    v_mov_b32 v16, 0
    v_mov_b32 v17, 0
    v_mov_b32 v18, 0
    v_mov_b32 v19, 0
    v_mov_b32 v20, 0
    v_mov_b32 v21, 0
    v_mov_b32 v22, 0
    v_mov_b32 v23, 0
    v_mov_b32 v24, 0
    v_mov_b32 v25, 0
    v_mov_b32 v26, 0
    v_mov_b32 v27, 0
    v_mov_b32 v28, 0
    v_mov_b32 v29, 0
    v_mov_b32 v30, 0
    v_mov_b32 v31, 0
    v_mov_b32 v32, 0
    v_mov_b32 v33, 0
    v_mov_b32 v34, 0
    v_mov_b32 v35, 0
    v_mov_b32 v36, 0
    v_mov_b32 v37, 0
    v_mov_b32 v38, 0
    v_mov_b32 v39, 0
    v_mov_b32 v40, 0
    v_mov_b32 v41, 0
    v_mov_b32 v42, 0
    v_mov_b32 v43, 0
    v_mov_b32 v44, 0
    v_mov_b32 v45, 0
    v_mov_b32 v46, 0
    v_mov_b32 v47, 0
    v_mov_b32 v48, 0
    v_mov_b32 v49, 0
    v_mov_b32 v50, 0
    v_mov_b32 v51, 0
    v_mov_b32 v52, 0
    v_mov_b32 v53, 0
    v_mov_b32 v54, 0
    v_mov_b32 v55, 0
    v_mov_b32 v56, 0
    v_mov_b32 v57, 0
    v_mov_b32 v58, 0
    v_mov_b32 v59, 0
    v_mov_b32 v60, 0
    v_mov_b32 v61, 0
    v_mov_b32 v62, 0
    v_mov_b32 v63, 0
    v_lshlrev_b32 v5, 1, v2
    s_lshl_b32 s5, s3, 11
    s_add_u32 s5, s5, 143360
    v_add_u32 v125, s5, v5
    ds_write_b128 v125, v[112:115]
    ds_write_b128 v125, v[116:119] offset:16
    s_waitcnt lgkmcnt(0)
    s_waitcnt vmcnt(16)
    s_barrier
    ds_read_b64_tr_b16 v[64:65], v122 offset:0
    ds_read_b64_tr_b16 v[66:67], v122 offset:1792
    ds_read_b64_tr_b16 v[68:69], v122 offset:32
    ds_read_b64_tr_b16 v[70:71], v122 offset:1824
    ds_read_b64_tr_b16 v[72:73], v122 offset:64
    ds_read_b64_tr_b16 v[74:75], v122 offset:1856
    ds_read_b64_tr_b16 v[76:77], v122 offset:96
    ds_read_b64_tr_b16 v[78:79], v122 offset:1888
    ds_read_b64_tr_b16 v[80:81], v122 offset:128
    ds_read_b64_tr_b16 v[82:83], v122 offset:1920
    ds_read_b64_tr_b16 v[84:85], v122 offset:160
    ds_read_b64_tr_b16 v[86:87], v122 offset:1952
    ds_read_b64_tr_b16 v[88:89], v122 offset:192
    ds_read_b64_tr_b16 v[90:91], v122 offset:1984
    s_waitcnt lgkmcnt(0)
    v_mfma_f32_16x16x32_bf16 v[8:11], v[64:67], v[128:131], v[8:11]
    v_mfma_f32_16x16x32_bf16 v[36:39], v[64:67], v[192:195], v[36:39]
    s_waitcnt vmcnt(12)
    s_barrier
    ds_read_b64_tr_b16 v[92:93], v122 offset:28672
    ds_read_b64_tr_b16 v[94:95], v122 offset:30464
    v_mfma_f32_16x16x32_bf16 v[12:15], v[68:71], v[128:131], v[12:15]
    ds_read_b64_tr_b16 v[96:97], v122 offset:28704
    ds_read_b64_tr_b16 v[98:99], v122 offset:30496
    s_add_u32 m0, s14, 0
    s_nop 0
    buffer_load_dwordx4 v2, s[48:51], s7 offen offset:0 sc1 lds
    v_mfma_f32_16x16x32_bf16 v[40:43], v[68:71], v[192:195], v[40:43]
    ds_read_b64_tr_b16 v[100:101], v122 offset:28736
    ds_read_b64_tr_b16 v[102:103], v122 offset:30528
    v_mfma_f32_16x16x32_bf16 v[16:19], v[72:75], v[128:131], v[16:19]
    ds_read_b64_tr_b16 v[104:105], v122 offset:28768
    ds_read_b64_tr_b16 v[106:107], v122 offset:30560
    v_mfma_f32_16x16x32_bf16 v[44:47], v[72:75], v[192:195], v[44:47]
    ds_read_b64_tr_b16 v[108:109], v122 offset:28800
    ds_read_b64_tr_b16 v[110:111], v122 offset:30592
    v_mfma_f32_16x16x32_bf16 v[20:23], v[76:79], v[128:131], v[20:23]
    ds_read_b64_tr_b16 v[112:113], v122 offset:28832
    ds_read_b64_tr_b16 v[114:115], v122 offset:30624
    buffer_load_dwordx4 v2, s[48:51], s7 offen offset:1024 sc1 lds
    v_mfma_f32_16x16x32_bf16 v[48:51], v[76:79], v[192:195], v[48:51]
    ds_read_b64_tr_b16 v[116:117], v122 offset:28864
    ds_read_b64_tr_b16 v[118:119], v122 offset:30656
    v_mfma_f32_16x16x32_bf16 v[24:27], v[80:83], v[128:131], v[24:27]
    v_mfma_f32_16x16x32_bf16 v[52:55], v[80:83], v[192:195], v[52:55]
    v_mfma_f32_16x16x32_bf16 v[28:31], v[84:87], v[128:131], v[28:31]
    buffer_load_dwordx4 v2, s[48:51], s7 offen offset:2048 sc1 lds
    v_mfma_f32_16x16x32_bf16 v[56:59], v[84:87], v[192:195], v[56:59]
    v_mfma_f32_16x16x32_bf16 v[32:35], v[88:91], v[128:131], v[32:35]
    v_mfma_f32_16x16x32_bf16 v[60:63], v[88:91], v[192:195], v[60:63]
    s_mov_b64 exec, s[10:11]
    buffer_load_dwordx4 v2, s[48:51], s7 offen offset:3072 sc1 lds
    s_mov_b64 exec, -1
    s_add_u32 s7, s7, 7168
    s_cmp_eq_u32 s7, s13
    s_cselect_b32 s7, s15, s7
    s_waitcnt lgkmcnt(0)
    v_mfma_f32_16x16x32_bf16 v[8:11], v[92:95], v[132:135], v[8:11]
    v_mfma_f32_16x16x32_bf16 v[36:39], v[92:95], v[196:199], v[36:39]
    s_waitcnt vmcnt(12)
    s_barrier
    ds_read_b64_tr_b16 v[64:65], v123 offset:0
    ds_read_b64_tr_b16 v[66:67], v123 offset:1792
    v_mfma_f32_16x16x32_bf16 v[12:15], v[96:99], v[132:135], v[12:15]
    ds_read_b64_tr_b16 v[68:69], v123 offset:32
    ds_read_b64_tr_b16 v[70:71], v123 offset:1824
    s_add_u32 m0, s14, 28672
    s_nop 0
    buffer_load_dwordx4 v2, s[48:51], s7 offen offset:0 sc1 lds
    v_mfma_f32_16x16x32_bf16 v[40:43], v[96:99], v[196:199], v[40:43]
    ds_read_b64_tr_b16 v[72:73], v123 offset:64
    ds_read_b64_tr_b16 v[74:75], v123 offset:1856
    v_mfma_f32_16x16x32_bf16 v[16:19], v[100:103], v[132:135], v[16:19]
    ds_read_b64_tr_b16 v[76:77], v123 offset:96
    ds_read_b64_tr_b16 v[78:79], v123 offset:1888
    v_mfma_f32_16x16x32_bf16 v[44:47], v[100:103], v[196:199], v[44:47]
    ds_read_b64_tr_b16 v[80:81], v123 offset:128
    ds_read_b64_tr_b16 v[82:83], v123 offset:1920
    v_mfma_f32_16x16x32_bf16 v[20:23], v[104:107], v[132:135], v[20:23]
    ds_read_b64_tr_b16 v[84:85], v123 offset:160
    ds_read_b64_tr_b16 v[86:87], v123 offset:1952
    buffer_load_dwordx4 v2, s[48:51], s7 offen offset:1024 sc1 lds
    v_mfma_f32_16x16x32_bf16 v[48:51], v[104:107], v[196:199], v[48:51]
    ds_read_b64_tr_b16 v[88:89], v123 offset:192
    ds_read_b64_tr_b16 v[90:91], v123 offset:1984
    v_mfma_f32_16x16x32_bf16 v[24:27], v[108:111], v[132:135], v[24:27]
    v_mfma_f32_16x16x32_bf16 v[52:55], v[108:111], v[196:199], v[52:55]
    v_mfma_f32_16x16x32_bf16 v[28:31], v[112:115], v[132:135], v[28:31]
    buffer_load_dwordx4 v2, s[48:51], s7 offen offset:2048 sc1 lds
    v_mfma_f32_16x16x32_bf16 v[56:59], v[112:115], v[196:199], v[56:59]
    v_mfma_f32_16x16x32_bf16 v[32:35], v[116:119], v[132:135], v[32:35]
    v_mfma_f32_16x16x32_bf16 v[60:63], v[116:119], v[196:199], v[60:63]
    s_mov_b64 exec, s[10:11]
    buffer_load_dwordx4 v2, s[48:51], s7 offen offset:3072 sc1 lds
    s_mov_b64 exec, -1
    s_add_u32 s7, s7, 7168
    s_cmp_eq_u32 s7, s13
    s_cselect_b32 s7, s15, s7
    s_waitcnt lgkmcnt(0)
    v_mfma_f32_16x16x32_bf16 v[8:11], v[64:67], v[136:139], v[8:11]
    v_mfma_f32_16x16x32_bf16 v[36:39], v[64:67], v[200:203], v[36:39]
    s_waitcnt vmcnt(12)
    s_barrier
    ds_read_b64_tr_b16 v[92:93], v123 offset:28672
    ds_read_b64_tr_b16 v[94:95], v123 offset:30464
    v_mfma_f32_16x16x32_bf16 v[12:15], v[68:71], v[136:139], v[12:15]
    ds_read_b64_tr_b16 v[96:97], v123 offset:28704
    ds_read_b64_tr_b16 v[98:99], v123 offset:30496
    s_add_u32 m0, s14, 57344
    s_nop 0
    buffer_load_dwordx4 v2, s[48:51], s7 offen offset:0 sc1 lds
    v_mfma_f32_16x16x32_bf16 v[40:43], v[68:71], v[200:203], v[40:43]
    ds_read_b64_tr_b16 v[100:101], v123 offset:28736
    ds_read_b64_tr_b16 v[102:103], v123 offset:30528
    v_mfma_f32_16x16x32_bf16 v[16:19], v[72:75], v[136:139], v[16:19]
    ds_read_b64_tr_b16 v[104:105], v123 offset:28768
    ds_read_b64_tr_b16 v[106:107], v123 offset:30560
    v_mfma_f32_16x16x32_bf16 v[44:47], v[72:75], v[200:203], v[44:47]
    ds_read_b64_tr_b16 v[108:109], v123 offset:28800
    ds_read_b64_tr_b16 v[110:111], v123 offset:30592
    v_mfma_f32_16x16x32_bf16 v[20:23], v[76:79], v[136:139], v[20:23]
    ds_read_b64_tr_b16 v[112:113], v123 offset:28832
    ds_read_b64_tr_b16 v[114:115], v123 offset:30624
    buffer_load_dwordx4 v2, s[48:51], s7 offen offset:1024 sc1 lds
    v_mfma_f32_16x16x32_bf16 v[48:51], v[76:79], v[200:203], v[48:51]
    ds_read_b64_tr_b16 v[116:117], v123 offset:28864
    ds_read_b64_tr_b16 v[118:119], v123 offset:30656
    v_mfma_f32_16x16x32_bf16 v[24:27], v[80:83], v[136:139], v[24:27]
    v_mfma_f32_16x16x32_bf16 v[52:55], v[80:83], v[200:203], v[52:55]
    v_mfma_f32_16x16x32_bf16 v[28:31], v[84:87], v[136:139], v[28:31]
    buffer_load_dwordx4 v2, s[48:51], s7 offen offset:2048 sc1 lds
    v_mfma_f32_16x16x32_bf16 v[56:59], v[84:87], v[200:203], v[56:59]
    v_mfma_f32_16x16x32_bf16 v[32:35], v[88:91], v[136:139], v[32:35]
    v_mfma_f32_16x16x32_bf16 v[60:63], v[88:91], v[200:203], v[60:63]
    s_mov_b64 exec, s[10:11]
    buffer_load_dwordx4 v2, s[48:51], s7 offen offset:3072 sc1 lds
    s_mov_b64 exec, -1
    s_add_u32 s7, s7, 7168
    s_cmp_eq_u32 s7, s13
    s_cselect_b32 s7, s15, s7
    s_waitcnt lgkmcnt(0)
    v_mfma_f32_16x16x32_bf16 v[8:11], v[92:95], v[140:143], v[8:11]
    v_mfma_f32_16x16x32_bf16 v[36:39], v[92:95], v[204:207], v[36:39]
    s_waitcnt vmcnt(12)
    s_barrier
    ds_read_b64_tr_b16 v[64:65], v124 offset:0
    ds_read_b64_tr_b16 v[66:67], v124 offset:1792
    v_mfma_f32_16x16x32_bf16 v[12:15], v[96:99], v[140:143], v[12:15]
    ds_read_b64_tr_b16 v[68:69], v124 offset:32
    ds_read_b64_tr_b16 v[70:71], v124 offset:1824
    s_add_u32 m0, s14, 86016
    s_nop 0
    buffer_load_dwordx4 v2, s[48:51], s7 offen offset:0 sc1 lds
    v_mfma_f32_16x16x32_bf16 v[40:43], v[96:99], v[204:207], v[40:43]
    ds_read_b64_tr_b16 v[72:73], v124 offset:64
    ds_read_b64_tr_b16 v[74:75], v124 offset:1856
    v_mfma_f32_16x16x32_bf16 v[16:19], v[100:103], v[140:143], v[16:19]
    ds_read_b64_tr_b16 v[76:77], v124 offset:96
    ds_read_b64_tr_b16 v[78:79], v124 offset:1888
    v_mfma_f32_16x16x32_bf16 v[44:47], v[100:103], v[204:207], v[44:47]
    ds_read_b64_tr_b16 v[80:81], v124 offset:128
    ds_read_b64_tr_b16 v[82:83], v124 offset:1920
    v_mfma_f32_16x16x32_bf16 v[20:23], v[104:107], v[140:143], v[20:23]
    ds_read_b64_tr_b16 v[84:85], v124 offset:160
    ds_read_b64_tr_b16 v[86:87], v124 offset:1952
    buffer_load_dwordx4 v2, s[48:51], s7 offen offset:1024 sc1 lds
    v_mfma_f32_16x16x32_bf16 v[48:51], v[104:107], v[204:207], v[48:51]
    ds_read_b64_tr_b16 v[88:89], v124 offset:192
    ds_read_b64_tr_b16 v[90:91], v124 offset:1984
    v_mfma_f32_16x16x32_bf16 v[24:27], v[108:111], v[140:143], v[24:27]
    v_mfma_f32_16x16x32_bf16 v[52:55], v[108:111], v[204:207], v[52:55]
    v_mfma_f32_16x16x32_bf16 v[28:31], v[112:115], v[140:143], v[28:31]
    buffer_load_dwordx4 v2, s[48:51], s7 offen offset:2048 sc1 lds
    v_mfma_f32_16x16x32_bf16 v[56:59], v[112:115], v[204:207], v[56:59]
    v_mfma_f32_16x16x32_bf16 v[32:35], v[116:119], v[140:143], v[32:35]
    v_mfma_f32_16x16x32_bf16 v[60:63], v[116:119], v[204:207], v[60:63]
    s_mov_b64 exec, s[10:11]
    buffer_load_dwordx4 v2, s[48:51], s7 offen offset:3072 sc1 lds
    s_mov_b64 exec, -1
    s_add_u32 s7, s7, 7168
    s_cmp_eq_u32 s7, s13
    s_cselect_b32 s7, s15, s7
    s_waitcnt lgkmcnt(0)
    v_mfma_f32_16x16x32_bf16 v[8:11], v[64:67], v[144:147], v[8:11]
    v_mfma_f32_16x16x32_bf16 v[36:39], v[64:67], v[208:211], v[36:39]
    s_waitcnt vmcnt(12)
    s_barrier
    ds_read_b64_tr_b16 v[92:93], v122 offset:0
    ds_read_b64_tr_b16 v[94:95], v122 offset:1792
    v_mfma_f32_16x16x32_bf16 v[12:15], v[68:71], v[144:147], v[12:15]
    ds_read_b64_tr_b16 v[96:97], v122 offset:32
    ds_read_b64_tr_b16 v[98:99], v122 offset:1824
    s_add_u32 m0, s14, 114688
    s_nop 0
    buffer_load_dwordx4 v2, s[48:51], s7 offen offset:0 sc1 lds
    v_mfma_f32_16x16x32_bf16 v[40:43], v[68:71], v[208:211], v[40:43]
    ds_read_b64_tr_b16 v[100:101], v122 offset:64
    ds_read_b64_tr_b16 v[102:103], v122 offset:1856
    v_mfma_f32_16x16x32_bf16 v[16:19], v[72:75], v[144:147], v[16:19]
    ds_read_b64_tr_b16 v[104:105], v122 offset:96
    ds_read_b64_tr_b16 v[106:107], v122 offset:1888
    v_mfma_f32_16x16x32_bf16 v[44:47], v[72:75], v[208:211], v[44:47]
    ds_read_b64_tr_b16 v[108:109], v122 offset:128
    ds_read_b64_tr_b16 v[110:111], v122 offset:1920
    v_mfma_f32_16x16x32_bf16 v[20:23], v[76:79], v[144:147], v[20:23]
    ds_read_b64_tr_b16 v[112:113], v122 offset:160
    ds_read_b64_tr_b16 v[114:115], v122 offset:1952
    buffer_load_dwordx4 v2, s[48:51], s7 offen offset:1024 sc1 lds
    v_mfma_f32_16x16x32_bf16 v[48:51], v[76:79], v[208:211], v[48:51]
    ds_read_b64_tr_b16 v[116:117], v122 offset:192
    ds_read_b64_tr_b16 v[118:119], v122 offset:1984
    v_mfma_f32_16x16x32_bf16 v[24:27], v[80:83], v[144:147], v[24:27]
    v_mfma_f32_16x16x32_bf16 v[52:55], v[80:83], v[208:211], v[52:55]
    v_mfma_f32_16x16x32_bf16 v[28:31], v[84:87], v[144:147], v[28:31]
    buffer_load_dwordx4 v2, s[48:51], s7 offen offset:2048 sc1 lds
    v_mfma_f32_16x16x32_bf16 v[56:59], v[84:87], v[208:211], v[56:59]
    v_mfma_f32_16x16x32_bf16 v[32:35], v[88:91], v[144:147], v[32:35]
    v_mfma_f32_16x16x32_bf16 v[60:63], v[88:91], v[208:211], v[60:63]
    s_mov_b64 exec, s[10:11]
    buffer_load_dwordx4 v2, s[48:51], s7 offen offset:3072 sc1 lds
    s_mov_b64 exec, -1
    s_add_u32 s7, s7, 7168
    s_cmp_eq_u32 s7, s13
    s_cselect_b32 s7, s15, s7
    s_waitcnt lgkmcnt(0)
    v_mfma_f32_16x16x32_bf16 v[8:11], v[92:95], v[148:151], v[8:11]
    v_mfma_f32_16x16x32_bf16 v[36:39], v[92:95], v[212:215], v[36:39]
    s_waitcnt vmcnt(12)
    s_barrier
    ds_read_b64_tr_b16 v[64:65], v122 offset:28672
    ds_read_b64_tr_b16 v[66:67], v122 offset:30464
    v_mfma_f32_16x16x32_bf16 v[12:15], v[96:99], v[148:151], v[12:15]
    ds_read_b64_tr_b16 v[68:69], v122 offset:28704
    ds_read_b64_tr_b16 v[70:71], v122 offset:30496
    s_add_u32 m0, s14, 0
    s_nop 0
    buffer_load_dwordx4 v2, s[48:51], s7 offen offset:0 sc1 lds
    v_mfma_f32_16x16x32_bf16 v[40:43], v[96:99], v[212:215], v[40:43]
    ds_read_b64_tr_b16 v[72:73], v122 offset:28736
    ds_read_b64_tr_b16 v[74:75], v122 offset:30528
    v_mfma_f32_16x16x32_bf16 v[16:19], v[100:103], v[148:151], v[16:19]
    ds_read_b64_tr_b16 v[76:77], v122 offset:28768
    ds_read_b64_tr_b16 v[78:79], v122 offset:30560
    v_mfma_f32_16x16x32_bf16 v[44:47], v[100:103], v[212:215], v[44:47]
    ds_read_b64_tr_b16 v[80:81], v122 offset:28800
    ds_read_b64_tr_b16 v[82:83], v122 offset:30592
    v_mfma_f32_16x16x32_bf16 v[20:23], v[104:107], v[148:151], v[20:23]
    ds_read_b64_tr_b16 v[84:85], v122 offset:28832
    ds_read_b64_tr_b16 v[86:87], v122 offset:30624
    buffer_load_dwordx4 v2, s[48:51], s7 offen offset:1024 sc1 lds
    v_mfma_f32_16x16x32_bf16 v[48:51], v[104:107], v[212:215], v[48:51]
    ds_read_b64_tr_b16 v[88:89], v122 offset:28864
    ds_read_b64_tr_b16 v[90:91], v122 offset:30656
    v_mfma_f32_16x16x32_bf16 v[24:27], v[108:111], v[148:151], v[24:27]
    v_mfma_f32_16x16x32_bf16 v[52:55], v[108:111], v[212:215], v[52:55]
    v_mfma_f32_16x16x32_bf16 v[28:31], v[112:115], v[148:151], v[28:31]
    buffer_load_dwordx4 v2, s[48:51], s7 offen offset:2048 sc1 lds
    v_mfma_f32_16x16x32_bf16 v[56:59], v[112:115], v[212:215], v[56:59]
    v_mfma_f32_16x16x32_bf16 v[32:35], v[116:119], v[148:151], v[32:35]
    v_mfma_f32_16x16x32_bf16 v[60:63], v[116:119], v[212:215], v[60:63]
    s_mov_b64 exec, s[10:11]
    buffer_load_dwordx4 v2, s[48:51], s7 offen offset:3072 sc1 lds
    s_mov_b64 exec, -1
    s_add_u32 s7, s7, 7168
    s_cmp_eq_u32 s7, s13
    s_cselect_b32 s7, s15, s7
    s_waitcnt lgkmcnt(0)
    v_mfma_f32_16x16x32_bf16 v[8:11], v[64:67], v[152:155], v[8:11]
    v_mfma_f32_16x16x32_bf16 v[36:39], v[64:67], v[216:219], v[36:39]
    s_waitcnt vmcnt(12)
    s_barrier
    ds_read_b64_tr_b16 v[92:93], v123 offset:0
    ds_read_b64_tr_b16 v[94:95], v123 offset:1792
    v_mfma_f32_16x16x32_bf16 v[12:15], v[68:71], v[152:155], v[12:15]
    ds_read_b64_tr_b16 v[96:97], v123 offset:32
    ds_read_b64_tr_b16 v[98:99], v123 offset:1824
    s_add_u32 m0, s14, 28672
    s_nop 0
    buffer_load_dwordx4 v2, s[48:51], s7 offen offset:0 sc1 lds
    v_mfma_f32_16x16x32_bf16 v[40:43], v[68:71], v[216:219], v[40:43]
    ds_read_b64_tr_b16 v[100:101], v123 offset:64
    ds_read_b64_tr_b16 v[102:103], v123 offset:1856
    v_mfma_f32_16x16x32_bf16 v[16:19], v[72:75], v[152:155], v[16:19]
    ds_read_b64_tr_b16 v[104:105], v123 offset:96
    ds_read_b64_tr_b16 v[106:107], v123 offset:1888
    v_mfma_f32_16x16x32_bf16 v[44:47], v[72:75], v[216:219], v[44:47]
    ds_read_b64_tr_b16 v[108:109], v123 offset:128
    ds_read_b64_tr_b16 v[110:111], v123 offset:1920
    v_mfma_f32_16x16x32_bf16 v[20:23], v[76:79], v[152:155], v[20:23]
    ds_read_b64_tr_b16 v[112:113], v123 offset:160
    ds_read_b64_tr_b16 v[114:115], v123 offset:1952
    buffer_load_dwordx4 v2, s[48:51], s7 offen offset:1024 sc1 lds
    v_mfma_f32_16x16x32_bf16 v[48:51], v[76:79], v[216:219], v[48:51]
    ds_read_b64_tr_b16 v[116:117], v123 offset:192
    ds_read_b64_tr_b16 v[118:119], v123 offset:1984
    v_mfma_f32_16x16x32_bf16 v[24:27], v[80:83], v[152:155], v[24:27]
    v_mfma_f32_16x16x32_bf16 v[52:55], v[80:83], v[216:219], v[52:55]
    v_mfma_f32_16x16x32_bf16 v[28:31], v[84:87], v[152:155], v[28:31]
    buffer_load_dwordx4 v2, s[48:51], s7 offen offset:2048 sc1 lds
    v_mfma_f32_16x16x32_bf16 v[56:59], v[84:87], v[216:219], v[56:59]
    v_mfma_f32_16x16x32_bf16 v[32:35], v[88:91], v[152:155], v[32:35]
    v_mfma_f32_16x16x32_bf16 v[60:63], v[88:91], v[216:219], v[60:63]
    s_mov_b64 exec, s[10:11]
    buffer_load_dwordx4 v2, s[48:51], s7 offen offset:3072 sc1 lds
    s_mov_b64 exec, -1
    s_add_u32 s7, s7, 7168
    s_cmp_eq_u32 s7, s13
    s_cselect_b32 s7, s15, s7
    s_waitcnt lgkmcnt(0)
    v_mfma_f32_16x16x32_bf16 v[8:11], v[92:95], v[156:159], v[8:11]
    v_mfma_f32_16x16x32_bf16 v[36:39], v[92:95], v[220:223], v[36:39]
    s_waitcnt vmcnt(12)
    s_barrier
    ds_read_b64_tr_b16 v[64:65], v123 offset:28672
    ds_read_b64_tr_b16 v[66:67], v123 offset:30464
    v_mfma_f32_16x16x32_bf16 v[12:15], v[96:99], v[156:159], v[12:15]
    ds_read_b64_tr_b16 v[68:69], v123 offset:28704
    ds_read_b64_tr_b16 v[70:71], v123 offset:30496
    s_add_u32 m0, s14, 57344
    s_nop 0
    buffer_load_dwordx4 v2, s[48:51], s7 offen offset:0 sc1 lds
    v_mfma_f32_16x16x32_bf16 v[40:43], v[96:99], v[220:223], v[40:43]
    ds_read_b64_tr_b16 v[72:73], v123 offset:28736
    ds_read_b64_tr_b16 v[74:75], v123 offset:30528
    v_mfma_f32_16x16x32_bf16 v[16:19], v[100:103], v[156:159], v[16:19]
    ds_read_b64_tr_b16 v[76:77], v123 offset:28768
    ds_read_b64_tr_b16 v[78:79], v123 offset:30560
    v_mfma_f32_16x16x32_bf16 v[44:47], v[100:103], v[220:223], v[44:47]
    ds_read_b64_tr_b16 v[80:81], v123 offset:28800
    ds_read_b64_tr_b16 v[82:83], v123 offset:30592
    v_mfma_f32_16x16x32_bf16 v[20:23], v[104:107], v[156:159], v[20:23]
    ds_read_b64_tr_b16 v[84:85], v123 offset:28832
    ds_read_b64_tr_b16 v[86:87], v123 offset:30624
    buffer_load_dwordx4 v2, s[48:51], s7 offen offset:1024 sc1 lds
    v_mfma_f32_16x16x32_bf16 v[48:51], v[104:107], v[220:223], v[48:51]
    ds_read_b64_tr_b16 v[88:89], v123 offset:28864
    ds_read_b64_tr_b16 v[90:91], v123 offset:30656
    v_mfma_f32_16x16x32_bf16 v[24:27], v[108:111], v[156:159], v[24:27]
    v_mfma_f32_16x16x32_bf16 v[52:55], v[108:111], v[220:223], v[52:55]
    v_mfma_f32_16x16x32_bf16 v[28:31], v[112:115], v[156:159], v[28:31]
    buffer_load_dwordx4 v2, s[48:51], s7 offen offset:2048 sc1 lds
    v_mfma_f32_16x16x32_bf16 v[56:59], v[112:115], v[220:223], v[56:59]
    v_mfma_f32_16x16x32_bf16 v[32:35], v[116:119], v[156:159], v[32:35]
    v_mfma_f32_16x16x32_bf16 v[60:63], v[116:119], v[220:223], v[60:63]
    s_mov_b64 exec, s[10:11]
    buffer_load_dwordx4 v2, s[48:51], s7 offen offset:3072 sc1 lds
    s_mov_b64 exec, -1
    s_add_u32 s7, s7, 7168
    s_cmp_eq_u32 s7, s13
    s_cselect_b32 s7, s15, s7
    s_waitcnt lgkmcnt(0)
    v_mfma_f32_16x16x32_bf16 v[8:11], v[64:67], v[160:163], v[8:11]
    v_mfma_f32_16x16x32_bf16 v[36:39], v[64:67], v[224:227], v[36:39]
    s_waitcnt vmcnt(12)
    s_barrier
    ds_read_b64_tr_b16 v[92:93], v124 offset:0
    ds_read_b64_tr_b16 v[94:95], v124 offset:1792
    v_mfma_f32_16x16x32_bf16 v[12:15], v[68:71], v[160:163], v[12:15]
    ds_read_b64_tr_b16 v[96:97], v124 offset:32
    ds_read_b64_tr_b16 v[98:99], v124 offset:1824
    s_add_u32 m0, s14, 86016
    s_nop 0
    buffer_load_dwordx4 v2, s[48:51], s7 offen offset:0 sc1 lds
    v_mfma_f32_16x16x32_bf16 v[40:43], v[68:71], v[224:227], v[40:43]
    ds_read_b64_tr_b16 v[100:101], v124 offset:64
    ds_read_b64_tr_b16 v[102:103], v124 offset:1856
    v_mfma_f32_16x16x32_bf16 v[16:19], v[72:75], v[160:163], v[16:19]
    ds_read_b64_tr_b16 v[104:105], v124 offset:96
    ds_read_b64_tr_b16 v[106:107], v124 offset:1888
    v_mfma_f32_16x16x32_bf16 v[44:47], v[72:75], v[224:227], v[44:47]
    ds_read_b64_tr_b16 v[108:109], v124 offset:128
    ds_read_b64_tr_b16 v[110:111], v124 offset:1920
    v_mfma_f32_16x16x32_bf16 v[20:23], v[76:79], v[160:163], v[20:23]
    ds_read_b64_tr_b16 v[112:113], v124 offset:160
    ds_read_b64_tr_b16 v[114:115], v124 offset:1952
    buffer_load_dwordx4 v2, s[48:51], s7 offen offset:1024 sc1 lds
    v_mfma_f32_16x16x32_bf16 v[48:51], v[76:79], v[224:227], v[48:51]
    ds_read_b64_tr_b16 v[116:117], v124 offset:192
    ds_read_b64_tr_b16 v[118:119], v124 offset:1984
    v_mfma_f32_16x16x32_bf16 v[24:27], v[80:83], v[160:163], v[24:27]
    v_mfma_f32_16x16x32_bf16 v[52:55], v[80:83], v[224:227], v[52:55]
    v_mfma_f32_16x16x32_bf16 v[28:31], v[84:87], v[160:163], v[28:31]
    buffer_load_dwordx4 v2, s[48:51], s7 offen offset:2048 sc1 lds
    v_mfma_f32_16x16x32_bf16 v[56:59], v[84:87], v[224:227], v[56:59]
    v_mfma_f32_16x16x32_bf16 v[32:35], v[88:91], v[160:163], v[32:35]
    v_mfma_f32_16x16x32_bf16 v[60:63], v[88:91], v[224:227], v[60:63]
    s_mov_b64 exec, s[10:11]
    buffer_load_dwordx4 v2, s[48:51], s7 offen offset:3072 sc1 lds
    s_mov_b64 exec, -1
    s_add_u32 s7, s7, 7168
    s_cmp_eq_u32 s7, s13
    s_cselect_b32 s7, s15, s7
    s_waitcnt lgkmcnt(0)
    v_mfma_f32_16x16x32_bf16 v[8:11], v[92:95], v[164:167], v[8:11]
    v_mfma_f32_16x16x32_bf16 v[36:39], v[92:95], v[228:231], v[36:39]
    s_waitcnt vmcnt(12)
    s_barrier
    ds_read_b64_tr_b16 v[64:65], v122 offset:0
    ds_read_b64_tr_b16 v[66:67], v122 offset:1792
    v_mfma_f32_16x16x32_bf16 v[12:15], v[96:99], v[164:167], v[12:15]
    ds_read_b64_tr_b16 v[68:69], v122 offset:32
    ds_read_b64_tr_b16 v[70:71], v122 offset:1824
    s_add_u32 m0, s14, 114688
    s_nop 0
    buffer_load_dwordx4 v2, s[48:51], s7 offen offset:0 sc1 lds
    v_mfma_f32_16x16x32_bf16 v[40:43], v[96:99], v[228:231], v[40:43]
    ds_read_b64_tr_b16 v[72:73], v122 offset:64
    ds_read_b64_tr_b16 v[74:75], v122 offset:1856
    v_mfma_f32_16x16x32_bf16 v[16:19], v[100:103], v[164:167], v[16:19]
    ds_read_b64_tr_b16 v[76:77], v122 offset:96
    ds_read_b64_tr_b16 v[78:79], v122 offset:1888
    v_mfma_f32_16x16x32_bf16 v[44:47], v[100:103], v[228:231], v[44:47]
    ds_read_b64_tr_b16 v[80:81], v122 offset:128
    ds_read_b64_tr_b16 v[82:83], v122 offset:1920
    v_mfma_f32_16x16x32_bf16 v[20:23], v[104:107], v[164:167], v[20:23]
    ds_read_b64_tr_b16 v[84:85], v122 offset:160
    ds_read_b64_tr_b16 v[86:87], v122 offset:1952
    buffer_load_dwordx4 v2, s[48:51], s7 offen offset:1024 sc1 lds
    v_mfma_f32_16x16x32_bf16 v[48:51], v[104:107], v[228:231], v[48:51]
    ds_read_b64_tr_b16 v[88:89], v122 offset:192
    ds_read_b64_tr_b16 v[90:91], v122 offset:1984
    v_mfma_f32_16x16x32_bf16 v[24:27], v[108:111], v[164:167], v[24:27]
    v_mfma_f32_16x16x32_bf16 v[52:55], v[108:111], v[228:231], v[52:55]
    v_mfma_f32_16x16x32_bf16 v[28:31], v[112:115], v[164:167], v[28:31]
    buffer_load_dwordx4 v2, s[48:51], s7 offen offset:2048 sc1 lds
    v_mfma_f32_16x16x32_bf16 v[56:59], v[112:115], v[228:231], v[56:59]
    v_mfma_f32_16x16x32_bf16 v[32:35], v[116:119], v[164:167], v[32:35]
    v_mfma_f32_16x16x32_bf16 v[60:63], v[116:119], v[228:231], v[60:63]
    s_mov_b64 exec, s[10:11]
    buffer_load_dwordx4 v2, s[48:51], s7 offen offset:3072 sc1 lds
    s_mov_b64 exec, -1
    s_add_u32 s7, s7, 7168
    s_cmp_eq_u32 s7, s13
    s_cselect_b32 s7, s15, s7
    s_waitcnt lgkmcnt(0)
    v_mfma_f32_16x16x32_bf16 v[8:11], v[64:67], v[168:171], v[8:11]
    v_mfma_f32_16x16x32_bf16 v[36:39], v[64:67], v[232:235], v[36:39]
    s_waitcnt vmcnt(12)
    s_barrier
    ds_read_b64_tr_b16 v[92:93], v122 offset:28672
    ds_read_b64_tr_b16 v[94:95], v122 offset:30464
    v_mfma_f32_16x16x32_bf16 v[12:15], v[68:71], v[168:171], v[12:15]
    ds_read_b64_tr_b16 v[96:97], v122 offset:28704
    ds_read_b64_tr_b16 v[98:99], v122 offset:30496
    s_add_u32 m0, s14, 0
    s_nop 0
    buffer_load_dwordx4 v2, s[48:51], s7 offen offset:0 sc1 lds
    v_mfma_f32_16x16x32_bf16 v[40:43], v[68:71], v[232:235], v[40:43]
    ds_read_b64_tr_b16 v[100:101], v122 offset:28736
    ds_read_b64_tr_b16 v[102:103], v122 offset:30528
    v_mfma_f32_16x16x32_bf16 v[16:19], v[72:75], v[168:171], v[16:19]
    ds_read_b64_tr_b16 v[104:105], v122 offset:28768
    ds_read_b64_tr_b16 v[106:107], v122 offset:30560
    v_mfma_f32_16x16x32_bf16 v[44:47], v[72:75], v[232:235], v[44:47]
    ds_read_b64_tr_b16 v[108:109], v122 offset:28800
    ds_read_b64_tr_b16 v[110:111], v122 offset:30592
    v_mfma_f32_16x16x32_bf16 v[20:23], v[76:79], v[168:171], v[20:23]
    ds_read_b64_tr_b16 v[112:113], v122 offset:28832
    ds_read_b64_tr_b16 v[114:115], v122 offset:30624
    buffer_load_dwordx4 v2, s[48:51], s7 offen offset:1024 sc1 lds
    v_mfma_f32_16x16x32_bf16 v[48:51], v[76:79], v[232:235], v[48:51]
    ds_read_b64_tr_b16 v[116:117], v122 offset:28864
    ds_read_b64_tr_b16 v[118:119], v122 offset:30656
    v_mfma_f32_16x16x32_bf16 v[24:27], v[80:83], v[168:171], v[24:27]
    v_mfma_f32_16x16x32_bf16 v[52:55], v[80:83], v[232:235], v[52:55]
    v_mfma_f32_16x16x32_bf16 v[28:31], v[84:87], v[168:171], v[28:31]
    buffer_load_dwordx4 v2, s[48:51], s7 offen offset:2048 sc1 lds
    v_mfma_f32_16x16x32_bf16 v[56:59], v[84:87], v[232:235], v[56:59]
    v_mfma_f32_16x16x32_bf16 v[32:35], v[88:91], v[168:171], v[32:35]
    v_mfma_f32_16x16x32_bf16 v[60:63], v[88:91], v[232:235], v[60:63]
    s_mov_b64 exec, s[10:11]
    buffer_load_dwordx4 v2, s[48:51], s7 offen offset:3072 sc1 lds
    s_mov_b64 exec, -1
    s_add_u32 s7, s7, 7168
    s_cmp_eq_u32 s7, s13
    s_cselect_b32 s7, s15, s7
    s_waitcnt lgkmcnt(0)
    v_mfma_f32_16x16x32_bf16 v[8:11], v[92:95], v[172:175], v[8:11]
    v_mfma_f32_16x16x32_bf16 v[36:39], v[92:95], v[236:239], v[36:39]
    s_waitcnt vmcnt(12)
    s_barrier
    ds_read_b64_tr_b16 v[64:65], v123 offset:0
    ds_read_b64_tr_b16 v[66:67], v123 offset:1792
    v_mfma_f32_16x16x32_bf16 v[12:15], v[96:99], v[172:175], v[12:15]
    ds_read_b64_tr_b16 v[68:69], v123 offset:32
    ds_read_b64_tr_b16 v[70:71], v123 offset:1824
    v_mfma_f32_16x16x32_bf16 v[40:43], v[96:99], v[236:239], v[40:43]
    ds_read_b64_tr_b16 v[72:73], v123 offset:64
    ds_read_b64_tr_b16 v[74:75], v123 offset:1856
    v_mfma_f32_16x16x32_bf16 v[16:19], v[100:103], v[172:175], v[16:19]
    ds_read_b64_tr_b16 v[76:77], v123 offset:96
    ds_read_b64_tr_b16 v[78:79], v123 offset:1888
    v_mfma_f32_16x16x32_bf16 v[44:47], v[100:103], v[236:239], v[44:47]
    ds_read_b64_tr_b16 v[80:81], v123 offset:128
    ds_read_b64_tr_b16 v[82:83], v123 offset:1920
    v_mfma_f32_16x16x32_bf16 v[20:23], v[104:107], v[172:175], v[20:23]
    ds_read_b64_tr_b16 v[84:85], v123 offset:160
    ds_read_b64_tr_b16 v[86:87], v123 offset:1952
    v_mfma_f32_16x16x32_bf16 v[48:51], v[104:107], v[236:239], v[48:51]
    ds_read_b64_tr_b16 v[88:89], v123 offset:192
    ds_read_b64_tr_b16 v[90:91], v123 offset:1984
    v_mfma_f32_16x16x32_bf16 v[24:27], v[108:111], v[172:175], v[24:27]
    v_mfma_f32_16x16x32_bf16 v[52:55], v[108:111], v[236:239], v[52:55]
    v_mfma_f32_16x16x32_bf16 v[28:31], v[112:115], v[172:175], v[28:31]
    v_mfma_f32_16x16x32_bf16 v[56:59], v[112:115], v[236:239], v[56:59]
    v_mfma_f32_16x16x32_bf16 v[32:35], v[116:119], v[172:175], v[32:35]
    v_mfma_f32_16x16x32_bf16 v[60:63], v[116:119], v[236:239], v[60:63]
    s_waitcnt lgkmcnt(0)
    v_mfma_f32_16x16x32_bf16 v[8:11], v[64:67], v[176:179], v[8:11]
    v_mfma_f32_16x16x32_bf16 v[36:39], v[64:67], v[240:243], v[36:39]
    s_waitcnt vmcnt(8)
    s_barrier
    ds_read_b64_tr_b16 v[92:93], v123 offset:28672
    ds_read_b64_tr_b16 v[94:95], v123 offset:30464
    v_mfma_f32_16x16x32_bf16 v[12:15], v[68:71], v[176:179], v[12:15]
    ds_read_b64_tr_b16 v[96:97], v123 offset:28704
    ds_read_b64_tr_b16 v[98:99], v123 offset:30496
    v_mfma_f32_16x16x32_bf16 v[40:43], v[68:71], v[240:243], v[40:43]
    ds_read_b64_tr_b16 v[100:101], v123 offset:28736
    ds_read_b64_tr_b16 v[102:103], v123 offset:30528
    v_mfma_f32_16x16x32_bf16 v[16:19], v[72:75], v[176:179], v[16:19]
    ds_read_b64_tr_b16 v[104:105], v123 offset:28768
    ds_read_b64_tr_b16 v[106:107], v123 offset:30560
    v_mfma_f32_16x16x32_bf16 v[44:47], v[72:75], v[240:243], v[44:47]
    ds_read_b64_tr_b16 v[108:109], v123 offset:28800
    ds_read_b64_tr_b16 v[110:111], v123 offset:30592
    v_mfma_f32_16x16x32_bf16 v[20:23], v[76:79], v[176:179], v[20:23]
    ds_read_b64_tr_b16 v[112:113], v123 offset:28832
    ds_read_b64_tr_b16 v[114:115], v123 offset:30624
    v_mfma_f32_16x16x32_bf16 v[48:51], v[76:79], v[240:243], v[48:51]
    ds_read_b64_tr_b16 v[116:117], v123 offset:28864
    ds_read_b64_tr_b16 v[118:119], v123 offset:30656
    v_mfma_f32_16x16x32_bf16 v[24:27], v[80:83], v[176:179], v[24:27]
    v_mfma_f32_16x16x32_bf16 v[52:55], v[80:83], v[240:243], v[52:55]
    v_mfma_f32_16x16x32_bf16 v[28:31], v[84:87], v[176:179], v[28:31]
    v_mfma_f32_16x16x32_bf16 v[56:59], v[84:87], v[240:243], v[56:59]
    v_mfma_f32_16x16x32_bf16 v[32:35], v[88:91], v[176:179], v[32:35]
    v_mfma_f32_16x16x32_bf16 v[60:63], v[88:91], v[240:243], v[60:63]
    s_waitcnt lgkmcnt(0)
    v_mfma_f32_16x16x32_bf16 v[8:11], v[92:95], v[180:183], v[8:11]
    v_mfma_f32_16x16x32_bf16 v[36:39], v[92:95], v[244:247], v[36:39]
    s_waitcnt vmcnt(4)
    s_barrier
    ds_read_b64_tr_b16 v[64:65], v124 offset:0
    ds_read_b64_tr_b16 v[66:67], v124 offset:1792
    v_mfma_f32_16x16x32_bf16 v[12:15], v[96:99], v[180:183], v[12:15]
    ds_read_b64_tr_b16 v[68:69], v124 offset:32
    ds_read_b64_tr_b16 v[70:71], v124 offset:1824
    v_mfma_f32_16x16x32_bf16 v[40:43], v[96:99], v[244:247], v[40:43]
    ds_read_b64_tr_b16 v[72:73], v124 offset:64
    ds_read_b64_tr_b16 v[74:75], v124 offset:1856
    v_mfma_f32_16x16x32_bf16 v[16:19], v[100:103], v[180:183], v[16:19]
    ds_read_b64_tr_b16 v[76:77], v124 offset:96
    ds_read_b64_tr_b16 v[78:79], v124 offset:1888
    v_mfma_f32_16x16x32_bf16 v[44:47], v[100:103], v[244:247], v[44:47]
    ds_read_b64_tr_b16 v[80:81], v124 offset:128
    ds_read_b64_tr_b16 v[82:83], v124 offset:1920
    v_mfma_f32_16x16x32_bf16 v[20:23], v[104:107], v[180:183], v[20:23]
    ds_read_b64_tr_b16 v[84:85], v124 offset:160
    ds_read_b64_tr_b16 v[86:87], v124 offset:1952
    v_mfma_f32_16x16x32_bf16 v[48:51], v[104:107], v[244:247], v[48:51]
    ds_read_b64_tr_b16 v[88:89], v124 offset:192
    ds_read_b64_tr_b16 v[90:91], v124 offset:1984
    v_mfma_f32_16x16x32_bf16 v[24:27], v[108:111], v[180:183], v[24:27]
    v_mfma_f32_16x16x32_bf16 v[52:55], v[108:111], v[244:247], v[52:55]
    v_mfma_f32_16x16x32_bf16 v[28:31], v[112:115], v[180:183], v[28:31]
    v_mfma_f32_16x16x32_bf16 v[56:59], v[112:115], v[244:247], v[56:59]
    v_mfma_f32_16x16x32_bf16 v[32:35], v[116:119], v[180:183], v[32:35]
    v_mfma_f32_16x16x32_bf16 v[60:63], v[116:119], v[244:247], v[60:63]
    s_waitcnt lgkmcnt(0)
    v_mfma_f32_16x16x32_bf16 v[8:11], v[64:67], v[184:187], v[8:11]
    v_mfma_f32_16x16x32_bf16 v[36:39], v[64:67], v[248:251], v[36:39]
    s_waitcnt vmcnt(0)
    s_barrier
    ds_read_b64_tr_b16 v[92:93], v122 offset:0
    ds_read_b64_tr_b16 v[94:95], v122 offset:1792
    v_mfma_f32_16x16x32_bf16 v[12:15], v[68:71], v[184:187], v[12:15]
    ds_read_b64_tr_b16 v[96:97], v122 offset:32
    ds_read_b64_tr_b16 v[98:99], v122 offset:1824
    v_mfma_f32_16x16x32_bf16 v[40:43], v[68:71], v[248:251], v[40:43]
    ds_read_b64_tr_b16 v[100:101], v122 offset:64
    ds_read_b64_tr_b16 v[102:103], v122 offset:1856
    v_mfma_f32_16x16x32_bf16 v[16:19], v[72:75], v[184:187], v[16:19]
    ds_read_b64_tr_b16 v[104:105], v122 offset:96
    ds_read_b64_tr_b16 v[106:107], v122 offset:1888
    v_mfma_f32_16x16x32_bf16 v[44:47], v[72:75], v[248:251], v[44:47]
    ds_read_b64_tr_b16 v[108:109], v122 offset:128
    ds_read_b64_tr_b16 v[110:111], v122 offset:1920
    v_mfma_f32_16x16x32_bf16 v[20:23], v[76:79], v[184:187], v[20:23]
    ds_read_b64_tr_b16 v[112:113], v122 offset:160
    ds_read_b64_tr_b16 v[114:115], v122 offset:1952
    v_mfma_f32_16x16x32_bf16 v[48:51], v[76:79], v[248:251], v[48:51]
    ds_read_b64_tr_b16 v[116:117], v122 offset:192
    ds_read_b64_tr_b16 v[118:119], v122 offset:1984
    v_mfma_f32_16x16x32_bf16 v[24:27], v[80:83], v[184:187], v[24:27]
    v_mfma_f32_16x16x32_bf16 v[52:55], v[80:83], v[248:251], v[52:55]
    v_mfma_f32_16x16x32_bf16 v[28:31], v[84:87], v[184:187], v[28:31]
    v_mfma_f32_16x16x32_bf16 v[56:59], v[84:87], v[248:251], v[56:59]
    v_mfma_f32_16x16x32_bf16 v[32:35], v[88:91], v[184:187], v[32:35]
    v_mfma_f32_16x16x32_bf16 v[60:63], v[88:91], v[248:251], v[60:63]
    s_waitcnt lgkmcnt(0)
    v_mfma_f32_16x16x32_bf16 v[8:11], v[92:95], v[188:191], v[8:11]
    v_mfma_f32_16x16x32_bf16 v[36:39], v[92:95], v[252:255], v[36:39]
    v_mfma_f32_16x16x32_bf16 v[12:15], v[96:99], v[188:191], v[12:15]
    v_mfma_f32_16x16x32_bf16 v[40:43], v[96:99], v[252:255], v[40:43]
    v_mfma_f32_16x16x32_bf16 v[16:19], v[100:103], v[188:191], v[16:19]
    v_mfma_f32_16x16x32_bf16 v[44:47], v[100:103], v[252:255], v[44:47]
    v_mfma_f32_16x16x32_bf16 v[20:23], v[104:107], v[188:191], v[20:23]
    v_mfma_f32_16x16x32_bf16 v[48:51], v[104:107], v[252:255], v[48:51]
    v_mfma_f32_16x16x32_bf16 v[24:27], v[108:111], v[188:191], v[24:27]
    v_mfma_f32_16x16x32_bf16 v[52:55], v[108:111], v[252:255], v[52:55]
    v_mfma_f32_16x16x32_bf16 v[28:31], v[112:115], v[188:191], v[28:31]
    v_mfma_f32_16x16x32_bf16 v[56:59], v[112:115], v[252:255], v[56:59]
    v_mfma_f32_16x16x32_bf16 v[32:35], v[116:119], v[188:191], v[32:35]
    v_mfma_f32_16x16x32_bf16 v[60:63], v[116:119], v[252:255], v[60:63]
    s_barrier
    s_mul_i32 s5, s4, 28672
    s_bfe_u32 s6, s3, 0x10001
    s_mul_i32 s6, s6, 14336
    s_add_u32 s5, s5, s6
    v_add_u32 v5, s5, v2
    ds_write_b128 v5, v[8:11] offset:0
    ds_write_b128 v5, v[12:15] offset:1024
    ds_write_b128 v5, v[16:19] offset:2048
    ds_write_b128 v5, v[20:23] offset:3072
    ds_write_b128 v5, v[24:27] offset:4096
    ds_write_b128 v5, v[28:31] offset:5120
    ds_write_b128 v5, v[32:35] offset:6144
    ds_write_b128 v5, v[36:39] offset:7168
    ds_write_b128 v5, v[40:43] offset:8192
    ds_write_b128 v5, v[44:47] offset:9216
    ds_write_b128 v5, v[48:51] offset:10240
    ds_write_b128 v5, v[52:55] offset:11264
    ds_write_b128 v5, v[56:59] offset:12288
    ds_write_b128 v5, v[60:63] offset:13312
    ds_read_b128 v[112:115], v125
    ds_read_b128 v[116:119], v125 offset:16
    s_waitcnt lgkmcnt(0)
    s_barrier
    s_and_b32 s5, s3, 3
    s_mul_i32 s5, s5, 7168
    s_lshr_b32 s6, s3, 2
    s_lshl_b32 s6, s6, 12
    s_add_u32 s5, s5, s6
    v_add_u32 v5, s5, v2
    v_add_u32 v6, 57344, v5
    ds_read_b128 v[128:131], v5 offset:0
    ds_read_b128 v[132:135], v5 offset:1024
    ds_read_b128 v[136:139], v5 offset:2048
    ds_read_b128 v[140:143], v5 offset:3072
    ds_read_b128 v[144:147], v5 offset:28672
    ds_read_b128 v[148:151], v5 offset:29696
    ds_read_b128 v[152:155], v5 offset:30720
    ds_read_b128 v[156:159], v5 offset:31744
    ds_read_b128 v[160:163], v6 offset:0
    ds_read_b128 v[164:167], v6 offset:1024
    ds_read_b128 v[168:171], v6 offset:2048
    ds_read_b128 v[172:175], v6 offset:3072
    ds_read_b128 v[176:179], v6 offset:28672
    ds_read_b128 v[180:183], v6 offset:29696
    ds_read_b128 v[184:187], v6 offset:30720
    ds_read_b128 v[188:191], v6 offset:31744
    v_bfe_u32 v5, v1, 4, 1
    v_lshlrev_b32 v5, 5, v5
    v_lshrrev_b32 v6, 5, v1
    v_lshl_add_u32 v5, v6, 4, v5
    s_lshr_b32 s5, s3, 2
    s_lshl_b32 s5, s5, 7
    v_add_u32 v16, s5, v5
    v_mul_u32_u24 v5, 1792, v120
    v_add_u32 v16, v16, v5
    s_mul_i32 s14, s9, 224
    s_waitcnt lgkmcnt(0)
    v_lshlrev_b32 v121, 16, v121
    v_pk_add_f32 v[128:129], v[128:129], v[144:145]
    v_pk_add_f32 v[160:161], v[160:161], v[176:177]
    v_pk_add_f32 v[130:131], v[130:131], v[146:147]
    v_pk_add_f32 v[162:163], v[162:163], v[178:179]
    v_pk_add_f32 v[132:133], v[132:133], v[148:149]
    v_pk_add_f32 v[164:165], v[164:165], v[180:181]
    v_pk_add_f32 v[134:135], v[134:135], v[150:151]
    v_pk_add_f32 v[166:167], v[166:167], v[182:183]
    v_pk_add_f32 v[136:137], v[136:137], v[152:153]
    v_pk_add_f32 v[168:169], v[168:169], v[184:185]
    v_pk_add_f32 v[138:139], v[138:139], v[154:155]
    v_pk_add_f32 v[170:171], v[170:171], v[186:187]
    v_pk_add_f32 v[140:141], v[140:141], v[156:157]
    v_pk_add_f32 v[172:173], v[172:173], v[188:189]
    v_pk_add_f32 v[142:143], v[142:143], v[158:159]
    v_pk_add_f32 v[174:175], v[174:175], v[190:191]
    v_pk_add_f32 v[128:129], v[128:129], v[160:161]
    v_pk_add_f32 v[130:131], v[130:131], v[162:163]
    v_pk_add_f32 v[132:133], v[132:133], v[164:165]
    v_pk_add_f32 v[134:135], v[134:135], v[166:167]
    v_pk_add_f32 v[136:137], v[136:137], v[168:169]
    v_pk_add_f32 v[138:139], v[138:139], v[170:171]
    v_pk_add_f32 v[140:141], v[140:141], v[172:173]
    v_pk_add_f32 v[142:143], v[142:143], v[174:175]
    v_cvt_pk_bf16_f32 v128, v128, v129
    v_cvt_pk_bf16_f32 v130, v130, v131
    v_cvt_pk_bf16_f32 v132, v132, v133
    v_cvt_pk_bf16_f32 v134, v134, v135
    v_cvt_pk_bf16_f32 v136, v136, v137
    v_cvt_pk_bf16_f32 v138, v138, v139
    v_cvt_pk_bf16_f32 v140, v140, v141
    v_cvt_pk_bf16_f32 v142, v142, v143
    v_and_b32 v129, 0xffff0000, v128
    v_and_b32 v131, 0xffff0000, v130
    v_and_b32 v133, 0xffff0000, v132
    v_and_b32 v135, 0xffff0000, v134
    v_and_b32 v137, 0xffff0000, v136
    v_and_b32 v139, 0xffff0000, v138
    v_and_b32 v141, 0xffff0000, v140
    v_and_b32 v143, 0xffff0000, v142
    v_lshlrev_b32 v128, 16, v128
    v_lshlrev_b32 v130, 16, v130
    v_lshlrev_b32 v132, 16, v132
    v_lshlrev_b32 v134, 16, v134
    v_lshlrev_b32 v136, 16, v136
    v_lshlrev_b32 v138, 16, v138
    v_lshlrev_b32 v140, 16, v140
    v_lshlrev_b32 v142, 16, v142
    v_pk_add_f32 v[128:129], v[128:129], v[120:121] op_sel:[0,1] op_sel_hi:[1,1]
    v_pk_add_f32 v[130:131], v[130:131], v[120:121] op_sel:[0,1] op_sel_hi:[1,1]
    v_pk_add_f32 v[132:133], v[132:133], v[120:121] op_sel:[0,1] op_sel_hi:[1,1]
    v_pk_add_f32 v[134:135], v[134:135], v[120:121] op_sel:[0,1] op_sel_hi:[1,1]
    v_pk_add_f32 v[136:137], v[136:137], v[120:121] op_sel:[0,1] op_sel_hi:[1,1]
    v_pk_add_f32 v[138:139], v[138:139], v[120:121] op_sel:[0,1] op_sel_hi:[1,1]
    v_pk_add_f32 v[140:141], v[140:141], v[120:121] op_sel:[0,1] op_sel_hi:[1,1]
    v_pk_add_f32 v[142:143], v[142:143], v[120:121] op_sel:[0,1] op_sel_hi:[1,1]
    v_cvt_pk_bf16_f32 v128, v128, v129
    v_cvt_pk_bf16_f32 v130, v130, v131
    v_cvt_pk_bf16_f32 v132, v132, v133
    v_cvt_pk_bf16_f32 v134, v134, v135
    v_cvt_pk_bf16_f32 v136, v136, v137
    v_cvt_pk_bf16_f32 v138, v138, v139
    v_cvt_pk_bf16_f32 v140, v140, v141
    v_cvt_pk_bf16_f32 v142, v142, v143
    v_and_b32 v129, 0xffff0000, v128
    v_and_b32 v131, 0xffff0000, v130
    v_and_b32 v133, 0xffff0000, v132
    v_and_b32 v135, 0xffff0000, v134
    v_and_b32 v137, 0xffff0000, v136
    v_and_b32 v139, 0xffff0000, v138
    v_and_b32 v141, 0xffff0000, v140
    v_and_b32 v143, 0xffff0000, v142
    v_lshlrev_b32 v128, 16, v128
    v_lshlrev_b32 v130, 16, v130
    v_lshlrev_b32 v132, 16, v132
    v_lshlrev_b32 v134, 16, v134
    v_lshlrev_b32 v136, 16, v136
    v_lshlrev_b32 v138, 16, v138
    v_lshlrev_b32 v140, 16, v140
    v_lshlrev_b32 v142, 16, v142
    v_lshlrev_b32 v144, 16, v112
    v_and_b32 v145, 0xffff0000, v112
    v_lshlrev_b32 v146, 16, v113
    v_and_b32 v147, 0xffff0000, v113
    v_lshlrev_b32 v148, 16, v114
    v_and_b32 v149, 0xffff0000, v114
    v_lshlrev_b32 v150, 16, v115
    v_and_b32 v151, 0xffff0000, v115
    v_lshlrev_b32 v152, 16, v116
    v_and_b32 v153, 0xffff0000, v116
    v_lshlrev_b32 v154, 16, v117
    v_and_b32 v155, 0xffff0000, v117
    v_lshlrev_b32 v156, 16, v118
    v_and_b32 v157, 0xffff0000, v118
    v_lshlrev_b32 v158, 16, v119
    v_and_b32 v159, 0xffff0000, v119
    v_pk_mul_f32 v[144:145], v[144:145], v[128:129]
    v_pk_mul_f32 v[146:147], v[146:147], v[130:131]
    v_pk_mul_f32 v[148:149], v[148:149], v[132:133]
    v_pk_mul_f32 v[150:151], v[150:151], v[134:135]
    v_pk_mul_f32 v[152:153], v[152:153], v[136:137]
    v_pk_mul_f32 v[154:155], v[154:155], v[138:139]
    v_pk_mul_f32 v[156:157], v[156:157], v[140:141]
    v_pk_mul_f32 v[158:159], v[158:159], v[142:143]
    v_cvt_pk_bf16_f32 v112, v144, v145
    v_cvt_pk_bf16_f32 v113, v146, v147
    v_cvt_pk_bf16_f32 v114, v148, v149
    v_cvt_pk_bf16_f32 v115, v150, v151
    v_cvt_pk_bf16_f32 v116, v152, v153
    v_cvt_pk_bf16_f32 v117, v154, v155
    v_cvt_pk_bf16_f32 v118, v156, v157
    v_cvt_pk_bf16_f32 v119, v158, v159
    v_permlane16_swap_b32 v112, v114
    v_permlane16_swap_b32 v113, v115
    v_permlane16_swap_b32 v116, v118
    v_permlane16_swap_b32 v117, v119
    buffer_store_dwordx4 v[112:115], v16, s[60:63], s14 offen sc1
    s_lshr_b32 s5, s3, 2
    v_bfe_u32 v5, v1, 4, 1
    v_and_b32 v5, s5, v5
    v_cmp_eq_u32 vcc, 0, v5
    s_nop 0
    s_and_saveexec_b64 s[12:13], vcc
    buffer_store_dwordx4 v[116:119], v16, s[60:63], s14 offen offset:64 sc1
    s_mov_b64 exec, s[12:13]
    s_waitcnt vmcnt(0)
    s_barrier
    s_cmp_eq_u32 s3, 0
    s_cbranch_scc0 pub_17027
    s_add_u32 s5, s8, 80
    s_lshl_b32 s5, s5, 8
    s_lshl_b32 s6, s9, 2
    s_add_u32 s5, s5, s6
    v_mov_b32 v5, 1
    s_mov_b64 exec, 1
    buffer_store_dword v5, off, s[84:87], s5 sc1
    s_mov_b64 exec, -1
pub_17027:
    s_add_u32 s44, s40, 0xc00000
    s_addc_u32 s45, s41, 0
    s_mov_b32 s46, 0x200000
    s_mov_b32 s47, 0x00020000
    s_add_u32 s48, s40, 0x1600000
    s_addc_u32 s49, s41, 0
    s_mov_b32 s50, 0x380000
    s_mov_b32 s51, 0x00020000
    s_mov_b32 s52, s40
    s_mov_b32 s53, s41
    s_mov_b32 s54, 0x3000
    s_mov_b32 s55, 0x00020000
    s_mov_b32 s60, s36
    s_mov_b32 s61, s37
    s_mov_b32 s62, 0x200000
    s_mov_b32 s63, 0x00020000
    v_lshrrev_b32 v5, 4, v1
    s_lshl_b32 s5, s3, 3
    s_add_u32 s5, s5, 0
    v_add_u32 v5, s5, v5
    v_mul_u32_u24 v28, 1792, v5
    v_and_b32 v5, 15, v5
    v_and_b32 v6, 15, v1
    v_xor_b32 v5, v5, v6
    v_lshl_add_u32 v28, v5, 4, v28
    v_lshrrev_b32 v5, 4, v1
    s_lshl_b32 s5, s3, 3
    s_add_u32 s5, s5, 4
    v_add_u32 v5, s5, v5
    v_mul_u32_u24 v29, 1792, v5
    v_and_b32 v5, 15, v5
    v_and_b32 v6, 15, v1
    v_xor_b32 v5, v5, v6
    v_lshl_add_u32 v29, v5, 4, v29
    s_mul_i32 s10, s8, 114688
    s_lshl_b32 s12, s3, 11
    s_mov_b32 s56, s30
    s_mov_b32 s57, s31
    s_mov_b32 s58, 0xe0000
    s_mov_b32 s59, 0x00020000
    v_lshrrev_b32 v5, 3, v1
    s_lshl_b32 s5, s3, 3
    v_add_u32 v5, s5, v5
    v_mul_u32_u24 v24, 1024, v5
    v_bfe_u32 v5, v1, 4, 1
    s_and_b32 s5, s3, 1
    s_lshl_b32 s5, s5, 1
    v_or_b32 v5, s5, v5
    v_lshlrev_b32 v5, 1, v5
    v_and_b32 v6, 7, v1
    v_xor_b32 v5, v5, v6
    v_lshl_add_u32 v24, v5, 4, v24
    s_lshl_b32 s5, s9, 7
    v_add_u32 v24, s5, v24
    s_lshl_b32 s11, s3, 10
    s_mov_b32 s5, 0
    s_add_u32 s6, s11, 49152
    s_mov_b32 m0, s6
    s_nop 0
    buffer_load_dwordx4 v24, s[56:59], s5 offen lds
    s_mov_b32 s5, 65536
    s_add_u32 s6, s11, 57344
    s_mov_b32 m0, s6
    s_nop 0
    buffer_load_dwordx4 v24, s[56:59], s5 offen lds
    s_mov_b32 s5, 131072
    s_add_u32 s6, s11, 65536
    s_mov_b32 m0, s6
    s_nop 0
    buffer_load_dwordx4 v24, s[56:59], s5 offen lds
    s_mov_b32 s5, 196608
    s_add_u32 s6, s11, 73728
    s_mov_b32 m0, s6
    s_nop 0
    buffer_load_dwordx4 v24, s[56:59], s5 offen lds
    s_mov_b32 s5, 262144
    s_add_u32 s6, s11, 81920
    s_mov_b32 m0, s6
    s_nop 0
    buffer_load_dwordx4 v24, s[56:59], s5 offen lds
    s_mov_b32 s5, 327680
    s_add_u32 s6, s11, 90112
    s_mov_b32 m0, s6
    s_nop 0
    buffer_load_dwordx4 v24, s[56:59], s5 offen lds
    s_mov_b32 s5, 393216
    s_add_u32 s6, s11, 98304
    s_mov_b32 m0, s6
    s_nop 0
    buffer_load_dwordx4 v24, s[56:59], s5 offen lds
    s_mov_b32 s5, 458752
    s_add_u32 s6, s11, 106496
    s_mov_b32 m0, s6
    s_nop 0
    buffer_load_dwordx4 v24, s[56:59], s5 offen lds
    s_mov_b32 s5, 524288
    s_add_u32 s6, s11, 114688
    s_mov_b32 m0, s6
    s_nop 0
    buffer_load_dwordx4 v24, s[56:59], s5 offen lds
    s_mov_b32 s5, 589824
    s_add_u32 s6, s11, 122880
    s_mov_b32 m0, s6
    s_nop 0
    buffer_load_dwordx4 v24, s[56:59], s5 offen lds
    s_mov_b32 s5, 655360
    s_add_u32 s6, s11, 131072
    s_mov_b32 m0, s6
    s_nop 0
    buffer_load_dwordx4 v24, s[56:59], s5 offen lds
    s_mov_b32 s5, 720896
    s_add_u32 s6, s11, 139264
    s_mov_b32 m0, s6
    s_nop 0
    buffer_load_dwordx4 v24, s[56:59], s5 offen lds
    s_mov_b32 s5, 786432
    s_add_u32 s6, s11, 147456
    s_mov_b32 m0, s6
    s_nop 0
    buffer_load_dwordx4 v24, s[56:59], s5 offen lds
    s_mov_b32 s5, 851968
    s_add_u32 s6, s11, 155648
    s_mov_b32 m0, s6
    s_nop 0
    buffer_load_dwordx4 v24, s[56:59], s5 offen lds
    v_and_b32 v5, 15, v1
    s_and_b32 s5, s3, 3
    s_lshl_b32 s5, s5, 4
    s_lshl_b32 s6, s8, 6
    s_add_u32 s5, s5, s6
    v_add_u32 v5, s5, v5
    v_mov_b32 v11, v5
    v_bfe_u32 v6, v1, 4, 1
    v_lshrrev_b32 v7, 5, v1
    v_lshlrev_b32 v6, 4, v6
    v_lshl_add_u32 v6, v7, 3, v6
    s_lshr_b32 s5, s3, 2
    s_lshl_b32 s5, s5, 5
    s_lshl_b32 s6, s9, 6
    s_add_u32 s5, s5, s6
    v_add_u32 v6, s5, v6
    v_lshlrev_b32 v10, 10, v5
    v_lshl_add_u32 v10, v6, 1, v10
    v_lshlrev_b32 v6, 2, v6
    buffer_load_dwordx4 v[12:15], v10, s[44:47], 0 offen
    s_mov_b32 s5, 10240
    buffer_load_dwordx4 v[16:19], v6, s[52:55], s5 offen sc1
    buffer_load_dwordx4 v[20:23], v6, s[52:55], s5 offen offset:16 sc1
    s_cmp_eq_u32 s3, 0
    s_cbranch_scc0 pd_17029
    s_add_u32 s5, s8, 80
    s_lshl_b32 s5, s5, 8
    v_lshlrev_b32 v6, 2, v1
    s_mov_b32 s6, 0
    s_mov_b32 exec_lo, 0xff
    s_mov_b32 exec_hi, 0
poll_17028:
    buffer_load_dword v5, v6, s[84:87], s5 offen sc0 sc1
    s_waitcnt vmcnt(0)
    v_cmp_ne_u32 vcc, 0, v5
    s_add_u32 s6, s6, 1
    s_cmp_gt_u32 s6, 0x20000
    s_cbranch_scc1 poll_17028_x
    s_cmp_eq_u64 vcc, exec
    s_cbranch_scc1 poll_17028_x
    s_sleep 6
    s_branch poll_17028
poll_17028_x:
    s_mov_b64 exec, -1
pd_17029:
    s_barrier
    s_add_u32 s5, s10, 0
    s_add_u32 s6, s12, 0
    s_mov_b32 m0, s6
    s_nop 0
    buffer_load_dwordx4 v28, s[48:51], s5 offen sc1 lds
    s_add_u32 s5, s10, 0
    s_add_u32 s6, s12, 1024
    s_mov_b32 m0, s6
    s_nop 0
    buffer_load_dwordx4 v29, s[48:51], s5 offen sc1 lds
    s_add_u32 s5, s10, 256
    s_add_u32 s6, s12, 16384
    s_mov_b32 m0, s6
    s_nop 0
    buffer_load_dwordx4 v28, s[48:51], s5 offen sc1 lds
    s_add_u32 s5, s10, 256
    s_add_u32 s6, s12, 17408
    s_mov_b32 m0, s6
    s_nop 0
    buffer_load_dwordx4 v29, s[48:51], s5 offen sc1 lds
    s_add_u32 s5, s10, 512
    s_add_u32 s6, s12, 32768
    s_mov_b32 m0, s6
    s_nop 0
    buffer_load_dwordx4 v28, s[48:51], s5 offen sc1 lds
    s_add_u32 s5, s10, 512
    s_add_u32 s6, s12, 33792
    s_mov_b32 m0, s6
    s_nop 0
    buffer_load_dwordx4 v29, s[48:51], s5 offen sc1 lds
    v_lshrrev_b32 v5, 4, v1
    v_bfe_u32 v6, v1, 2, 2
    v_lshl_add_u32 v7, v5, 3, v6
    v_bfe_u32 v8, v1, 3, 1
    v_and_b32 v9, 1, v5
    v_lshl_or_b32 v8, v9, 1, v8
    v_lshlrev_b32 v7, 7, v7
    v_and_b32 v9, 3, v1
    v_lshl_add_u32 v7, v9, 3, v7
    v_add_u32 v7, 49152, v7
    s_lshr_b32 s5, s3, 2
    s_lshl_b32 s5, s5, 1
    v_xor_b32 v9, s5, v8
    v_lshl_add_u32 v25, v9, 5, v7
    s_add_u32 s5, s5, 1
    v_xor_b32 v9, s5, v8
    v_lshl_add_u32 v26, v9, 5, v7
    v_add_u32 v30, 0xe000, v25
    v_add_u32 v31, 0xe000, v26
    v_and_b32 v5, 15, v1
    v_lshrrev_b32 v6, 4, v1
    v_xor_b32 v6, v5, v6
    v_lshlrev_b32 v6, 4, v6
    v_lshl_add_u32 v6, v5, 8, v6
    s_and_b32 s5, s3, 3
    s_lshl_b32 s5, s5, 12
    v_add_u32 v6, s5, v6
    v_xor_b32 v88, 0, v6
    v_xor_b32 v89, 64, v6
    v_xor_b32 v90, 128, v6
    v_xor_b32 v91, 192, v6
    v_mov_b32 v32, 0
    v_mov_b32 v33, 0
    v_mov_b32 v34, 0
    v_mov_b32 v35, 0
    v_mov_b32 v36, 0
    v_mov_b32 v37, 0
    v_mov_b32 v38, 0
    v_mov_b32 v39, 0
    s_waitcnt lgkmcnt(0)
    s_waitcnt vmcnt(4)
    s_barrier
    ds_read_b128 v[40:43], v88 offset:0
    ds_read_b64_tr_b16 v[48:49], v25 offset:0
    ds_read_b64_tr_b16 v[50:51], v25 offset:512
    ds_read_b64_tr_b16 v[52:53], v26 offset:0
    ds_read_b64_tr_b16 v[54:55], v26 offset:512
    ds_read_b128 v[44:47], v89 offset:0
    ds_read_b64_tr_b16 v[56:57], v25 offset:4096
    ds_read_b64_tr_b16 v[58:59], v25 offset:4608
    ds_read_b64_tr_b16 v[60:61], v26 offset:4096
    ds_read_b64_tr_b16 v[62:63], v26 offset:4608
    s_waitcnt lgkmcnt(0)
    v_mfma_f32_16x16x32_bf16 v[32:35], v[48:51], v[40:43], v[32:35]
    ds_read_b128 v[64:67], v90 offset:0
    ds_read_b64_tr_b16 v[72:73], v25 offset:8192
    ds_read_b64_tr_b16 v[74:75], v25 offset:8704
    v_mfma_f32_16x16x32_bf16 v[36:39], v[52:55], v[40:43], v[36:39]
    ds_read_b64_tr_b16 v[76:77], v26 offset:8192
    ds_read_b64_tr_b16 v[78:79], v26 offset:8704
    ds_read_b128 v[68:71], v91 offset:0
    v_mfma_f32_16x16x32_bf16 v[32:35], v[56:59], v[44:47], v[32:35]
    ds_read_b64_tr_b16 v[80:81], v25 offset:12288
    ds_read_b64_tr_b16 v[82:83], v25 offset:12800
    ds_read_b64_tr_b16 v[84:85], v26 offset:12288
    v_mfma_f32_16x16x32_bf16 v[36:39], v[60:63], v[44:47], v[36:39]
    ds_read_b64_tr_b16 v[86:87], v26 offset:12800
    s_waitcnt lgkmcnt(0)
    v_mfma_f32_16x16x32_bf16 v[32:35], v[72:75], v[64:67], v[32:35]
    s_waitcnt vmcnt(2)
    s_barrier
    ds_read_b128 v[40:43], v88 offset:16384
    ds_read_b64_tr_b16 v[48:49], v25 offset:16384
    ds_read_b64_tr_b16 v[50:51], v25 offset:16896
    v_mfma_f32_16x16x32_bf16 v[36:39], v[76:79], v[64:67], v[36:39]
    ds_read_b64_tr_b16 v[52:53], v26 offset:16384
    ds_read_b64_tr_b16 v[54:55], v26 offset:16896
    ds_read_b128 v[44:47], v89 offset:16384
    v_mfma_f32_16x16x32_bf16 v[32:35], v[80:83], v[68:71], v[32:35]
    ds_read_b64_tr_b16 v[56:57], v25 offset:20480
    ds_read_b64_tr_b16 v[58:59], v25 offset:20992
    ds_read_b64_tr_b16 v[60:61], v26 offset:20480
    v_mfma_f32_16x16x32_bf16 v[36:39], v[84:87], v[68:71], v[36:39]
    ds_read_b64_tr_b16 v[62:63], v26 offset:20992
    s_add_u32 s5, s10, 768
    s_add_u32 s6, s12, 0
    s_mov_b32 m0, s6
    s_nop 0
    buffer_load_dwordx4 v28, s[48:51], s5 offen sc1 lds
    s_add_u32 s5, s10, 768
    s_add_u32 s6, s12, 1024
    s_mov_b32 m0, s6
    s_nop 0
    buffer_load_dwordx4 v29, s[48:51], s5 offen sc1 lds
    s_waitcnt lgkmcnt(0)
    v_mfma_f32_16x16x32_bf16 v[32:35], v[48:51], v[40:43], v[32:35]
    ds_read_b128 v[64:67], v90 offset:16384
    ds_read_b64_tr_b16 v[72:73], v25 offset:24576
    ds_read_b64_tr_b16 v[74:75], v25 offset:25088
    v_mfma_f32_16x16x32_bf16 v[36:39], v[52:55], v[40:43], v[36:39]
    ds_read_b64_tr_b16 v[76:77], v26 offset:24576
    ds_read_b64_tr_b16 v[78:79], v26 offset:25088
    ds_read_b128 v[68:71], v91 offset:16384
    v_mfma_f32_16x16x32_bf16 v[32:35], v[56:59], v[44:47], v[32:35]
    ds_read_b64_tr_b16 v[80:81], v25 offset:28672
    ds_read_b64_tr_b16 v[82:83], v25 offset:29184
    ds_read_b64_tr_b16 v[84:85], v26 offset:28672
    v_mfma_f32_16x16x32_bf16 v[36:39], v[60:63], v[44:47], v[36:39]
    ds_read_b64_tr_b16 v[86:87], v26 offset:29184
    s_waitcnt lgkmcnt(0)
    v_mfma_f32_16x16x32_bf16 v[32:35], v[72:75], v[64:67], v[32:35]
    s_waitcnt vmcnt(2)
    s_barrier
    ds_read_b128 v[40:43], v88 offset:32768
    ds_read_b64_tr_b16 v[48:49], v25 offset:32768
    ds_read_b64_tr_b16 v[50:51], v25 offset:33280
    v_mfma_f32_16x16x32_bf16 v[36:39], v[76:79], v[64:67], v[36:39]
    ds_read_b64_tr_b16 v[52:53], v26 offset:32768
    ds_read_b64_tr_b16 v[54:55], v26 offset:33280
    ds_read_b128 v[44:47], v89 offset:32768
    v_mfma_f32_16x16x32_bf16 v[32:35], v[80:83], v[68:71], v[32:35]
    ds_read_b64_tr_b16 v[56:57], v25 offset:36864
    ds_read_b64_tr_b16 v[58:59], v25 offset:37376
    ds_read_b64_tr_b16 v[60:61], v26 offset:36864
    v_mfma_f32_16x16x32_bf16 v[36:39], v[84:87], v[68:71], v[36:39]
    ds_read_b64_tr_b16 v[62:63], v26 offset:37376
    s_add_u32 s5, s10, 1024
    s_add_u32 s6, s12, 16384
    s_mov_b32 m0, s6
    s_nop 0
    buffer_load_dwordx4 v28, s[48:51], s5 offen sc1 lds
    s_add_u32 s5, s10, 1024
    s_add_u32 s6, s12, 17408
    s_mov_b32 m0, s6
    s_nop 0
    buffer_load_dwordx4 v29, s[48:51], s5 offen sc1 lds
    s_waitcnt lgkmcnt(0)
    v_mfma_f32_16x16x32_bf16 v[32:35], v[48:51], v[40:43], v[32:35]
    ds_read_b128 v[64:67], v90 offset:32768
    ds_read_b64_tr_b16 v[72:73], v25 offset:40960
    ds_read_b64_tr_b16 v[74:75], v25 offset:41472
    v_mfma_f32_16x16x32_bf16 v[36:39], v[52:55], v[40:43], v[36:39]
    ds_read_b64_tr_b16 v[76:77], v26 offset:40960
    ds_read_b64_tr_b16 v[78:79], v26 offset:41472
    ds_read_b128 v[68:71], v91 offset:32768
    v_mfma_f32_16x16x32_bf16 v[32:35], v[56:59], v[44:47], v[32:35]
    ds_read_b64_tr_b16 v[80:81], v25 offset:45056
    ds_read_b64_tr_b16 v[82:83], v25 offset:45568
    ds_read_b64_tr_b16 v[84:85], v26 offset:45056
    v_mfma_f32_16x16x32_bf16 v[36:39], v[60:63], v[44:47], v[36:39]
    ds_read_b64_tr_b16 v[86:87], v26 offset:45568
    s_waitcnt lgkmcnt(0)
    v_mfma_f32_16x16x32_bf16 v[32:35], v[72:75], v[64:67], v[32:35]
    s_waitcnt vmcnt(2)
    s_barrier
    ds_read_b128 v[40:43], v88 offset:0
    ds_read_b64_tr_b16 v[48:49], v25 offset:49152
    ds_read_b64_tr_b16 v[50:51], v25 offset:49664
    v_mfma_f32_16x16x32_bf16 v[36:39], v[76:79], v[64:67], v[36:39]
    ds_read_b64_tr_b16 v[52:53], v26 offset:49152
    ds_read_b64_tr_b16 v[54:55], v26 offset:49664
    ds_read_b128 v[44:47], v89 offset:0
    v_mfma_f32_16x16x32_bf16 v[32:35], v[80:83], v[68:71], v[32:35]
    ds_read_b64_tr_b16 v[56:57], v25 offset:53248
    ds_read_b64_tr_b16 v[58:59], v25 offset:53760
    ds_read_b64_tr_b16 v[60:61], v26 offset:53248
    v_mfma_f32_16x16x32_bf16 v[36:39], v[84:87], v[68:71], v[36:39]
    ds_read_b64_tr_b16 v[62:63], v26 offset:53760
    s_add_u32 s5, s10, 1280
    s_add_u32 s6, s12, 32768
    s_mov_b32 m0, s6
    s_nop 0
    buffer_load_dwordx4 v28, s[48:51], s5 offen sc1 lds
    s_add_u32 s5, s10, 1280
    s_add_u32 s6, s12, 33792
    s_mov_b32 m0, s6
    s_nop 0
    buffer_load_dwordx4 v29, s[48:51], s5 offen sc1 lds
    s_waitcnt lgkmcnt(0)
    v_mfma_f32_16x16x32_bf16 v[32:35], v[48:51], v[40:43], v[32:35]
    ds_read_b128 v[64:67], v90 offset:0
    ds_read_b64_tr_b16 v[72:73], v30 offset:0
    ds_read_b64_tr_b16 v[74:75], v30 offset:512
    v_mfma_f32_16x16x32_bf16 v[36:39], v[52:55], v[40:43], v[36:39]
    ds_read_b64_tr_b16 v[76:77], v31 offset:0
    ds_read_b64_tr_b16 v[78:79], v31 offset:512
    ds_read_b128 v[68:71], v91 offset:0
    v_mfma_f32_16x16x32_bf16 v[32:35], v[56:59], v[44:47], v[32:35]
    ds_read_b64_tr_b16 v[80:81], v30 offset:4096
    ds_read_b64_tr_b16 v[82:83], v30 offset:4608
    ds_read_b64_tr_b16 v[84:85], v31 offset:4096
    v_mfma_f32_16x16x32_bf16 v[36:39], v[60:63], v[44:47], v[36:39]
    ds_read_b64_tr_b16 v[86:87], v31 offset:4608
    s_waitcnt lgkmcnt(0)
    v_mfma_f32_16x16x32_bf16 v[32:35], v[72:75], v[64:67], v[32:35]
    s_waitcnt vmcnt(2)
    s_barrier
    ds_read_b128 v[40:43], v88 offset:16384
    ds_read_b64_tr_b16 v[48:49], v30 offset:8192
    ds_read_b64_tr_b16 v[50:51], v30 offset:8704
    v_mfma_f32_16x16x32_bf16 v[36:39], v[76:79], v[64:67], v[36:39]
    ds_read_b64_tr_b16 v[52:53], v31 offset:8192
    ds_read_b64_tr_b16 v[54:55], v31 offset:8704
    ds_read_b128 v[44:47], v89 offset:16384
    v_mfma_f32_16x16x32_bf16 v[32:35], v[80:83], v[68:71], v[32:35]
    ds_read_b64_tr_b16 v[56:57], v30 offset:12288
    ds_read_b64_tr_b16 v[58:59], v30 offset:12800
    ds_read_b64_tr_b16 v[60:61], v31 offset:12288
    v_mfma_f32_16x16x32_bf16 v[36:39], v[84:87], v[68:71], v[36:39]
    ds_read_b64_tr_b16 v[62:63], v31 offset:12800
    s_add_u32 s5, s10, 1536
    s_add_u32 s6, s12, 0
    s_mov_b32 m0, s6
    s_nop 0
    buffer_load_dwordx4 v28, s[48:51], s5 offen sc1 lds
    s_add_u32 s5, s10, 1536
    s_add_u32 s6, s12, 1024
    s_mov_b32 m0, s6
    s_nop 0
    buffer_load_dwordx4 v29, s[48:51], s5 offen sc1 lds
    s_waitcnt lgkmcnt(0)
    v_mfma_f32_16x16x32_bf16 v[32:35], v[48:51], v[40:43], v[32:35]
    ds_read_b128 v[64:67], v90 offset:16384
    ds_read_b64_tr_b16 v[72:73], v30 offset:16384
    ds_read_b64_tr_b16 v[74:75], v30 offset:16896
    v_mfma_f32_16x16x32_bf16 v[36:39], v[52:55], v[40:43], v[36:39]
    ds_read_b64_tr_b16 v[76:77], v31 offset:16384
    ds_read_b64_tr_b16 v[78:79], v31 offset:16896
    ds_read_b128 v[68:71], v91 offset:16384
    v_mfma_f32_16x16x32_bf16 v[32:35], v[56:59], v[44:47], v[32:35]
    ds_read_b64_tr_b16 v[80:81], v30 offset:20480
    ds_read_b64_tr_b16 v[82:83], v30 offset:20992
    ds_read_b64_tr_b16 v[84:85], v31 offset:20480
    v_mfma_f32_16x16x32_bf16 v[36:39], v[60:63], v[44:47], v[36:39]
    ds_read_b64_tr_b16 v[86:87], v31 offset:20992
    s_waitcnt lgkmcnt(0)
    v_mfma_f32_16x16x32_bf16 v[32:35], v[72:75], v[64:67], v[32:35]
    s_waitcnt vmcnt(2)
    s_barrier
    ds_read_b128 v[40:43], v88 offset:32768
    ds_read_b64_tr_b16 v[48:49], v30 offset:24576
    ds_read_b64_tr_b16 v[50:51], v30 offset:25088
    v_mfma_f32_16x16x32_bf16 v[36:39], v[76:79], v[64:67], v[36:39]
    ds_read_b64_tr_b16 v[52:53], v31 offset:24576
    ds_read_b64_tr_b16 v[54:55], v31 offset:25088
    ds_read_b128 v[44:47], v89 offset:32768
    v_mfma_f32_16x16x32_bf16 v[32:35], v[80:83], v[68:71], v[32:35]
    ds_read_b64_tr_b16 v[56:57], v30 offset:28672
    ds_read_b64_tr_b16 v[58:59], v30 offset:29184
    ds_read_b64_tr_b16 v[60:61], v31 offset:28672
    v_mfma_f32_16x16x32_bf16 v[36:39], v[84:87], v[68:71], v[36:39]
    ds_read_b64_tr_b16 v[62:63], v31 offset:29184
    s_waitcnt lgkmcnt(0)
    v_mfma_f32_16x16x32_bf16 v[32:35], v[48:51], v[40:43], v[32:35]
    ds_read_b128 v[64:67], v90 offset:32768
    ds_read_b64_tr_b16 v[72:73], v30 offset:32768
    ds_read_b64_tr_b16 v[74:75], v30 offset:33280
    v_mfma_f32_16x16x32_bf16 v[36:39], v[52:55], v[40:43], v[36:39]
    ds_read_b64_tr_b16 v[76:77], v31 offset:32768
    ds_read_b64_tr_b16 v[78:79], v31 offset:33280
    ds_read_b128 v[68:71], v91 offset:32768
    v_mfma_f32_16x16x32_bf16 v[32:35], v[56:59], v[44:47], v[32:35]
    ds_read_b64_tr_b16 v[80:81], v30 offset:36864
    ds_read_b64_tr_b16 v[82:83], v30 offset:37376
    ds_read_b64_tr_b16 v[84:85], v31 offset:36864
    v_mfma_f32_16x16x32_bf16 v[36:39], v[60:63], v[44:47], v[36:39]
    ds_read_b64_tr_b16 v[86:87], v31 offset:37376
    s_waitcnt lgkmcnt(0)
    v_mfma_f32_16x16x32_bf16 v[32:35], v[72:75], v[64:67], v[32:35]
    s_waitcnt vmcnt(0)
    s_barrier
    ds_read_b128 v[40:43], v88 offset:0
    ds_read_b64_tr_b16 v[48:49], v30 offset:40960
    ds_read_b64_tr_b16 v[50:51], v30 offset:41472
    v_mfma_f32_16x16x32_bf16 v[36:39], v[76:79], v[64:67], v[36:39]
    ds_read_b64_tr_b16 v[52:53], v31 offset:40960
    ds_read_b64_tr_b16 v[54:55], v31 offset:41472
    ds_read_b128 v[44:47], v89 offset:0
    v_mfma_f32_16x16x32_bf16 v[32:35], v[80:83], v[68:71], v[32:35]
    ds_read_b64_tr_b16 v[56:57], v30 offset:45056
    ds_read_b64_tr_b16 v[58:59], v30 offset:45568
    ds_read_b64_tr_b16 v[60:61], v31 offset:45056
    v_mfma_f32_16x16x32_bf16 v[36:39], v[84:87], v[68:71], v[36:39]
    ds_read_b64_tr_b16 v[62:63], v31 offset:45568
    s_waitcnt lgkmcnt(0)
    v_mfma_f32_16x16x32_bf16 v[32:35], v[48:51], v[40:43], v[32:35]
    ds_read_b128 v[64:67], v90 offset:0
    ds_read_b64_tr_b16 v[72:73], v30 offset:49152
    ds_read_b64_tr_b16 v[74:75], v30 offset:49664
    v_mfma_f32_16x16x32_bf16 v[36:39], v[52:55], v[40:43], v[36:39]
    ds_read_b64_tr_b16 v[76:77], v31 offset:49152
    ds_read_b64_tr_b16 v[78:79], v31 offset:49664
    ds_read_b128 v[68:71], v91 offset:0
    v_mfma_f32_16x16x32_bf16 v[32:35], v[56:59], v[44:47], v[32:35]
    ds_read_b64_tr_b16 v[80:81], v30 offset:53248
    ds_read_b64_tr_b16 v[82:83], v30 offset:53760
    ds_read_b64_tr_b16 v[84:85], v31 offset:53248
    v_mfma_f32_16x16x32_bf16 v[36:39], v[60:63], v[44:47], v[36:39]
    ds_read_b64_tr_b16 v[86:87], v31 offset:53760
    s_waitcnt lgkmcnt(0)
    v_mfma_f32_16x16x32_bf16 v[32:35], v[72:75], v[64:67], v[32:35]
    v_mfma_f32_16x16x32_bf16 v[36:39], v[76:79], v[64:67], v[36:39]
    v_mfma_f32_16x16x32_bf16 v[32:35], v[80:83], v[68:71], v[32:35]
    v_mfma_f32_16x16x32_bf16 v[36:39], v[84:87], v[68:71], v[36:39]
    s_nop 7
    v_permlane16_swap_b32 v32, v36
    v_permlane16_swap_b32 v33, v37
    v_permlane16_swap_b32 v34, v38
    v_permlane16_swap_b32 v35, v39
    s_waitcnt vmcnt(0)
    v_lshlrev_b32 v6, 16, v12
    v_and_b32 v7, 0xffff0000, v12
    v_fma_f32 v6, v32, v16, v6
    v_fma_f32 v7, v33, v17, v7
    v_cvt_pk_bf16_f32 v12, v6, v7
    v_lshlrev_b32 v6, 16, v13
    v_and_b32 v7, 0xffff0000, v13
    v_fma_f32 v6, v34, v18, v6
    v_fma_f32 v7, v35, v19, v7
    v_cvt_pk_bf16_f32 v13, v6, v7
    v_lshlrev_b32 v6, 16, v14
    v_and_b32 v7, 0xffff0000, v14
    v_fma_f32 v6, v36, v20, v6
    v_fma_f32 v7, v37, v21, v7
    v_cvt_pk_bf16_f32 v14, v6, v7
    v_lshlrev_b32 v6, 16, v15
    v_and_b32 v7, 0xffff0000, v15
    v_fma_f32 v6, v38, v22, v6
    v_fma_f32 v7, v39, v23, v7
    v_cvt_pk_bf16_f32 v15, v6, v7
    buffer_store_dwordx4 v[12:15], v10, s[60:63], 0 offen
    s_endpgm
.section .rodata,"a"
.p2align 6
.amdhsa_kernel adaLN_cond__mha_block__mixer_gmlp__prompt_kernel
  .amdhsa_next_free_vgpr 256
  .amdhsa_next_free_sgpr 102
  .amdhsa_accum_offset 256
  .amdhsa_group_segment_fixed_size 0
  .amdhsa_kernarg_size 104
  .amdhsa_user_sgpr_count 2
  .amdhsa_user_sgpr_kernarg_segment_ptr 1
  .amdhsa_system_sgpr_workgroup_id_x 1
.end_amdhsa_kernel
```
